```python
import torch

def _softmax(x, axis=-1):
    return torch.softmax(x, dim=axis)
def _gelu(x):
    return torch.nn.functional.gelu(x, approximate="tanh")
def _silu(x):
    return torch.nn.functional.silu(x)
def _sigmoid(x):
    return torch.sigmoid(x)
def _layernorm(x, axis=-1, eps=1e-5):
    m = x.mean(dim=axis, keepdim=True)
    v = x.var(dim=axis, keepdim=True, unbiased=False)
    return (x - m) / torch.sqrt(v + eps)
def _scatter_add(tgt, idx, src, axis=0):
    return tgt.clone().index_add_(axis, idx, src)
def _segment_sum(src, seg, n):
    out = torch.zeros((n,) + src.shape[1:], dtype=src.dtype)
    return out.index_add_(0, seg, src)
def _pad(x, pw):
    flat = tuple(v for pair in reversed(pw) for v in pair)
    return torch.nn.functional.pad(x, flat)

kernel_name = 'concat_heads__grouped_kv_mqa__spectral_fnet__prompt'

def setup_inputs():

    _w = (lambda a: (lambda t: t.to(torch.bfloat16) if t.is_floating_point() else t)(torch.as_tensor(a)))
    def _A_setup():
        B, S, D, H = 1, 2048, 1024, 32
        Dh = D // H
        return {
            "x": _w((lambda *s: torch.randn(*s, dtype=torch.bfloat16) * 0.05)(B, S, D)),
            "wq": _w((lambda *s: torch.randn(*s, dtype=torch.bfloat16) * 3.2)(D, H * Dh)),
            "wk": _w((lambda *s: torch.randn(*s, dtype=torch.bfloat16) * 3.2)(D, Dh)),
            "wv": _w((lambda *s: torch.randn(*s, dtype=torch.bfloat16) * 0.4)(D, Dh)),
            "wo": _w((lambda *s: torch.randn(*s, dtype=torch.bfloat16) * 0.4)(H * Dh, D)),
        }
    _A_in = _A_setup()

    def _B_setup():
        B, S, D = 1, 2048, 1024
        ns = torch.arange(S)[:, None] * torch.arange(S)[None, :]
        nd = torch.arange(D)[:, None] * torch.arange(D)[None, :]
        Ws_re = torch.cos(-2.0 * torch.pi * ns / S).to(float)
        Ws_im = torch.sin(-2.0 * torch.pi * ns / S).to(float)
        Wd_re = torch.cos(-2.0 * torch.pi * nd / D).to(float)
        Wd_im = torch.sin(-2.0 * torch.pi * nd / D).to(float)
        return {
            "x": _w((lambda *s: torch.randn(*s, dtype=torch.bfloat16) * 0.05)(B, S, D)),
            "dft_seq_re": _w(Ws_re),
            "dft_seq_im": _w(Ws_im),
            "dft_hid_re": _w(Wd_re),
            "dft_hid_im": _w(Wd_im),
        }
    _B_in = _B_setup()

    return {
        "A_x": _A_in["x"],
        "A_wq": _A_in["wq"],
        "A_wk": _A_in["wk"],
        "A_wv": _A_in["wv"],
        "A_wo": _A_in["wo"],
        "B_x": _B_in["x"],
        "B_dft_seq_re": _B_in["dft_seq_re"],
        "B_dft_seq_im": _B_in["dft_seq_im"],
        "B_dft_hid_re": _B_in["dft_hid_re"],
        "B_dft_hid_im": _B_in["dft_hid_im"],
    }

def reference(A_x, A_wq, A_wk, A_wv, A_wo, B_x, B_dft_seq_re, B_dft_seq_im, B_dft_hid_re, B_dft_hid_im):
    def _A_ref(x, wq, wk, wv, wo):
        B, S, D = x.shape
        H = 32
        Dh = D // H
        q = (lambda x, *d: x.permute(*d))((x @ wq).reshape(B, S, H, Dh), 0, 2, 1, 3)
        k = x @ wk
        v = x @ wv
        scores = torch.einsum("bhqd,bkd->bhqk", q, k) * (Dh ** -0.5)
        p = _softmax(scores, axis=-1)
        o = torch.einsum("bhqk,bkd->bhqd", p, v)
        return (lambda x, *d: x.permute(*d))(o, 0, 2, 1, 3).reshape(B, S, H * Dh) @ wo

    def _B_ref(x, dft_seq_re, dft_seq_im, dft_hid_re, dft_hid_im):
        a = torch.einsum("bsd,ed->bse", x, dft_hid_re)
        b = torch.einsum("bsd,ed->bse", x, dft_hid_im)
        y = torch.einsum("ts,bse->bte", dft_seq_re, a) - torch.einsum("ts,bse->bte", dft_seq_im, b)
        return y

    a = _A_ref(A_x, A_wq, A_wk, A_wv, A_wo)
    b = _B_ref(B_x, B_dft_seq_re, B_dft_seq_im, B_dft_hid_re, B_dft_hid_im)
    return torch.concatenate([a, b], axis=-1)
```

```asm
; @launch kernel=k1_kernel grid=(256,1,1) block=(512,1,1) lds=131072
; @launch kernel=k2_kernel grid=(256,1,1) block=(512,1,1) lds=163840
; @launch kernel=k3_kernel grid=(256,1,1) block=(512,1,1) lds=147456
.amdgcn_target "amdgcn-amd-amdhsa--gfx950"
.text
.globl k1_kernel
.p2align 8
.type k1_kernel,@function
k1_kernel:
    s_cmp_ge_u32 s2, 256
    s_cbranch_scc1 L_k1_end
    s_load_dwordx4 s[32:35], s[0:1], 0
    s_load_dwordx2 s[50:51], s[0:1], 64
    s_load_dwordx2 s[52:53], s[0:1], 72
    s_load_dwordx2 s[88:89], s[0:1], 32
    s_load_dwordx4 s[92:95], s[0:1], 48
    s_load_dwordx2 s[48:49], s[0:1], 96
    s_load_dwordx4 s[64:67], s[0:1], 16
    s_load_dwordx2 s[74:75], s[0:1], 40
    s_load_dwordx2 s[90:91], s[0:1], 88
    v_lshrrev_b32 v1, 6, v0
    s_nop 0
    v_readfirstlane_b32 s22, v1
    v_and_b32 v2, 63, v0
    s_nop 2
    s_lshl_b32 s18, s22, 10
    v_lshrrev_b32 v3, 3, v2
    v_lshl_add_u32 v3, v1, 5, v3
    v_bfe_u32 v4, v3, 1, 1
    v_bfe_u32 v5, v2, 2, 1
    v_xor_b32 v4, v4, v5
    v_and_b32 v5, 3, v2
    v_lshlrev_b32 v5, 4, v5
    v_lshl_add_u32 v5, v4, 6, v5
    v_lshl_add_u32 v6, v3, 11, v5
    v_subrev_u32 v3, 64, v3
    v_bfe_u32 v4, v3, 1, 3
    v_and_b32 v5, 7, v2
    v_xor_b32 v4, v4, v5
    v_lshlrev_b32 v4, 4, v4
    v_lshl_add_u32 v7, v3, 11, v4
    v_lshlrev_b32 v8, 4, v2
    v_cmp_gt_u32 vcc, 2, v1
    v_mov_b32 v9, 64
    v_mov_b32 v10, 16384
    v_cndmask_b32 v152, v7, v6, vcc
    v_cndmask_b32 v9, v9, 0, vcc
    v_cmp_lt_u32 vcc, 5, v1
    v_mov_b32 v11, 1024
    s_lshl_b32 s20, s22, 12
    v_cndmask_b32 v152, v152, v8, vcc
    v_cndmask_b32 v9, v9, 0, vcc
    v_cndmask_b32 v10, v10, v11, vcc
    v_xor_b32 v153, v152, v9
    v_add_u32 v153, v153, v10
    v_lshl_add_u32 v154, v10, 1, v152
    v_lshl_add_u32 v155, v10, 1, v153
    s_waitcnt lgkmcnt(0)
    s_bitcmp1_b32 s2, 2
    s_cselect_b32 s96, s66, s64
    s_cselect_b32 s97, s67, s65
    s_mov_b32 s98, 65536
    s_mov_b32 s99, 0x00020000
    s_cmp_lt_u32 s22, 6
    s_cselect_b32 s96, s32, s96
    s_cselect_b32 s97, s33, s97
    s_cselect_b32 s98, 4194304, s98
    s_cmp_lt_u32 s22, 2
    s_cselect_b32 s96, s34, s96
    s_cselect_b32 s97, s35, s97
    s_cselect_b32 s98, 2097152, s98
    s_mov_b32 s12, s48
    s_mov_b32 s13, s49
    s_mov_b32 s14, 41943040
    s_mov_b32 s15, 0x00020000
    s_mov_b32 s36, s34
    s_mov_b32 s37, s35
    s_mov_b32 s38, 2097152
    s_mov_b32 s39, 0x00020000
    s_mov_b32 s44, s32
    s_mov_b32 s45, s33
    s_mov_b32 s46, 4194304
    s_mov_b32 s47, 0x00020000
    s_mov_b32 s80, s74
    s_mov_b32 s81, s75
    s_mov_b32 s82, 4194304
    s_mov_b32 s83, 0x00020000
    s_mov_b32 s84, s50
    s_mov_b32 s85, s51
    s_mov_b32 s86, 1050624
    s_mov_b32 s87, 0x00020000
    s_and_b32 s30, s2, 7
    s_lshr_b32 s31, s2, 3
    s_and_b32 s54, s30, 3
    s_lshl_b32 s54, s54, 2
    s_and_b32 s55, s31, 3
    s_add_u32 s54, s54, s55
    s_lshr_b32 s55, s30, 2
    s_lshl_b32 s55, s55, 3
    s_lshr_b32 s56, s31, 2
    s_add_u32 s55, s55, s56
    s_lshl_b32 s16, s55, 7
    s_lshl_b32 s17, s54, 18
    s_add_u32 s26, s17, s16
    s_cmp_lt_u32 s22, 2
    s_cselect_b32 s16, s16, s17
    s_mov_b32 s23, 128
    s_cselect_b32 s17, 131072, s23
    s_cmp_ge_u32 s22, 6
    s_cselect_b32 s16, 0, s16
    s_cselect_b32 s17, 4096, s17
    s_mov_b32 s5, 0
    s_lshr_b32 s56, s55, 1
    s_and_b32 s23, s55, 1
    s_lshl_b32 s23, s23, 3
    s_or_b32 s56, s56, s23
    s_and_b32 s24, s56, 3
    s_lshl_b32 s23, s54, 2
    s_add_u32 s24, s24, s23
    s_lshl_b32 s24, s24, 12
    s_add_u32 s24, s24, 4194304
    s_lshl_b32 s26, s2, 14
    s_lshl_b32 s23, s22, 11
    s_add_u32 s26, s26, s23
    s_cmp_ge_u32 s2, 128
    s_cselect_b32 s8, s52, s50
    s_cselect_b32 s9, s53, s51
    s_mov_b32 s10, 1048576
    s_mov_b32 s11, 0x00020000
    s_cmp_ge_u32 s56, 8
    s_cselect_b32 s23, 6, 7
    s_cmp_ge_u32 s22, s23
    s_cbranch_scc1 L_qg_F
    s_cmp_ge_u32 s56, 8
    s_cbranch_scc1 L_qg_D
    s_and_b32 s23, s56, 3
    s_cmp_lg_u32 s22, s23
    s_cbranch_scc1 L_qg_D
    s_cmp_ge_u32 s56, 4
    s_cbranch_scc1 L_qg_PV
L_qg_PK:
    s_add_u32 m0, s20, 0
    s_nop 0
    buffer_load_dwordx4 v152, s[96:99], s16 offen lds
    s_add_u32 m0, s20, 1024
    s_nop 0
    buffer_load_dwordx4 v153, s[96:99], s16 offen lds
    s_add_u32 m0, s20, 2048
    s_nop 0
    buffer_load_dwordx4 v154, s[96:99], s16 offen lds
    s_add_u32 m0, s20, 3072
    s_nop 0
    buffer_load_dwordx4 v155, s[96:99], s16 offen lds
    s_add_u32 s16, s16, s17
    s_add_u32 m0, s20, 28672
    s_nop 0
    buffer_load_dwordx4 v152, s[96:99], s16 offen lds
    s_add_u32 m0, s20, 29696
    s_nop 0
    buffer_load_dwordx4 v153, s[96:99], s16 offen lds
    s_add_u32 m0, s20, 30720
    s_nop 0
    buffer_load_dwordx4 v154, s[96:99], s16 offen lds
    s_add_u32 m0, s20, 31744
    s_nop 0
    buffer_load_dwordx4 v155, s[96:99], s16 offen lds
    s_add_u32 s16, s16, s17
    s_add_u32 m0, s20, 57344
    s_nop 0
    buffer_load_dwordx4 v152, s[96:99], s16 offen lds
    s_add_u32 m0, s20, 58368
    s_nop 0
    buffer_load_dwordx4 v153, s[96:99], s16 offen lds
    s_add_u32 m0, s20, 59392
    s_nop 0
    buffer_load_dwordx4 v154, s[96:99], s16 offen lds
    s_add_u32 m0, s20, 60416
    s_nop 0
    buffer_load_dwordx4 v155, s[96:99], s16 offen lds
    s_add_u32 s16, s16, s17
    v_lshlrev_b32 v9, 4, v2
    v_bfe_u32 v3, v2, 2, 2
    v_lshrrev_b32 v4, 5, v2
    v_lshl_add_u32 v4, v4, 3, v3
    v_bfe_u32 v5, v2, 4, 1
    v_and_b32 v6, 3, v2
    v_lshlrev_b32 v6, 3, v6
    v_lshl_add_u32 v6, v5, 5, v6
    v_lshl_add_u32 v7, v4, 6, v6
    v_lshl_add_u32 v4, v4, 7, v6
    v_lshrrev_b32 v3, 1, v3
    v_lshrrev_b32 v5, 2, v1
    v_xor_b32 v3, v3, v5
    v_lshl_add_u32 v4, v3, 6, v4
    v_add_u32 v181, 24576, v7
    v_add_u32 v182, 81920, v7
    v_add_u32 v183, 139264, v7
    v_add_u32 v156, 0, v4
    v_add_u32 v161, 28672, v4
    v_add_u32 v166, 57344, v4
    v_add_u32 v171, 86016, v4
    s_mov_b32 s27, 0
    s_and_b32 s25, s22, 3
    s_lshl_b32 s25, s25, 5
    v_and_b32 v3, 31, v2
    v_bfe_u32 v4, v3, 1, 3
    v_lshrrev_b32 v5, 5, v2
    v_xor_b32 v4, v4, v5
    v_xor_b32 v4, s27, v4
    v_add_u32 v3, s25, v3
    v_lshlrev_b32 v3, 7, v3
    v_lshl_add_u32 v3, v4, 4, v3
    v_add_u32 v157, 8192, v3
    v_xor_b32 v158, 32, v157
    v_xor_b32 v159, 64, v157
    v_xor_b32 v160, 96, v157
    v_add_u32 v162, 36864, v3
    v_xor_b32 v163, 32, v162
    v_xor_b32 v164, 64, v162
    v_xor_b32 v165, 96, v162
    v_add_u32 v167, 65536, v3
    v_xor_b32 v168, 32, v167
    v_xor_b32 v169, 64, v167
    v_xor_b32 v170, 96, v167
    v_add_u32 v172, 94208, v3
    v_xor_b32 v173, 32, v172
    v_xor_b32 v174, 64, v172
    v_xor_b32 v175, 96, v172
    v_mov_b32 v120, 0
    v_mov_b32 v121, 0
    v_mov_b32 v122, 0
    v_mov_b32 v123, 0
    v_mov_b32 v124, 0
    v_mov_b32 v125, 0
    v_mov_b32 v126, 0
    v_mov_b32 v127, 0
    v_mov_b32 v128, 0
    v_mov_b32 v129, 0
    v_mov_b32 v130, 0
    v_mov_b32 v131, 0
    v_mov_b32 v132, 0
    v_mov_b32 v133, 0
    v_mov_b32 v134, 0
    v_mov_b32 v135, 0
    v_mov_b32 v72, 0
    v_mov_b32 v73, 0
    v_mov_b32 v74, 0
    v_mov_b32 v75, 0
    v_mov_b32 v76, 0
    v_mov_b32 v77, 0
    v_mov_b32 v78, 0
    v_mov_b32 v79, 0
    v_mov_b32 v80, 0
    v_mov_b32 v81, 0
    v_mov_b32 v82, 0
    v_mov_b32 v83, 0
    v_mov_b32 v84, 0
    v_mov_b32 v85, 0
    v_mov_b32 v86, 0
    v_mov_b32 v87, 0
    s_waitcnt vmcnt(8)
    s_barrier
    ds_read_b64_tr_b16 v[88:89], v156 offset:0
    ds_read_b64_tr_b16 v[90:91], v156 offset:512
    ds_read_b128 v[96:99], v157
    ds_read_b64_tr_b16 v[32:33], v181 offset:0
    ds_read_b64_tr_b16 v[34:35], v181 offset:256
    ds_read_b64_tr_b16 v[92:93], v156 offset:2048
    ds_read_b64_tr_b16 v[94:95], v156 offset:2560
    ds_read_b128 v[100:103], v158
    ds_read_b64_tr_b16 v[36:37], v181 offset:1024
    ds_read_b64_tr_b16 v[38:39], v181 offset:1280
    ds_read_b64_tr_b16 v[104:105], v156 offset:4096
    ds_read_b64_tr_b16 v[106:107], v156 offset:4608
    ds_read_b128 v[112:115], v159
    ds_read_b64_tr_b16 v[40:41], v181 offset:2048
    ds_read_b64_tr_b16 v[42:43], v181 offset:2304
    ds_read_b64_tr_b16 v[108:109], v156 offset:6144
    ds_read_b64_tr_b16 v[110:111], v156 offset:6656
    ds_read_b128 v[116:119], v160
    ds_read_b64_tr_b16 v[44:45], v181 offset:3072
    ds_read_b64_tr_b16 v[46:47], v181 offset:3328
    s_waitcnt lgkmcnt(10)
    v_mfma_f32_32x32x16_bf16 v[120:135], v[88:91], v[96:99], v[120:135]
    s_add_u32 m0, s20, 86016
    s_nop 0
    buffer_load_dwordx4 v152, s[96:99], s16 offen lds
    v_mfma_f32_32x32x16_bf16 v[72:87], v[32:35], v[96:99], v[72:87]
    s_add_u32 m0, s20, 87040
    s_nop 0
    buffer_load_dwordx4 v153, s[96:99], s16 offen lds
    v_mfma_f32_32x32x16_bf16 v[120:135], v[92:95], v[100:103], v[120:135]
    v_mfma_f32_32x32x16_bf16 v[72:87], v[36:39], v[100:103], v[72:87]
    s_add_u32 m0, s20, 88064
    s_nop 0
    buffer_load_dwordx4 v154, s[96:99], s16 offen lds
    s_waitcnt lgkmcnt(0)
    v_mfma_f32_32x32x16_bf16 v[120:135], v[104:107], v[112:115], v[120:135]
    s_add_u32 m0, s20, 89088
    s_nop 0
    buffer_load_dwordx4 v155, s[96:99], s16 offen lds
    v_mfma_f32_32x32x16_bf16 v[72:87], v[40:43], v[112:115], v[72:87]
    s_add_u32 s16, s16, s17
    s_waitcnt vmcnt(8)
    s_barrier
    ds_read_b64_tr_b16 v[88:89], v161 offset:0
    ds_read_b64_tr_b16 v[90:91], v161 offset:512
    ds_read_b128 v[96:99], v162
    ds_read_b64_tr_b16 v[32:33], v181 offset:28672
    ds_read_b64_tr_b16 v[34:35], v181 offset:28928
    ds_read_b64_tr_b16 v[92:93], v161 offset:2048
    ds_read_b64_tr_b16 v[94:95], v161 offset:2560
    ds_read_b128 v[100:103], v163
    ds_read_b64_tr_b16 v[36:37], v181 offset:29696
    ds_read_b64_tr_b16 v[38:39], v181 offset:29952
    v_mfma_f32_32x32x16_bf16 v[120:135], v[108:111], v[116:119], v[120:135]
    v_mfma_f32_32x32x16_bf16 v[72:87], v[44:47], v[116:119], v[72:87]
    ds_read_b64_tr_b16 v[104:105], v161 offset:4096
    ds_read_b64_tr_b16 v[106:107], v161 offset:4608
    ds_read_b128 v[112:115], v164
    ds_read_b64_tr_b16 v[40:41], v181 offset:30720
    ds_read_b64_tr_b16 v[42:43], v181 offset:30976
    ds_read_b64_tr_b16 v[108:109], v161 offset:6144
    ds_read_b64_tr_b16 v[110:111], v161 offset:6656
    ds_read_b128 v[116:119], v165
    ds_read_b64_tr_b16 v[44:45], v181 offset:31744
    ds_read_b64_tr_b16 v[46:47], v181 offset:32000
    s_waitcnt lgkmcnt(10)
    v_mfma_f32_32x32x16_bf16 v[120:135], v[88:91], v[96:99], v[120:135]
    s_add_u32 m0, s20, 0
    s_nop 0
    buffer_load_dwordx4 v152, s[96:99], s16 offen lds
    v_mfma_f32_32x32x16_bf16 v[72:87], v[32:35], v[96:99], v[72:87]
    s_add_u32 m0, s20, 1024
    s_nop 0
    buffer_load_dwordx4 v153, s[96:99], s16 offen lds
    v_mfma_f32_32x32x16_bf16 v[120:135], v[92:95], v[100:103], v[120:135]
    v_mfma_f32_32x32x16_bf16 v[72:87], v[36:39], v[100:103], v[72:87]
    s_add_u32 m0, s20, 2048
    s_nop 0
    buffer_load_dwordx4 v154, s[96:99], s16 offen lds
    s_waitcnt lgkmcnt(0)
    v_mfma_f32_32x32x16_bf16 v[120:135], v[104:107], v[112:115], v[120:135]
    s_add_u32 m0, s20, 3072
    s_nop 0
    buffer_load_dwordx4 v155, s[96:99], s16 offen lds
    v_mfma_f32_32x32x16_bf16 v[72:87], v[40:43], v[112:115], v[72:87]
    s_add_u32 s16, s16, s17
    s_waitcnt vmcnt(8)
    s_barrier
    ds_read_b64_tr_b16 v[88:89], v166 offset:0
    ds_read_b64_tr_b16 v[90:91], v166 offset:512
    ds_read_b128 v[96:99], v167
    ds_read_b64_tr_b16 v[32:33], v182 offset:0
    ds_read_b64_tr_b16 v[34:35], v182 offset:256
    ds_read_b64_tr_b16 v[92:93], v166 offset:2048
    ds_read_b64_tr_b16 v[94:95], v166 offset:2560
    ds_read_b128 v[100:103], v168
    ds_read_b64_tr_b16 v[36:37], v182 offset:1024
    ds_read_b64_tr_b16 v[38:39], v182 offset:1280
    v_mfma_f32_32x32x16_bf16 v[120:135], v[108:111], v[116:119], v[120:135]
    v_mfma_f32_32x32x16_bf16 v[72:87], v[44:47], v[116:119], v[72:87]
    ds_read_b64_tr_b16 v[104:105], v166 offset:4096
    ds_read_b64_tr_b16 v[106:107], v166 offset:4608
    ds_read_b128 v[112:115], v169
    ds_read_b64_tr_b16 v[40:41], v182 offset:2048
    ds_read_b64_tr_b16 v[42:43], v182 offset:2304
    ds_read_b64_tr_b16 v[108:109], v166 offset:6144
    ds_read_b64_tr_b16 v[110:111], v166 offset:6656
    ds_read_b128 v[116:119], v170
    ds_read_b64_tr_b16 v[44:45], v182 offset:3072
    ds_read_b64_tr_b16 v[46:47], v182 offset:3328
    s_waitcnt lgkmcnt(10)
    v_mfma_f32_32x32x16_bf16 v[120:135], v[88:91], v[96:99], v[120:135]
    s_add_u32 m0, s20, 28672
    s_nop 0
    buffer_load_dwordx4 v152, s[96:99], s16 offen lds
    v_mfma_f32_32x32x16_bf16 v[72:87], v[32:35], v[96:99], v[72:87]
    s_add_u32 m0, s20, 29696
    s_nop 0
    buffer_load_dwordx4 v153, s[96:99], s16 offen lds
    v_mfma_f32_32x32x16_bf16 v[120:135], v[92:95], v[100:103], v[120:135]
    v_mfma_f32_32x32x16_bf16 v[72:87], v[36:39], v[100:103], v[72:87]
    s_add_u32 m0, s20, 30720
    s_nop 0
    buffer_load_dwordx4 v154, s[96:99], s16 offen lds
    s_waitcnt lgkmcnt(0)
    v_mfma_f32_32x32x16_bf16 v[120:135], v[104:107], v[112:115], v[120:135]
    s_add_u32 m0, s20, 31744
    s_nop 0
    buffer_load_dwordx4 v155, s[96:99], s16 offen lds
    v_mfma_f32_32x32x16_bf16 v[72:87], v[40:43], v[112:115], v[72:87]
    s_add_u32 s16, s16, s17
    s_waitcnt vmcnt(8)
    s_barrier
    ds_read_b64_tr_b16 v[88:89], v171 offset:0
    ds_read_b64_tr_b16 v[90:91], v171 offset:512
    ds_read_b128 v[96:99], v172
    ds_read_b64_tr_b16 v[32:33], v182 offset:28672
    ds_read_b64_tr_b16 v[34:35], v182 offset:28928
    ds_read_b64_tr_b16 v[92:93], v171 offset:2048
    ds_read_b64_tr_b16 v[94:95], v171 offset:2560
    ds_read_b128 v[100:103], v173
    ds_read_b64_tr_b16 v[36:37], v182 offset:29696
    ds_read_b64_tr_b16 v[38:39], v182 offset:29952
    v_mfma_f32_32x32x16_bf16 v[120:135], v[108:111], v[116:119], v[120:135]
    v_mfma_f32_32x32x16_bf16 v[72:87], v[44:47], v[116:119], v[72:87]
    ds_read_b64_tr_b16 v[104:105], v171 offset:4096
    ds_read_b64_tr_b16 v[106:107], v171 offset:4608
    ds_read_b128 v[112:115], v174
    ds_read_b64_tr_b16 v[40:41], v182 offset:30720
    ds_read_b64_tr_b16 v[42:43], v182 offset:30976
    ds_read_b64_tr_b16 v[108:109], v171 offset:6144
    ds_read_b64_tr_b16 v[110:111], v171 offset:6656
    ds_read_b128 v[116:119], v175
    ds_read_b64_tr_b16 v[44:45], v182 offset:31744
    ds_read_b64_tr_b16 v[46:47], v182 offset:32000
    s_waitcnt lgkmcnt(10)
    v_mfma_f32_32x32x16_bf16 v[120:135], v[88:91], v[96:99], v[120:135]
    s_add_u32 m0, s20, 57344
    s_nop 0
    buffer_load_dwordx4 v152, s[96:99], s16 offen lds
    v_mfma_f32_32x32x16_bf16 v[72:87], v[32:35], v[96:99], v[72:87]
    s_add_u32 m0, s20, 58368
    s_nop 0
    buffer_load_dwordx4 v153, s[96:99], s16 offen lds
    v_mfma_f32_32x32x16_bf16 v[120:135], v[92:95], v[100:103], v[120:135]
    v_mfma_f32_32x32x16_bf16 v[72:87], v[36:39], v[100:103], v[72:87]
    s_add_u32 m0, s20, 59392
    s_nop 0
    buffer_load_dwordx4 v154, s[96:99], s16 offen lds
    s_waitcnt lgkmcnt(0)
    v_mfma_f32_32x32x16_bf16 v[120:135], v[104:107], v[112:115], v[120:135]
    s_add_u32 m0, s20, 60416
    s_nop 0
    buffer_load_dwordx4 v155, s[96:99], s16 offen lds
    v_mfma_f32_32x32x16_bf16 v[72:87], v[40:43], v[112:115], v[72:87]
    s_add_u32 s16, s16, s17
    s_waitcnt vmcnt(8)
    s_barrier
    ds_read_b64_tr_b16 v[88:89], v156 offset:0
    ds_read_b64_tr_b16 v[90:91], v156 offset:512
    ds_read_b128 v[96:99], v157
    ds_read_b64_tr_b16 v[32:33], v181 offset:0
    ds_read_b64_tr_b16 v[34:35], v181 offset:256
    ds_read_b64_tr_b16 v[92:93], v156 offset:2048
    ds_read_b64_tr_b16 v[94:95], v156 offset:2560
    ds_read_b128 v[100:103], v158
    ds_read_b64_tr_b16 v[36:37], v181 offset:1024
    ds_read_b64_tr_b16 v[38:39], v181 offset:1280
    v_mfma_f32_32x32x16_bf16 v[120:135], v[108:111], v[116:119], v[120:135]
    v_mfma_f32_32x32x16_bf16 v[72:87], v[44:47], v[116:119], v[72:87]
    ds_read_b64_tr_b16 v[104:105], v156 offset:4096
    ds_read_b64_tr_b16 v[106:107], v156 offset:4608
    ds_read_b128 v[112:115], v159
    ds_read_b64_tr_b16 v[40:41], v181 offset:2048
    ds_read_b64_tr_b16 v[42:43], v181 offset:2304
    ds_read_b64_tr_b16 v[108:109], v156 offset:6144
    ds_read_b64_tr_b16 v[110:111], v156 offset:6656
    ds_read_b128 v[116:119], v160
    ds_read_b64_tr_b16 v[44:45], v181 offset:3072
    ds_read_b64_tr_b16 v[46:47], v181 offset:3328
    s_waitcnt lgkmcnt(10)
    v_mfma_f32_32x32x16_bf16 v[120:135], v[88:91], v[96:99], v[120:135]
    s_add_u32 m0, s20, 86016
    s_nop 0
    buffer_load_dwordx4 v152, s[96:99], s16 offen lds
    v_mfma_f32_32x32x16_bf16 v[72:87], v[32:35], v[96:99], v[72:87]
    s_add_u32 m0, s20, 87040
    s_nop 0
    buffer_load_dwordx4 v153, s[96:99], s16 offen lds
    v_mfma_f32_32x32x16_bf16 v[120:135], v[92:95], v[100:103], v[120:135]
    v_mfma_f32_32x32x16_bf16 v[72:87], v[36:39], v[100:103], v[72:87]
    s_add_u32 m0, s20, 88064
    s_nop 0
    buffer_load_dwordx4 v154, s[96:99], s16 offen lds
    s_waitcnt lgkmcnt(0)
    v_mfma_f32_32x32x16_bf16 v[120:135], v[104:107], v[112:115], v[120:135]
    s_add_u32 m0, s20, 89088
    s_nop 0
    buffer_load_dwordx4 v155, s[96:99], s16 offen lds
    v_mfma_f32_32x32x16_bf16 v[72:87], v[40:43], v[112:115], v[72:87]
    s_add_u32 s16, s16, s17
    s_waitcnt vmcnt(8)
    s_barrier
    ds_read_b64_tr_b16 v[88:89], v161 offset:0
    ds_read_b64_tr_b16 v[90:91], v161 offset:512
    ds_read_b128 v[96:99], v162
    ds_read_b64_tr_b16 v[32:33], v181 offset:28672
    ds_read_b64_tr_b16 v[34:35], v181 offset:28928
    ds_read_b64_tr_b16 v[92:93], v161 offset:2048
    ds_read_b64_tr_b16 v[94:95], v161 offset:2560
    ds_read_b128 v[100:103], v163
    ds_read_b64_tr_b16 v[36:37], v181 offset:29696
    ds_read_b64_tr_b16 v[38:39], v181 offset:29952
    v_mfma_f32_32x32x16_bf16 v[120:135], v[108:111], v[116:119], v[120:135]
    v_mfma_f32_32x32x16_bf16 v[72:87], v[44:47], v[116:119], v[72:87]
    ds_read_b64_tr_b16 v[104:105], v161 offset:4096
    ds_read_b64_tr_b16 v[106:107], v161 offset:4608
    ds_read_b128 v[112:115], v164
    ds_read_b64_tr_b16 v[40:41], v181 offset:30720
    ds_read_b64_tr_b16 v[42:43], v181 offset:30976
    ds_read_b64_tr_b16 v[108:109], v161 offset:6144
    ds_read_b64_tr_b16 v[110:111], v161 offset:6656
    ds_read_b128 v[116:119], v165
    ds_read_b64_tr_b16 v[44:45], v181 offset:31744
    ds_read_b64_tr_b16 v[46:47], v181 offset:32000
    s_waitcnt lgkmcnt(10)
    v_mfma_f32_32x32x16_bf16 v[120:135], v[88:91], v[96:99], v[120:135]
    s_add_u32 m0, s20, 0
    s_nop 0
    buffer_load_dwordx4 v152, s[96:99], s16 offen lds
    v_mfma_f32_32x32x16_bf16 v[72:87], v[32:35], v[96:99], v[72:87]
    s_add_u32 m0, s20, 1024
    s_nop 0
    buffer_load_dwordx4 v153, s[96:99], s16 offen lds
    v_mfma_f32_32x32x16_bf16 v[120:135], v[92:95], v[100:103], v[120:135]
    v_mfma_f32_32x32x16_bf16 v[72:87], v[36:39], v[100:103], v[72:87]
    s_add_u32 m0, s20, 2048
    s_nop 0
    buffer_load_dwordx4 v154, s[96:99], s16 offen lds
    s_waitcnt lgkmcnt(0)
    v_mfma_f32_32x32x16_bf16 v[120:135], v[104:107], v[112:115], v[120:135]
    s_add_u32 m0, s20, 3072
    s_nop 0
    buffer_load_dwordx4 v155, s[96:99], s16 offen lds
    v_mfma_f32_32x32x16_bf16 v[72:87], v[40:43], v[112:115], v[72:87]
    s_add_u32 s16, s16, s17
    s_waitcnt vmcnt(8)
    s_barrier
    ds_read_b64_tr_b16 v[88:89], v166 offset:0
    ds_read_b64_tr_b16 v[90:91], v166 offset:512
    ds_read_b128 v[96:99], v167
    ds_read_b64_tr_b16 v[32:33], v182 offset:0
    ds_read_b64_tr_b16 v[34:35], v182 offset:256
    ds_read_b64_tr_b16 v[92:93], v166 offset:2048
    ds_read_b64_tr_b16 v[94:95], v166 offset:2560
    ds_read_b128 v[100:103], v168
    ds_read_b64_tr_b16 v[36:37], v182 offset:1024
    ds_read_b64_tr_b16 v[38:39], v182 offset:1280
    v_mfma_f32_32x32x16_bf16 v[120:135], v[108:111], v[116:119], v[120:135]
    v_mfma_f32_32x32x16_bf16 v[72:87], v[44:47], v[116:119], v[72:87]
    ds_read_b64_tr_b16 v[104:105], v166 offset:4096
    ds_read_b64_tr_b16 v[106:107], v166 offset:4608
    ds_read_b128 v[112:115], v169
    ds_read_b64_tr_b16 v[40:41], v182 offset:2048
    ds_read_b64_tr_b16 v[42:43], v182 offset:2304
    ds_read_b64_tr_b16 v[108:109], v166 offset:6144
    ds_read_b64_tr_b16 v[110:111], v166 offset:6656
    ds_read_b128 v[116:119], v170
    ds_read_b64_tr_b16 v[44:45], v182 offset:3072
    ds_read_b64_tr_b16 v[46:47], v182 offset:3328
    s_waitcnt lgkmcnt(10)
    v_mfma_f32_32x32x16_bf16 v[120:135], v[88:91], v[96:99], v[120:135]
    s_add_u32 m0, s20, 28672
    s_nop 0
    buffer_load_dwordx4 v152, s[96:99], s16 offen lds
    v_mfma_f32_32x32x16_bf16 v[72:87], v[32:35], v[96:99], v[72:87]
    s_add_u32 m0, s20, 29696
    s_nop 0
    buffer_load_dwordx4 v153, s[96:99], s16 offen lds
    v_mfma_f32_32x32x16_bf16 v[120:135], v[92:95], v[100:103], v[120:135]
    v_mfma_f32_32x32x16_bf16 v[72:87], v[36:39], v[100:103], v[72:87]
    s_add_u32 m0, s20, 30720
    s_nop 0
    buffer_load_dwordx4 v154, s[96:99], s16 offen lds
    s_waitcnt lgkmcnt(0)
    v_mfma_f32_32x32x16_bf16 v[120:135], v[104:107], v[112:115], v[120:135]
    s_add_u32 m0, s20, 31744
    s_nop 0
    buffer_load_dwordx4 v155, s[96:99], s16 offen lds
    v_mfma_f32_32x32x16_bf16 v[72:87], v[40:43], v[112:115], v[72:87]
    s_add_u32 s16, s16, s17
    s_waitcnt vmcnt(8)
    s_barrier
    ds_read_b64_tr_b16 v[88:89], v171 offset:0
    ds_read_b64_tr_b16 v[90:91], v171 offset:512
    ds_read_b128 v[96:99], v172
    ds_read_b64_tr_b16 v[32:33], v182 offset:28672
    ds_read_b64_tr_b16 v[34:35], v182 offset:28928
    ds_read_b64_tr_b16 v[92:93], v171 offset:2048
    ds_read_b64_tr_b16 v[94:95], v171 offset:2560
    ds_read_b128 v[100:103], v173
    ds_read_b64_tr_b16 v[36:37], v182 offset:29696
    ds_read_b64_tr_b16 v[38:39], v182 offset:29952
    v_mfma_f32_32x32x16_bf16 v[120:135], v[108:111], v[116:119], v[120:135]
    v_mfma_f32_32x32x16_bf16 v[72:87], v[44:47], v[116:119], v[72:87]
    ds_read_b64_tr_b16 v[104:105], v171 offset:4096
    ds_read_b64_tr_b16 v[106:107], v171 offset:4608
    ds_read_b128 v[112:115], v174
    ds_read_b64_tr_b16 v[40:41], v182 offset:30720
    ds_read_b64_tr_b16 v[42:43], v182 offset:30976
    ds_read_b64_tr_b16 v[108:109], v171 offset:6144
    ds_read_b64_tr_b16 v[110:111], v171 offset:6656
    ds_read_b128 v[116:119], v175
    ds_read_b64_tr_b16 v[44:45], v182 offset:31744
    ds_read_b64_tr_b16 v[46:47], v182 offset:32000
    s_waitcnt lgkmcnt(10)
    v_mfma_f32_32x32x16_bf16 v[120:135], v[88:91], v[96:99], v[120:135]
    s_add_u32 m0, s20, 57344
    s_nop 0
    buffer_load_dwordx4 v152, s[96:99], s16 offen lds
    v_mfma_f32_32x32x16_bf16 v[72:87], v[32:35], v[96:99], v[72:87]
    s_add_u32 m0, s20, 58368
    s_nop 0
    buffer_load_dwordx4 v153, s[96:99], s16 offen lds
    v_mfma_f32_32x32x16_bf16 v[120:135], v[92:95], v[100:103], v[120:135]
    v_mfma_f32_32x32x16_bf16 v[72:87], v[36:39], v[100:103], v[72:87]
    s_add_u32 m0, s20, 59392
    s_nop 0
    buffer_load_dwordx4 v154, s[96:99], s16 offen lds
    s_waitcnt lgkmcnt(0)
    v_mfma_f32_32x32x16_bf16 v[120:135], v[104:107], v[112:115], v[120:135]
    s_add_u32 m0, s20, 60416
    s_nop 0
    buffer_load_dwordx4 v155, s[96:99], s16 offen lds
    v_mfma_f32_32x32x16_bf16 v[72:87], v[40:43], v[112:115], v[72:87]
    s_add_u32 s16, s16, s17
    s_waitcnt vmcnt(8)
    s_barrier
    ds_read_b64_tr_b16 v[88:89], v156 offset:0
    ds_read_b64_tr_b16 v[90:91], v156 offset:512
    ds_read_b128 v[96:99], v157
    ds_read_b64_tr_b16 v[32:33], v181 offset:0
    ds_read_b64_tr_b16 v[34:35], v181 offset:256
    ds_read_b64_tr_b16 v[92:93], v156 offset:2048
    ds_read_b64_tr_b16 v[94:95], v156 offset:2560
    ds_read_b128 v[100:103], v158
    ds_read_b64_tr_b16 v[36:37], v181 offset:1024
    ds_read_b64_tr_b16 v[38:39], v181 offset:1280
    v_mfma_f32_32x32x16_bf16 v[120:135], v[108:111], v[116:119], v[120:135]
    v_mfma_f32_32x32x16_bf16 v[72:87], v[44:47], v[116:119], v[72:87]
    ds_read_b64_tr_b16 v[104:105], v156 offset:4096
    ds_read_b64_tr_b16 v[106:107], v156 offset:4608
    ds_read_b128 v[112:115], v159
    ds_read_b64_tr_b16 v[40:41], v181 offset:2048
    ds_read_b64_tr_b16 v[42:43], v181 offset:2304
    ds_read_b64_tr_b16 v[108:109], v156 offset:6144
    ds_read_b64_tr_b16 v[110:111], v156 offset:6656
    ds_read_b128 v[116:119], v160
    ds_read_b64_tr_b16 v[44:45], v181 offset:3072
    ds_read_b64_tr_b16 v[46:47], v181 offset:3328
    s_waitcnt lgkmcnt(10)
    v_mfma_f32_32x32x16_bf16 v[120:135], v[88:91], v[96:99], v[120:135]
    s_add_u32 m0, s20, 86016
    s_nop 0
    buffer_load_dwordx4 v152, s[96:99], s16 offen lds
    v_mfma_f32_32x32x16_bf16 v[72:87], v[32:35], v[96:99], v[72:87]
    s_add_u32 m0, s20, 87040
    s_nop 0
    buffer_load_dwordx4 v153, s[96:99], s16 offen lds
    v_mfma_f32_32x32x16_bf16 v[120:135], v[92:95], v[100:103], v[120:135]
    v_mfma_f32_32x32x16_bf16 v[72:87], v[36:39], v[100:103], v[72:87]
    s_add_u32 m0, s20, 88064
    s_nop 0
    buffer_load_dwordx4 v154, s[96:99], s16 offen lds
    s_waitcnt lgkmcnt(0)
    v_mfma_f32_32x32x16_bf16 v[120:135], v[104:107], v[112:115], v[120:135]
    s_add_u32 m0, s20, 89088
    s_nop 0
    buffer_load_dwordx4 v155, s[96:99], s16 offen lds
    v_mfma_f32_32x32x16_bf16 v[72:87], v[40:43], v[112:115], v[72:87]
    s_add_u32 s16, s16, s17
    s_waitcnt vmcnt(8)
    s_barrier
    ds_read_b64_tr_b16 v[88:89], v161 offset:0
    ds_read_b64_tr_b16 v[90:91], v161 offset:512
    ds_read_b128 v[96:99], v162
    ds_read_b64_tr_b16 v[32:33], v181 offset:28672
    ds_read_b64_tr_b16 v[34:35], v181 offset:28928
    ds_read_b64_tr_b16 v[92:93], v161 offset:2048
    ds_read_b64_tr_b16 v[94:95], v161 offset:2560
    ds_read_b128 v[100:103], v163
    ds_read_b64_tr_b16 v[36:37], v181 offset:29696
    ds_read_b64_tr_b16 v[38:39], v181 offset:29952
    v_mfma_f32_32x32x16_bf16 v[120:135], v[108:111], v[116:119], v[120:135]
    v_mfma_f32_32x32x16_bf16 v[72:87], v[44:47], v[116:119], v[72:87]
    ds_read_b64_tr_b16 v[104:105], v161 offset:4096
    ds_read_b64_tr_b16 v[106:107], v161 offset:4608
    ds_read_b128 v[112:115], v164
    ds_read_b64_tr_b16 v[40:41], v181 offset:30720
    ds_read_b64_tr_b16 v[42:43], v181 offset:30976
    ds_read_b64_tr_b16 v[108:109], v161 offset:6144
    ds_read_b64_tr_b16 v[110:111], v161 offset:6656
    ds_read_b128 v[116:119], v165
    ds_read_b64_tr_b16 v[44:45], v181 offset:31744
    ds_read_b64_tr_b16 v[46:47], v181 offset:32000
    s_waitcnt lgkmcnt(10)
    v_mfma_f32_32x32x16_bf16 v[120:135], v[88:91], v[96:99], v[120:135]
    s_add_u32 m0, s20, 0
    s_nop 0
    buffer_load_dwordx4 v152, s[96:99], s16 offen lds
    v_mfma_f32_32x32x16_bf16 v[72:87], v[32:35], v[96:99], v[72:87]
    s_add_u32 m0, s20, 1024
    s_nop 0
    buffer_load_dwordx4 v153, s[96:99], s16 offen lds
    v_mfma_f32_32x32x16_bf16 v[120:135], v[92:95], v[100:103], v[120:135]
    v_mfma_f32_32x32x16_bf16 v[72:87], v[36:39], v[100:103], v[72:87]
    s_add_u32 m0, s20, 2048
    s_nop 0
    buffer_load_dwordx4 v154, s[96:99], s16 offen lds
    s_waitcnt lgkmcnt(0)
    v_mfma_f32_32x32x16_bf16 v[120:135], v[104:107], v[112:115], v[120:135]
    s_add_u32 m0, s20, 3072
    s_nop 0
    buffer_load_dwordx4 v155, s[96:99], s16 offen lds
    v_mfma_f32_32x32x16_bf16 v[72:87], v[40:43], v[112:115], v[72:87]
    s_add_u32 s16, s16, s17
    s_waitcnt vmcnt(8)
    s_barrier
    ds_read_b64_tr_b16 v[88:89], v166 offset:0
    ds_read_b64_tr_b16 v[90:91], v166 offset:512
    ds_read_b128 v[96:99], v167
    ds_read_b64_tr_b16 v[32:33], v182 offset:0
    ds_read_b64_tr_b16 v[34:35], v182 offset:256
    ds_read_b64_tr_b16 v[92:93], v166 offset:2048
    ds_read_b64_tr_b16 v[94:95], v166 offset:2560
    ds_read_b128 v[100:103], v168
    ds_read_b64_tr_b16 v[36:37], v182 offset:1024
    ds_read_b64_tr_b16 v[38:39], v182 offset:1280
    v_mfma_f32_32x32x16_bf16 v[120:135], v[108:111], v[116:119], v[120:135]
    v_mfma_f32_32x32x16_bf16 v[72:87], v[44:47], v[116:119], v[72:87]
    ds_read_b64_tr_b16 v[104:105], v166 offset:4096
    ds_read_b64_tr_b16 v[106:107], v166 offset:4608
    ds_read_b128 v[112:115], v169
    ds_read_b64_tr_b16 v[40:41], v182 offset:2048
    ds_read_b64_tr_b16 v[42:43], v182 offset:2304
    ds_read_b64_tr_b16 v[108:109], v166 offset:6144
    ds_read_b64_tr_b16 v[110:111], v166 offset:6656
    ds_read_b128 v[116:119], v170
    ds_read_b64_tr_b16 v[44:45], v182 offset:3072
    ds_read_b64_tr_b16 v[46:47], v182 offset:3328
    s_waitcnt lgkmcnt(10)
    v_mfma_f32_32x32x16_bf16 v[120:135], v[88:91], v[96:99], v[120:135]
    s_add_u32 m0, s20, 28672
    s_nop 0
    buffer_load_dwordx4 v152, s[96:99], s16 offen lds
    v_mfma_f32_32x32x16_bf16 v[72:87], v[32:35], v[96:99], v[72:87]
    s_add_u32 m0, s20, 29696
    s_nop 0
    buffer_load_dwordx4 v153, s[96:99], s16 offen lds
    v_mfma_f32_32x32x16_bf16 v[120:135], v[92:95], v[100:103], v[120:135]
    v_mfma_f32_32x32x16_bf16 v[72:87], v[36:39], v[100:103], v[72:87]
    s_add_u32 m0, s20, 30720
    s_nop 0
    buffer_load_dwordx4 v154, s[96:99], s16 offen lds
    s_waitcnt lgkmcnt(0)
    v_mfma_f32_32x32x16_bf16 v[120:135], v[104:107], v[112:115], v[120:135]
    s_add_u32 m0, s20, 31744
    s_nop 0
    buffer_load_dwordx4 v155, s[96:99], s16 offen lds
    v_mfma_f32_32x32x16_bf16 v[72:87], v[40:43], v[112:115], v[72:87]
    s_add_u32 s16, s16, s17
    s_waitcnt vmcnt(8)
    s_barrier
    ds_read_b64_tr_b16 v[88:89], v171 offset:0
    ds_read_b64_tr_b16 v[90:91], v171 offset:512
    ds_read_b128 v[96:99], v172
    ds_read_b64_tr_b16 v[32:33], v182 offset:28672
    ds_read_b64_tr_b16 v[34:35], v182 offset:28928
    ds_read_b64_tr_b16 v[92:93], v171 offset:2048
    ds_read_b64_tr_b16 v[94:95], v171 offset:2560
    ds_read_b128 v[100:103], v173
    ds_read_b64_tr_b16 v[36:37], v182 offset:29696
    ds_read_b64_tr_b16 v[38:39], v182 offset:29952
    v_mfma_f32_32x32x16_bf16 v[120:135], v[108:111], v[116:119], v[120:135]
    v_mfma_f32_32x32x16_bf16 v[72:87], v[44:47], v[116:119], v[72:87]
    ds_read_b64_tr_b16 v[104:105], v171 offset:4096
    ds_read_b64_tr_b16 v[106:107], v171 offset:4608
    ds_read_b128 v[112:115], v174
    ds_read_b64_tr_b16 v[40:41], v182 offset:30720
    ds_read_b64_tr_b16 v[42:43], v182 offset:30976
    ds_read_b64_tr_b16 v[108:109], v171 offset:6144
    ds_read_b64_tr_b16 v[110:111], v171 offset:6656
    ds_read_b128 v[116:119], v175
    ds_read_b64_tr_b16 v[44:45], v182 offset:31744
    ds_read_b64_tr_b16 v[46:47], v182 offset:32000
    s_waitcnt lgkmcnt(10)
    v_mfma_f32_32x32x16_bf16 v[120:135], v[88:91], v[96:99], v[120:135]
    s_add_u32 m0, s20, 57344
    s_nop 0
    buffer_load_dwordx4 v152, s[96:99], s16 offen lds
    v_mfma_f32_32x32x16_bf16 v[72:87], v[32:35], v[96:99], v[72:87]
    s_add_u32 m0, s20, 58368
    s_nop 0
    buffer_load_dwordx4 v153, s[96:99], s16 offen lds
    v_mfma_f32_32x32x16_bf16 v[120:135], v[92:95], v[100:103], v[120:135]
    v_mfma_f32_32x32x16_bf16 v[72:87], v[36:39], v[100:103], v[72:87]
    s_add_u32 m0, s20, 59392
    s_nop 0
    buffer_load_dwordx4 v154, s[96:99], s16 offen lds
    s_waitcnt lgkmcnt(0)
    v_mfma_f32_32x32x16_bf16 v[120:135], v[104:107], v[112:115], v[120:135]
    s_add_u32 m0, s20, 60416
    s_nop 0
    buffer_load_dwordx4 v155, s[96:99], s16 offen lds
    v_mfma_f32_32x32x16_bf16 v[72:87], v[40:43], v[112:115], v[72:87]
    s_add_u32 s16, s16, s17
    s_waitcnt vmcnt(8)
    s_barrier
    ds_read_b64_tr_b16 v[88:89], v156 offset:0
    ds_read_b64_tr_b16 v[90:91], v156 offset:512
    ds_read_b128 v[96:99], v157
    ds_read_b64_tr_b16 v[32:33], v181 offset:0
    ds_read_b64_tr_b16 v[34:35], v181 offset:256
    ds_read_b64_tr_b16 v[92:93], v156 offset:2048
    ds_read_b64_tr_b16 v[94:95], v156 offset:2560
    ds_read_b128 v[100:103], v158
    ds_read_b64_tr_b16 v[36:37], v181 offset:1024
    ds_read_b64_tr_b16 v[38:39], v181 offset:1280
    v_mfma_f32_32x32x16_bf16 v[120:135], v[108:111], v[116:119], v[120:135]
    v_mfma_f32_32x32x16_bf16 v[72:87], v[44:47], v[116:119], v[72:87]
    ds_read_b64_tr_b16 v[104:105], v156 offset:4096
    ds_read_b64_tr_b16 v[106:107], v156 offset:4608
    ds_read_b128 v[112:115], v159
    ds_read_b64_tr_b16 v[40:41], v181 offset:2048
    ds_read_b64_tr_b16 v[42:43], v181 offset:2304
    ds_read_b64_tr_b16 v[108:109], v156 offset:6144
    ds_read_b64_tr_b16 v[110:111], v156 offset:6656
    ds_read_b128 v[116:119], v160
    ds_read_b64_tr_b16 v[44:45], v181 offset:3072
    ds_read_b64_tr_b16 v[46:47], v181 offset:3328
    s_waitcnt lgkmcnt(10)
    v_mfma_f32_32x32x16_bf16 v[120:135], v[88:91], v[96:99], v[120:135]
    s_add_u32 m0, s20, 86016
    s_nop 0
    buffer_load_dwordx4 v152, s[96:99], s16 offen lds
    v_mfma_f32_32x32x16_bf16 v[72:87], v[32:35], v[96:99], v[72:87]
    s_add_u32 m0, s20, 87040
    s_nop 0
    buffer_load_dwordx4 v153, s[96:99], s16 offen lds
    v_mfma_f32_32x32x16_bf16 v[120:135], v[92:95], v[100:103], v[120:135]
    v_mfma_f32_32x32x16_bf16 v[72:87], v[36:39], v[100:103], v[72:87]
    s_add_u32 m0, s20, 88064
    s_nop 0
    buffer_load_dwordx4 v154, s[96:99], s16 offen lds
    s_waitcnt lgkmcnt(0)
    v_mfma_f32_32x32x16_bf16 v[120:135], v[104:107], v[112:115], v[120:135]
    s_add_u32 m0, s20, 89088
    s_nop 0
    buffer_load_dwordx4 v155, s[96:99], s16 offen lds
    v_mfma_f32_32x32x16_bf16 v[72:87], v[40:43], v[112:115], v[72:87]
    s_add_u32 s16, s16, s17
    s_waitcnt vmcnt(8)
    s_barrier
    ds_read_b64_tr_b16 v[88:89], v161 offset:0
    ds_read_b64_tr_b16 v[90:91], v161 offset:512
    ds_read_b128 v[96:99], v162
    ds_read_b64_tr_b16 v[32:33], v181 offset:28672
    ds_read_b64_tr_b16 v[34:35], v181 offset:28928
    ds_read_b64_tr_b16 v[92:93], v161 offset:2048
    ds_read_b64_tr_b16 v[94:95], v161 offset:2560
    ds_read_b128 v[100:103], v163
    ds_read_b64_tr_b16 v[36:37], v181 offset:29696
    ds_read_b64_tr_b16 v[38:39], v181 offset:29952
    v_mfma_f32_32x32x16_bf16 v[120:135], v[108:111], v[116:119], v[120:135]
    v_mfma_f32_32x32x16_bf16 v[72:87], v[44:47], v[116:119], v[72:87]
    ds_read_b64_tr_b16 v[104:105], v161 offset:4096
    ds_read_b64_tr_b16 v[106:107], v161 offset:4608
    ds_read_b128 v[112:115], v164
    ds_read_b64_tr_b16 v[40:41], v181 offset:30720
    ds_read_b64_tr_b16 v[42:43], v181 offset:30976
    ds_read_b64_tr_b16 v[108:109], v161 offset:6144
    ds_read_b64_tr_b16 v[110:111], v161 offset:6656
    ds_read_b128 v[116:119], v165
    ds_read_b64_tr_b16 v[44:45], v181 offset:31744
    ds_read_b64_tr_b16 v[46:47], v181 offset:32000
    s_waitcnt lgkmcnt(10)
    v_mfma_f32_32x32x16_bf16 v[120:135], v[88:91], v[96:99], v[120:135]
    v_mfma_f32_32x32x16_bf16 v[72:87], v[32:35], v[96:99], v[72:87]
    v_mfma_f32_32x32x16_bf16 v[120:135], v[92:95], v[100:103], v[120:135]
    v_mfma_f32_32x32x16_bf16 v[72:87], v[36:39], v[100:103], v[72:87]
    s_waitcnt lgkmcnt(0)
    v_mfma_f32_32x32x16_bf16 v[120:135], v[104:107], v[112:115], v[120:135]
    v_mfma_f32_32x32x16_bf16 v[72:87], v[40:43], v[112:115], v[72:87]
    s_waitcnt vmcnt(4)
    s_barrier
    ds_read_b64_tr_b16 v[88:89], v166 offset:0
    ds_read_b64_tr_b16 v[90:91], v166 offset:512
    ds_read_b128 v[96:99], v167
    ds_read_b64_tr_b16 v[32:33], v182 offset:0
    ds_read_b64_tr_b16 v[34:35], v182 offset:256
    ds_read_b64_tr_b16 v[92:93], v166 offset:2048
    ds_read_b64_tr_b16 v[94:95], v166 offset:2560
    ds_read_b128 v[100:103], v168
    ds_read_b64_tr_b16 v[36:37], v182 offset:1024
    ds_read_b64_tr_b16 v[38:39], v182 offset:1280
    v_mfma_f32_32x32x16_bf16 v[120:135], v[108:111], v[116:119], v[120:135]
    v_mfma_f32_32x32x16_bf16 v[72:87], v[44:47], v[116:119], v[72:87]
    ds_read_b64_tr_b16 v[104:105], v166 offset:4096
    ds_read_b64_tr_b16 v[106:107], v166 offset:4608
    ds_read_b128 v[112:115], v169
    ds_read_b64_tr_b16 v[40:41], v182 offset:2048
    ds_read_b64_tr_b16 v[42:43], v182 offset:2304
    ds_read_b64_tr_b16 v[108:109], v166 offset:6144
    ds_read_b64_tr_b16 v[110:111], v166 offset:6656
    ds_read_b128 v[116:119], v170
    ds_read_b64_tr_b16 v[44:45], v182 offset:3072
    ds_read_b64_tr_b16 v[46:47], v182 offset:3328
    s_waitcnt lgkmcnt(10)
    v_mfma_f32_32x32x16_bf16 v[120:135], v[88:91], v[96:99], v[120:135]
    v_mfma_f32_32x32x16_bf16 v[72:87], v[32:35], v[96:99], v[72:87]
    v_mfma_f32_32x32x16_bf16 v[120:135], v[92:95], v[100:103], v[120:135]
    v_mfma_f32_32x32x16_bf16 v[72:87], v[36:39], v[100:103], v[72:87]
    s_waitcnt lgkmcnt(0)
    v_mfma_f32_32x32x16_bf16 v[120:135], v[104:107], v[112:115], v[120:135]
    v_mfma_f32_32x32x16_bf16 v[72:87], v[40:43], v[112:115], v[72:87]
    s_waitcnt vmcnt(0)
    s_barrier
    ds_read_b64_tr_b16 v[88:89], v171 offset:0
    ds_read_b64_tr_b16 v[90:91], v171 offset:512
    ds_read_b128 v[96:99], v172
    ds_read_b64_tr_b16 v[32:33], v182 offset:28672
    ds_read_b64_tr_b16 v[34:35], v182 offset:28928
    ds_read_b64_tr_b16 v[92:93], v171 offset:2048
    ds_read_b64_tr_b16 v[94:95], v171 offset:2560
    ds_read_b128 v[100:103], v173
    ds_read_b64_tr_b16 v[36:37], v182 offset:29696
    ds_read_b64_tr_b16 v[38:39], v182 offset:29952
    v_mfma_f32_32x32x16_bf16 v[120:135], v[108:111], v[116:119], v[120:135]
    v_mfma_f32_32x32x16_bf16 v[72:87], v[44:47], v[116:119], v[72:87]
    v_lshlrev_b32 v6, 5, v2
    s_lshr_b32 s31, s2, 6
    s_lshl_b32 s31, s31, 5
    s_and_b32 s23, s2, 31
    s_add_u32 s31, s31, s23
    s_bitcmp0_b32 s2, 5
    s_cbranch_scc1 L_sj_emvPK
    s_lshl_b32 s64, s31, 3
    s_add_u32 s64, s64, s22
    s_sub_u32 s31, 2048, s64
    s_lshl_b32 s23, s64, 11
    s_lshl_b32 s31, s31, 11
    s_mov_b32 s19, 1048576
    buffer_load_dwordx4 v[200:203], v6, s[80:83], s23 offen
    buffer_load_dwordx4 v[204:207], v6, s[80:83], s23 offen offset:16
    buffer_load_dwordx4 v[208:211], v6, s[80:83], s31 offen
    buffer_load_dwordx4 v[212:215], v6, s[80:83], s31 offen offset:16
    buffer_load_dwordx4 v[216:219], v6, s[84:87], s19 offen
    buffer_load_dwordx4 v[220:223], v6, s[84:87], s19 offen offset:16
    s_branch L_sj_1PK
L_sj_emvPK:
    s_lshl_b32 s64, s31, 2
    s_add_u32 s64, s64, s22
    s_cmp_ge_u32 s22, 4
    s_cselect_b32 s64, 0x10000, s64
    s_lshl_b32 s31, s31, 3
    s_add_u32 s31, s31, s22
    s_cmp_eq_u32 s31, 4
    s_cselect_b32 s64, 512, s64
    s_lshl_b32 s23, s64, 11
    s_mov_b32 s19, 2097152
    buffer_load_dwordx4 v[200:203], v6, s[84:87], s23 offen
    buffer_load_dwordx4 v[204:207], v6, s[84:87], s23 offen offset:16
    buffer_load_dwordx4 v[216:219], v6, s[80:83], s19 offen
    buffer_load_dwordx4 v[220:223], v6, s[80:83], s19 offen offset:16
L_sj_1PK:
    ds_read_b64_tr_b16 v[104:105], v171 offset:4096
    ds_read_b64_tr_b16 v[106:107], v171 offset:4608
    ds_read_b128 v[112:115], v174
    ds_read_b64_tr_b16 v[40:41], v182 offset:30720
    ds_read_b64_tr_b16 v[42:43], v182 offset:30976
    ds_read_b64_tr_b16 v[108:109], v171 offset:6144
    ds_read_b64_tr_b16 v[110:111], v171 offset:6656
    ds_read_b128 v[116:119], v175
    ds_read_b64_tr_b16 v[44:45], v182 offset:31744
    ds_read_b64_tr_b16 v[46:47], v182 offset:32000
    s_waitcnt lgkmcnt(10)
    v_mfma_f32_32x32x16_bf16 v[120:135], v[88:91], v[96:99], v[120:135]
    v_mfma_f32_32x32x16_bf16 v[72:87], v[32:35], v[96:99], v[72:87]
    v_mfma_f32_32x32x16_bf16 v[120:135], v[92:95], v[100:103], v[120:135]
    v_mfma_f32_32x32x16_bf16 v[72:87], v[36:39], v[100:103], v[72:87]
    s_waitcnt lgkmcnt(0)
    v_mfma_f32_32x32x16_bf16 v[120:135], v[104:107], v[112:115], v[120:135]
    v_mfma_f32_32x32x16_bf16 v[72:87], v[40:43], v[112:115], v[72:87]
    v_mfma_f32_32x32x16_bf16 v[120:135], v[108:111], v[116:119], v[120:135]
    v_mfma_f32_32x32x16_bf16 v[72:87], v[44:47], v[116:119], v[72:87]
    s_mov_b32 s23, 1048744942
    s_nop 11
    v_cvt_pk_bf16_f32 v88, v72, v73
    v_cvt_pk_bf16_f32 v89, v74, v75
    v_cvt_pk_bf16_f32 v90, v76, v77
    v_cvt_pk_bf16_f32 v91, v78, v79
    v_cvt_pk_bf16_f32 v92, v80, v81
    v_cvt_pk_bf16_f32 v93, v82, v83
    v_cvt_pk_bf16_f32 v94, v84, v85
    v_cvt_pk_bf16_f32 v95, v86, v87
    v_add_u32 v3, s24, v9
    buffer_store_dwordx4 v[88:91], v3, s[12:15], 0 offen offset:0
    buffer_store_dwordx4 v[92:95], v3, s[12:15], 0 offen offset:1024
    v_mul_f32 v120, s23, v120
    v_mul_f32 v121, s23, v121
    v_mul_f32 v122, s23, v122
    v_mul_f32 v123, s23, v123
    v_mul_f32 v124, s23, v124
    v_mul_f32 v125, s23, v125
    v_mul_f32 v126, s23, v126
    v_mul_f32 v127, s23, v127
    v_mul_f32 v128, s23, v128
    v_mul_f32 v129, s23, v129
    v_mul_f32 v130, s23, v130
    v_mul_f32 v131, s23, v131
    v_mul_f32 v132, s23, v132
    v_mul_f32 v133, s23, v133
    v_mul_f32 v134, s23, v134
    v_mul_f32 v135, s23, v135
    v_cvt_pk_bf16_f32 v16, v120, v121
    v_cvt_pk_bf16_f32 v17, v122, v123
    v_cvt_pk_bf16_f32 v18, v124, v125
    v_cvt_pk_bf16_f32 v19, v126, v127
    v_cvt_pk_bf16_f32 v20, v128, v129
    v_cvt_pk_bf16_f32 v21, v130, v131
    v_cvt_pk_bf16_f32 v22, v132, v133
    v_cvt_pk_bf16_f32 v23, v134, v135
    buffer_store_dwordx4 v[16:19], v9, s[12:15], s26 offen
    buffer_store_dwordx4 v[20:23], v9, s[12:15], s26 offen offset:1024
    s_waitcnt vmcnt(4)
    v_lshlrev_b32 v6, 5, v2
    v_mov_b32 v7, 0
    s_bitcmp0_b32 s2, 5
    s_cbranch_scc1 L_sj_emv2PK
    v_lshlrev_b32 v240, 16, v200
    v_and_b32 v241, 0xffff0000, v200
    v_lshlrev_b32 v242, 16, v208
    v_and_b32 v243, 0xffff0000, v208
    v_add_f32 v244, v240, v242
    v_add_f32 v245, v241, v243
    v_sub_f32 v246, v240, v242
    v_sub_f32 v247, v241, v243
    v_cvt_pk_bf16_f32 v224, v244, v245
    v_cvt_pk_bf16_f32 v232, v246, v247
    v_dot2c_f32_bf16 v7, v224, v216
    v_lshlrev_b32 v240, 16, v201
    v_and_b32 v241, 0xffff0000, v201
    v_lshlrev_b32 v242, 16, v209
    v_and_b32 v243, 0xffff0000, v209
    v_add_f32 v244, v240, v242
    v_add_f32 v245, v241, v243
    v_sub_f32 v246, v240, v242
    v_sub_f32 v247, v241, v243
    v_cvt_pk_bf16_f32 v225, v244, v245
    v_cvt_pk_bf16_f32 v233, v246, v247
    v_dot2c_f32_bf16 v7, v225, v217
    v_lshlrev_b32 v240, 16, v202
    v_and_b32 v241, 0xffff0000, v202
    v_lshlrev_b32 v242, 16, v210
    v_and_b32 v243, 0xffff0000, v210
    v_add_f32 v244, v240, v242
    v_add_f32 v245, v241, v243
    v_sub_f32 v246, v240, v242
    v_sub_f32 v247, v241, v243
    v_cvt_pk_bf16_f32 v226, v244, v245
    v_cvt_pk_bf16_f32 v234, v246, v247
    v_dot2c_f32_bf16 v7, v226, v218
    v_lshlrev_b32 v240, 16, v203
    v_and_b32 v241, 0xffff0000, v203
    v_lshlrev_b32 v242, 16, v211
    v_and_b32 v243, 0xffff0000, v211
    v_add_f32 v244, v240, v242
    v_add_f32 v245, v241, v243
    v_sub_f32 v246, v240, v242
    v_sub_f32 v247, v241, v243
    v_cvt_pk_bf16_f32 v227, v244, v245
    v_cvt_pk_bf16_f32 v235, v246, v247
    v_dot2c_f32_bf16 v7, v227, v219
    v_lshlrev_b32 v240, 16, v204
    v_and_b32 v241, 0xffff0000, v204
    v_lshlrev_b32 v242, 16, v212
    v_and_b32 v243, 0xffff0000, v212
    v_add_f32 v244, v240, v242
    v_add_f32 v245, v241, v243
    v_sub_f32 v246, v240, v242
    v_sub_f32 v247, v241, v243
    v_cvt_pk_bf16_f32 v228, v244, v245
    v_cvt_pk_bf16_f32 v236, v246, v247
    v_dot2c_f32_bf16 v7, v228, v220
    v_lshlrev_b32 v240, 16, v205
    v_and_b32 v241, 0xffff0000, v205
    v_lshlrev_b32 v242, 16, v213
    v_and_b32 v243, 0xffff0000, v213
    v_add_f32 v244, v240, v242
    v_add_f32 v245, v241, v243
    v_sub_f32 v246, v240, v242
    v_sub_f32 v247, v241, v243
    v_cvt_pk_bf16_f32 v229, v244, v245
    v_cvt_pk_bf16_f32 v237, v246, v247
    v_dot2c_f32_bf16 v7, v229, v221
    v_lshlrev_b32 v240, 16, v206
    v_and_b32 v241, 0xffff0000, v206
    v_lshlrev_b32 v242, 16, v214
    v_and_b32 v243, 0xffff0000, v214
    v_add_f32 v244, v240, v242
    v_add_f32 v245, v241, v243
    v_sub_f32 v246, v240, v242
    v_sub_f32 v247, v241, v243
    v_cvt_pk_bf16_f32 v230, v244, v245
    v_cvt_pk_bf16_f32 v238, v246, v247
    v_dot2c_f32_bf16 v7, v230, v222
    v_lshlrev_b32 v240, 16, v207
    v_and_b32 v241, 0xffff0000, v207
    v_lshlrev_b32 v242, 16, v215
    v_and_b32 v243, 0xffff0000, v215
    v_add_f32 v244, v240, v242
    v_add_f32 v245, v241, v243
    v_sub_f32 v246, v240, v242
    v_sub_f32 v247, v241, v243
    v_cvt_pk_bf16_f32 v231, v244, v245
    v_cvt_pk_bf16_f32 v239, v246, v247
    v_dot2c_f32_bf16 v7, v231, v223
    s_lshl_b32 s23, s64, 11
    s_add_u32 s31, s23, 30408704
    s_add_u32 s23, s23, 27262976
    buffer_store_dwordx4 v[224:227], v6, s[12:15], s23 offen
    buffer_store_dwordx4 v[228:231], v6, s[12:15], s23 offen offset:16
    buffer_store_dwordx4 v[232:235], v6, s[12:15], s31 offen
    buffer_store_dwordx4 v[236:239], v6, s[12:15], s31 offen offset:16
    s_nop 1
    v_add_f32_dpp v7, v7, v7 row_ror:8 row_mask:0xf bank_mask:0xf
    s_nop 1
    v_add_f32_dpp v7, v7, v7 row_ror:4 row_mask:0xf bank_mask:0xf
    s_nop 1
    v_add_f32_dpp v7, v7, v7 row_ror:2 row_mask:0xf bank_mask:0xf
    s_nop 1
    v_add_f32_dpp v7, v7, v7 row_ror:1 row_mask:0xf bank_mask:0xf
    v_mov_b32 v3, v7
    s_nop 1
    v_permlane16_swap_b32 v7, v3
    s_nop 1
    v_add_f32 v7, v7, v3
    v_mov_b32 v3, v7
    s_nop 1
    v_permlane32_swap_b32 v7, v3
    s_nop 1
    v_add_f32 v7, v7, v3
    v_cvt_pk_bf16_f32 v7, v7, v7
    s_lshl_b32 s23, s64, 1
    s_add_u32 s23, s23, 34668544
    v_mov_b32 v4, 0
    s_mov_b64 exec, 1
    buffer_store_short v7, v4, s[12:15], s23 offen
    s_mov_b64 exec, -1
    s_branch L_sj_donePK
L_sj_emv2PK:
    s_cmp_gt_u32 s64, 512
    s_cbranch_scc1 L_sj_donePK
    v_dot2c_f32_bf16 v7, v200, v216
    v_dot2c_f32_bf16 v7, v201, v217
    v_dot2c_f32_bf16 v7, v202, v218
    v_dot2c_f32_bf16 v7, v203, v219
    v_dot2c_f32_bf16 v7, v204, v220
    v_dot2c_f32_bf16 v7, v205, v221
    v_dot2c_f32_bf16 v7, v206, v222
    v_dot2c_f32_bf16 v7, v207, v223
    s_nop 3
    s_nop 1
    v_add_f32_dpp v7, v7, v7 row_ror:8 row_mask:0xf bank_mask:0xf
    s_nop 1
    v_add_f32_dpp v7, v7, v7 row_ror:4 row_mask:0xf bank_mask:0xf
    s_nop 1
    v_add_f32_dpp v7, v7, v7 row_ror:2 row_mask:0xf bank_mask:0xf
    s_nop 1
    v_add_f32_dpp v7, v7, v7 row_ror:1 row_mask:0xf bank_mask:0xf
    v_mov_b32 v3, v7
    s_nop 1
    v_permlane16_swap_b32 v7, v3
    s_nop 1
    v_add_f32 v7, v7, v3
    v_mov_b32 v3, v7
    s_nop 1
    v_permlane32_swap_b32 v7, v3
    s_nop 1
    v_add_f32 v7, v7, v3
    v_mov_b32 v5, 0
    v_cvt_pk_bf16_f32 v7, v7, v5
    v_cmp_eq_u32 vcc, 0, v2
    s_mul_i32 s23, s64, 2176
    s_add_u32 s31, s23, 35653632
    s_add_u32 s23, s23, 33556480
    v_cndmask_b32 v7, v5, v7, vcc
    v_lshlrev_b32 v4, 2, v2
    s_mov_b32 exec_hi, 0
    buffer_store_dword v7, v4, s[12:15], s23 offen
    buffer_store_dword v5, v4, s[12:15], s31 offen
    s_mov_b64 exec, -1
L_sj_donePK:
    s_branch L_qg_done
L_qg_PV:
    s_add_u32 m0, s20, 0
    s_nop 0
    buffer_load_dwordx4 v152, s[96:99], s16 offen lds
    s_add_u32 m0, s20, 1024
    s_nop 0
    buffer_load_dwordx4 v153, s[96:99], s16 offen lds
    s_add_u32 m0, s20, 2048
    s_nop 0
    buffer_load_dwordx4 v154, s[96:99], s16 offen lds
    s_add_u32 m0, s20, 3072
    s_nop 0
    buffer_load_dwordx4 v155, s[96:99], s16 offen lds
    s_add_u32 s16, s16, s17
    s_add_u32 m0, s20, 28672
    s_nop 0
    buffer_load_dwordx4 v152, s[96:99], s16 offen lds
    s_add_u32 m0, s20, 29696
    s_nop 0
    buffer_load_dwordx4 v153, s[96:99], s16 offen lds
    s_add_u32 m0, s20, 30720
    s_nop 0
    buffer_load_dwordx4 v154, s[96:99], s16 offen lds
    s_add_u32 m0, s20, 31744
    s_nop 0
    buffer_load_dwordx4 v155, s[96:99], s16 offen lds
    s_add_u32 s16, s16, s17
    s_add_u32 m0, s20, 57344
    s_nop 0
    buffer_load_dwordx4 v152, s[96:99], s16 offen lds
    s_add_u32 m0, s20, 58368
    s_nop 0
    buffer_load_dwordx4 v153, s[96:99], s16 offen lds
    s_add_u32 m0, s20, 59392
    s_nop 0
    buffer_load_dwordx4 v154, s[96:99], s16 offen lds
    s_add_u32 m0, s20, 60416
    s_nop 0
    buffer_load_dwordx4 v155, s[96:99], s16 offen lds
    s_add_u32 s16, s16, s17
    v_lshlrev_b32 v9, 4, v2
    v_bfe_u32 v3, v2, 2, 2
    v_lshrrev_b32 v4, 5, v2
    v_lshl_add_u32 v4, v4, 3, v3
    v_bfe_u32 v5, v2, 4, 1
    v_and_b32 v6, 3, v2
    v_lshlrev_b32 v6, 3, v6
    v_lshl_add_u32 v6, v5, 5, v6
    v_lshl_add_u32 v7, v4, 6, v6
    v_lshl_add_u32 v4, v4, 7, v6
    v_lshrrev_b32 v3, 1, v3
    v_lshrrev_b32 v5, 2, v1
    v_xor_b32 v3, v3, v5
    v_lshl_add_u32 v4, v3, 6, v4
    v_add_u32 v181, 24576, v7
    v_add_u32 v182, 81920, v7
    v_add_u32 v183, 139264, v7
    v_add_u32 v156, 0, v4
    v_add_u32 v161, 28672, v4
    v_add_u32 v166, 57344, v4
    v_add_u32 v171, 86016, v4
    s_mov_b32 s27, 0
    s_and_b32 s25, s22, 3
    s_lshl_b32 s25, s25, 5
    v_and_b32 v3, 31, v2
    v_bfe_u32 v4, v3, 1, 3
    v_lshrrev_b32 v5, 5, v2
    v_xor_b32 v4, v4, v5
    v_xor_b32 v4, s27, v4
    v_add_u32 v3, s25, v3
    v_lshlrev_b32 v3, 7, v3
    v_lshl_add_u32 v3, v4, 4, v3
    v_add_u32 v157, 8192, v3
    v_xor_b32 v158, 32, v157
    v_xor_b32 v159, 64, v157
    v_xor_b32 v160, 96, v157
    v_add_u32 v162, 36864, v3
    v_xor_b32 v163, 32, v162
    v_xor_b32 v164, 64, v162
    v_xor_b32 v165, 96, v162
    v_add_u32 v167, 65536, v3
    v_xor_b32 v168, 32, v167
    v_xor_b32 v169, 64, v167
    v_xor_b32 v170, 96, v167
    v_add_u32 v172, 94208, v3
    v_xor_b32 v173, 32, v172
    v_xor_b32 v174, 64, v172
    v_xor_b32 v175, 96, v172
    v_mov_b32 v120, 0
    v_mov_b32 v121, 0
    v_mov_b32 v122, 0
    v_mov_b32 v123, 0
    v_mov_b32 v124, 0
    v_mov_b32 v125, 0
    v_mov_b32 v126, 0
    v_mov_b32 v127, 0
    v_mov_b32 v128, 0
    v_mov_b32 v129, 0
    v_mov_b32 v130, 0
    v_mov_b32 v131, 0
    v_mov_b32 v132, 0
    v_mov_b32 v133, 0
    v_mov_b32 v134, 0
    v_mov_b32 v135, 0
    v_mov_b32 v72, 0
    v_mov_b32 v73, 0
    v_mov_b32 v74, 0
    v_mov_b32 v75, 0
    v_mov_b32 v76, 0
    v_mov_b32 v77, 0
    v_mov_b32 v78, 0
    v_mov_b32 v79, 0
    v_mov_b32 v80, 0
    v_mov_b32 v81, 0
    v_mov_b32 v82, 0
    v_mov_b32 v83, 0
    v_mov_b32 v84, 0
    v_mov_b32 v85, 0
    v_mov_b32 v86, 0
    v_mov_b32 v87, 0
    s_waitcnt vmcnt(8)
    s_barrier
    ds_read_b64_tr_b16 v[88:89], v156 offset:0
    ds_read_b64_tr_b16 v[90:91], v156 offset:512
    ds_read_b128 v[96:99], v157
    ds_read_b64_tr_b16 v[32:33], v181 offset:0
    ds_read_b64_tr_b16 v[34:35], v181 offset:256
    ds_read_b64_tr_b16 v[92:93], v156 offset:2048
    ds_read_b64_tr_b16 v[94:95], v156 offset:2560
    ds_read_b128 v[100:103], v158
    ds_read_b64_tr_b16 v[36:37], v181 offset:1024
    ds_read_b64_tr_b16 v[38:39], v181 offset:1280
    ds_read_b64_tr_b16 v[104:105], v156 offset:4096
    ds_read_b64_tr_b16 v[106:107], v156 offset:4608
    ds_read_b128 v[112:115], v159
    ds_read_b64_tr_b16 v[40:41], v181 offset:2048
    ds_read_b64_tr_b16 v[42:43], v181 offset:2304
    ds_read_b64_tr_b16 v[108:109], v156 offset:6144
    ds_read_b64_tr_b16 v[110:111], v156 offset:6656
    ds_read_b128 v[116:119], v160
    ds_read_b64_tr_b16 v[44:45], v181 offset:3072
    ds_read_b64_tr_b16 v[46:47], v181 offset:3328
    s_waitcnt lgkmcnt(10)
    v_mfma_f32_32x32x16_bf16 v[120:135], v[88:91], v[96:99], v[120:135]
    s_add_u32 m0, s20, 86016
    s_nop 0
    buffer_load_dwordx4 v152, s[96:99], s16 offen lds
    v_mfma_f32_32x32x16_bf16 v[72:87], v[96:99], v[32:35], v[72:87]
    s_add_u32 m0, s20, 87040
    s_nop 0
    buffer_load_dwordx4 v153, s[96:99], s16 offen lds
    v_mfma_f32_32x32x16_bf16 v[120:135], v[92:95], v[100:103], v[120:135]
    v_mfma_f32_32x32x16_bf16 v[72:87], v[100:103], v[36:39], v[72:87]
    s_add_u32 m0, s20, 88064
    s_nop 0
    buffer_load_dwordx4 v154, s[96:99], s16 offen lds
    s_waitcnt lgkmcnt(0)
    v_mfma_f32_32x32x16_bf16 v[120:135], v[104:107], v[112:115], v[120:135]
    s_add_u32 m0, s20, 89088
    s_nop 0
    buffer_load_dwordx4 v155, s[96:99], s16 offen lds
    v_mfma_f32_32x32x16_bf16 v[72:87], v[112:115], v[40:43], v[72:87]
    s_add_u32 s16, s16, s17
    s_waitcnt vmcnt(8)
    s_barrier
    ds_read_b64_tr_b16 v[88:89], v161 offset:0
    ds_read_b64_tr_b16 v[90:91], v161 offset:512
    ds_read_b128 v[96:99], v162
    ds_read_b64_tr_b16 v[32:33], v181 offset:28672
    ds_read_b64_tr_b16 v[34:35], v181 offset:28928
    ds_read_b64_tr_b16 v[92:93], v161 offset:2048
    ds_read_b64_tr_b16 v[94:95], v161 offset:2560
    ds_read_b128 v[100:103], v163
    ds_read_b64_tr_b16 v[36:37], v181 offset:29696
    ds_read_b64_tr_b16 v[38:39], v181 offset:29952
    v_mfma_f32_32x32x16_bf16 v[120:135], v[108:111], v[116:119], v[120:135]
    v_mfma_f32_32x32x16_bf16 v[72:87], v[116:119], v[44:47], v[72:87]
    ds_read_b64_tr_b16 v[104:105], v161 offset:4096
    ds_read_b64_tr_b16 v[106:107], v161 offset:4608
    ds_read_b128 v[112:115], v164
    ds_read_b64_tr_b16 v[40:41], v181 offset:30720
    ds_read_b64_tr_b16 v[42:43], v181 offset:30976
    ds_read_b64_tr_b16 v[108:109], v161 offset:6144
    ds_read_b64_tr_b16 v[110:111], v161 offset:6656
    ds_read_b128 v[116:119], v165
    ds_read_b64_tr_b16 v[44:45], v181 offset:31744
    ds_read_b64_tr_b16 v[46:47], v181 offset:32000
    s_waitcnt lgkmcnt(10)
    v_mfma_f32_32x32x16_bf16 v[120:135], v[88:91], v[96:99], v[120:135]
    s_add_u32 m0, s20, 0
    s_nop 0
    buffer_load_dwordx4 v152, s[96:99], s16 offen lds
    v_mfma_f32_32x32x16_bf16 v[72:87], v[96:99], v[32:35], v[72:87]
    s_add_u32 m0, s20, 1024
    s_nop 0
    buffer_load_dwordx4 v153, s[96:99], s16 offen lds
    v_mfma_f32_32x32x16_bf16 v[120:135], v[92:95], v[100:103], v[120:135]
    v_mfma_f32_32x32x16_bf16 v[72:87], v[100:103], v[36:39], v[72:87]
    s_add_u32 m0, s20, 2048
    s_nop 0
    buffer_load_dwordx4 v154, s[96:99], s16 offen lds
    s_waitcnt lgkmcnt(0)
    v_mfma_f32_32x32x16_bf16 v[120:135], v[104:107], v[112:115], v[120:135]
    s_add_u32 m0, s20, 3072
    s_nop 0
    buffer_load_dwordx4 v155, s[96:99], s16 offen lds
    v_mfma_f32_32x32x16_bf16 v[72:87], v[112:115], v[40:43], v[72:87]
    s_add_u32 s16, s16, s17
    s_waitcnt vmcnt(8)
    s_barrier
    ds_read_b64_tr_b16 v[88:89], v166 offset:0
    ds_read_b64_tr_b16 v[90:91], v166 offset:512
    ds_read_b128 v[96:99], v167
    ds_read_b64_tr_b16 v[32:33], v182 offset:0
    ds_read_b64_tr_b16 v[34:35], v182 offset:256
    ds_read_b64_tr_b16 v[92:93], v166 offset:2048
    ds_read_b64_tr_b16 v[94:95], v166 offset:2560
    ds_read_b128 v[100:103], v168
    ds_read_b64_tr_b16 v[36:37], v182 offset:1024
    ds_read_b64_tr_b16 v[38:39], v182 offset:1280
    v_mfma_f32_32x32x16_bf16 v[120:135], v[108:111], v[116:119], v[120:135]
    v_mfma_f32_32x32x16_bf16 v[72:87], v[116:119], v[44:47], v[72:87]
    ds_read_b64_tr_b16 v[104:105], v166 offset:4096
    ds_read_b64_tr_b16 v[106:107], v166 offset:4608
    ds_read_b128 v[112:115], v169
    ds_read_b64_tr_b16 v[40:41], v182 offset:2048
    ds_read_b64_tr_b16 v[42:43], v182 offset:2304
    ds_read_b64_tr_b16 v[108:109], v166 offset:6144
    ds_read_b64_tr_b16 v[110:111], v166 offset:6656
    ds_read_b128 v[116:119], v170
    ds_read_b64_tr_b16 v[44:45], v182 offset:3072
    ds_read_b64_tr_b16 v[46:47], v182 offset:3328
    s_waitcnt lgkmcnt(10)
    v_mfma_f32_32x32x16_bf16 v[120:135], v[88:91], v[96:99], v[120:135]
    s_add_u32 m0, s20, 28672
    s_nop 0
    buffer_load_dwordx4 v152, s[96:99], s16 offen lds
    v_mfma_f32_32x32x16_bf16 v[72:87], v[96:99], v[32:35], v[72:87]
    s_add_u32 m0, s20, 29696
    s_nop 0
    buffer_load_dwordx4 v153, s[96:99], s16 offen lds
    v_mfma_f32_32x32x16_bf16 v[120:135], v[92:95], v[100:103], v[120:135]
    v_mfma_f32_32x32x16_bf16 v[72:87], v[100:103], v[36:39], v[72:87]
    s_add_u32 m0, s20, 30720
    s_nop 0
    buffer_load_dwordx4 v154, s[96:99], s16 offen lds
    s_waitcnt lgkmcnt(0)
    v_mfma_f32_32x32x16_bf16 v[120:135], v[104:107], v[112:115], v[120:135]
    s_add_u32 m0, s20, 31744
    s_nop 0
    buffer_load_dwordx4 v155, s[96:99], s16 offen lds
    v_mfma_f32_32x32x16_bf16 v[72:87], v[112:115], v[40:43], v[72:87]
    s_add_u32 s16, s16, s17
    s_waitcnt vmcnt(8)
    s_barrier
    ds_read_b64_tr_b16 v[88:89], v171 offset:0
    ds_read_b64_tr_b16 v[90:91], v171 offset:512
    ds_read_b128 v[96:99], v172
    ds_read_b64_tr_b16 v[32:33], v182 offset:28672
    ds_read_b64_tr_b16 v[34:35], v182 offset:28928
    ds_read_b64_tr_b16 v[92:93], v171 offset:2048
    ds_read_b64_tr_b16 v[94:95], v171 offset:2560
    ds_read_b128 v[100:103], v173
    ds_read_b64_tr_b16 v[36:37], v182 offset:29696
    ds_read_b64_tr_b16 v[38:39], v182 offset:29952
    v_mfma_f32_32x32x16_bf16 v[120:135], v[108:111], v[116:119], v[120:135]
    v_mfma_f32_32x32x16_bf16 v[72:87], v[116:119], v[44:47], v[72:87]
    ds_read_b64_tr_b16 v[104:105], v171 offset:4096
    ds_read_b64_tr_b16 v[106:107], v171 offset:4608
    ds_read_b128 v[112:115], v174
    ds_read_b64_tr_b16 v[40:41], v182 offset:30720
    ds_read_b64_tr_b16 v[42:43], v182 offset:30976
    ds_read_b64_tr_b16 v[108:109], v171 offset:6144
    ds_read_b64_tr_b16 v[110:111], v171 offset:6656
    ds_read_b128 v[116:119], v175
    ds_read_b64_tr_b16 v[44:45], v182 offset:31744
    ds_read_b64_tr_b16 v[46:47], v182 offset:32000
    s_waitcnt lgkmcnt(10)
    v_mfma_f32_32x32x16_bf16 v[120:135], v[88:91], v[96:99], v[120:135]
    s_add_u32 m0, s20, 57344
    s_nop 0
    buffer_load_dwordx4 v152, s[96:99], s16 offen lds
    v_mfma_f32_32x32x16_bf16 v[72:87], v[96:99], v[32:35], v[72:87]
    s_add_u32 m0, s20, 58368
    s_nop 0
    buffer_load_dwordx4 v153, s[96:99], s16 offen lds
    v_mfma_f32_32x32x16_bf16 v[120:135], v[92:95], v[100:103], v[120:135]
    v_mfma_f32_32x32x16_bf16 v[72:87], v[100:103], v[36:39], v[72:87]
    s_add_u32 m0, s20, 59392
    s_nop 0
    buffer_load_dwordx4 v154, s[96:99], s16 offen lds
    s_waitcnt lgkmcnt(0)
    v_mfma_f32_32x32x16_bf16 v[120:135], v[104:107], v[112:115], v[120:135]
    s_add_u32 m0, s20, 60416
    s_nop 0
    buffer_load_dwordx4 v155, s[96:99], s16 offen lds
    v_mfma_f32_32x32x16_bf16 v[72:87], v[112:115], v[40:43], v[72:87]
    s_add_u32 s16, s16, s17
    s_waitcnt vmcnt(8)
    s_barrier
    ds_read_b64_tr_b16 v[88:89], v156 offset:0
    ds_read_b64_tr_b16 v[90:91], v156 offset:512
    ds_read_b128 v[96:99], v157
    ds_read_b64_tr_b16 v[32:33], v181 offset:0
    ds_read_b64_tr_b16 v[34:35], v181 offset:256
    ds_read_b64_tr_b16 v[92:93], v156 offset:2048
    ds_read_b64_tr_b16 v[94:95], v156 offset:2560
    ds_read_b128 v[100:103], v158
    ds_read_b64_tr_b16 v[36:37], v181 offset:1024
    ds_read_b64_tr_b16 v[38:39], v181 offset:1280
    v_mfma_f32_32x32x16_bf16 v[120:135], v[108:111], v[116:119], v[120:135]
    v_mfma_f32_32x32x16_bf16 v[72:87], v[116:119], v[44:47], v[72:87]
    ds_read_b64_tr_b16 v[104:105], v156 offset:4096
    ds_read_b64_tr_b16 v[106:107], v156 offset:4608
    ds_read_b128 v[112:115], v159
    ds_read_b64_tr_b16 v[40:41], v181 offset:2048
    ds_read_b64_tr_b16 v[42:43], v181 offset:2304
    ds_read_b64_tr_b16 v[108:109], v156 offset:6144
    ds_read_b64_tr_b16 v[110:111], v156 offset:6656
    ds_read_b128 v[116:119], v160
    ds_read_b64_tr_b16 v[44:45], v181 offset:3072
    ds_read_b64_tr_b16 v[46:47], v181 offset:3328
    s_waitcnt lgkmcnt(10)
    v_mfma_f32_32x32x16_bf16 v[120:135], v[88:91], v[96:99], v[120:135]
    s_add_u32 m0, s20, 86016
    s_nop 0
    buffer_load_dwordx4 v152, s[96:99], s16 offen lds
    v_mfma_f32_32x32x16_bf16 v[72:87], v[96:99], v[32:35], v[72:87]
    s_add_u32 m0, s20, 87040
    s_nop 0
    buffer_load_dwordx4 v153, s[96:99], s16 offen lds
    v_mfma_f32_32x32x16_bf16 v[120:135], v[92:95], v[100:103], v[120:135]
    v_mfma_f32_32x32x16_bf16 v[72:87], v[100:103], v[36:39], v[72:87]
    s_add_u32 m0, s20, 88064
    s_nop 0
    buffer_load_dwordx4 v154, s[96:99], s16 offen lds
    s_waitcnt lgkmcnt(0)
    v_mfma_f32_32x32x16_bf16 v[120:135], v[104:107], v[112:115], v[120:135]
    s_add_u32 m0, s20, 89088
    s_nop 0
    buffer_load_dwordx4 v155, s[96:99], s16 offen lds
    v_mfma_f32_32x32x16_bf16 v[72:87], v[112:115], v[40:43], v[72:87]
    s_add_u32 s16, s16, s17
    s_waitcnt vmcnt(8)
    s_barrier
    ds_read_b64_tr_b16 v[88:89], v161 offset:0
    ds_read_b64_tr_b16 v[90:91], v161 offset:512
    ds_read_b128 v[96:99], v162
    ds_read_b64_tr_b16 v[32:33], v181 offset:28672
    ds_read_b64_tr_b16 v[34:35], v181 offset:28928
    ds_read_b64_tr_b16 v[92:93], v161 offset:2048
    ds_read_b64_tr_b16 v[94:95], v161 offset:2560
    ds_read_b128 v[100:103], v163
    ds_read_b64_tr_b16 v[36:37], v181 offset:29696
    ds_read_b64_tr_b16 v[38:39], v181 offset:29952
    v_mfma_f32_32x32x16_bf16 v[120:135], v[108:111], v[116:119], v[120:135]
    v_mfma_f32_32x32x16_bf16 v[72:87], v[116:119], v[44:47], v[72:87]
    ds_read_b64_tr_b16 v[104:105], v161 offset:4096
    ds_read_b64_tr_b16 v[106:107], v161 offset:4608
    ds_read_b128 v[112:115], v164
    ds_read_b64_tr_b16 v[40:41], v181 offset:30720
    ds_read_b64_tr_b16 v[42:43], v181 offset:30976
    ds_read_b64_tr_b16 v[108:109], v161 offset:6144
    ds_read_b64_tr_b16 v[110:111], v161 offset:6656
    ds_read_b128 v[116:119], v165
    ds_read_b64_tr_b16 v[44:45], v181 offset:31744
    ds_read_b64_tr_b16 v[46:47], v181 offset:32000
    s_waitcnt lgkmcnt(10)
    v_mfma_f32_32x32x16_bf16 v[120:135], v[88:91], v[96:99], v[120:135]
    s_add_u32 m0, s20, 0
    s_nop 0
    buffer_load_dwordx4 v152, s[96:99], s16 offen lds
    v_mfma_f32_32x32x16_bf16 v[72:87], v[96:99], v[32:35], v[72:87]
    s_add_u32 m0, s20, 1024
    s_nop 0
    buffer_load_dwordx4 v153, s[96:99], s16 offen lds
    v_mfma_f32_32x32x16_bf16 v[120:135], v[92:95], v[100:103], v[120:135]
    v_mfma_f32_32x32x16_bf16 v[72:87], v[100:103], v[36:39], v[72:87]
    s_add_u32 m0, s20, 2048
    s_nop 0
    buffer_load_dwordx4 v154, s[96:99], s16 offen lds
    s_waitcnt lgkmcnt(0)
    v_mfma_f32_32x32x16_bf16 v[120:135], v[104:107], v[112:115], v[120:135]
    s_add_u32 m0, s20, 3072
    s_nop 0
    buffer_load_dwordx4 v155, s[96:99], s16 offen lds
    v_mfma_f32_32x32x16_bf16 v[72:87], v[112:115], v[40:43], v[72:87]
    s_add_u32 s16, s16, s17
    s_waitcnt vmcnt(8)
    s_barrier
    ds_read_b64_tr_b16 v[88:89], v166 offset:0
    ds_read_b64_tr_b16 v[90:91], v166 offset:512
    ds_read_b128 v[96:99], v167
    ds_read_b64_tr_b16 v[32:33], v182 offset:0
    ds_read_b64_tr_b16 v[34:35], v182 offset:256
    ds_read_b64_tr_b16 v[92:93], v166 offset:2048
    ds_read_b64_tr_b16 v[94:95], v166 offset:2560
    ds_read_b128 v[100:103], v168
    ds_read_b64_tr_b16 v[36:37], v182 offset:1024
    ds_read_b64_tr_b16 v[38:39], v182 offset:1280
    v_mfma_f32_32x32x16_bf16 v[120:135], v[108:111], v[116:119], v[120:135]
    v_mfma_f32_32x32x16_bf16 v[72:87], v[116:119], v[44:47], v[72:87]
    ds_read_b64_tr_b16 v[104:105], v166 offset:4096
    ds_read_b64_tr_b16 v[106:107], v166 offset:4608
    ds_read_b128 v[112:115], v169
    ds_read_b64_tr_b16 v[40:41], v182 offset:2048
    ds_read_b64_tr_b16 v[42:43], v182 offset:2304
    ds_read_b64_tr_b16 v[108:109], v166 offset:6144
    ds_read_b64_tr_b16 v[110:111], v166 offset:6656
    ds_read_b128 v[116:119], v170
    ds_read_b64_tr_b16 v[44:45], v182 offset:3072
    ds_read_b64_tr_b16 v[46:47], v182 offset:3328
    s_waitcnt lgkmcnt(10)
    v_mfma_f32_32x32x16_bf16 v[120:135], v[88:91], v[96:99], v[120:135]
    s_add_u32 m0, s20, 28672
    s_nop 0
    buffer_load_dwordx4 v152, s[96:99], s16 offen lds
    v_mfma_f32_32x32x16_bf16 v[72:87], v[96:99], v[32:35], v[72:87]
    s_add_u32 m0, s20, 29696
    s_nop 0
    buffer_load_dwordx4 v153, s[96:99], s16 offen lds
    v_mfma_f32_32x32x16_bf16 v[120:135], v[92:95], v[100:103], v[120:135]
    v_mfma_f32_32x32x16_bf16 v[72:87], v[100:103], v[36:39], v[72:87]
    s_add_u32 m0, s20, 30720
    s_nop 0
    buffer_load_dwordx4 v154, s[96:99], s16 offen lds
    s_waitcnt lgkmcnt(0)
    v_mfma_f32_32x32x16_bf16 v[120:135], v[104:107], v[112:115], v[120:135]
    s_add_u32 m0, s20, 31744
    s_nop 0
    buffer_load_dwordx4 v155, s[96:99], s16 offen lds
    v_mfma_f32_32x32x16_bf16 v[72:87], v[112:115], v[40:43], v[72:87]
    s_add_u32 s16, s16, s17
    s_waitcnt vmcnt(8)
    s_barrier
    ds_read_b64_tr_b16 v[88:89], v171 offset:0
    ds_read_b64_tr_b16 v[90:91], v171 offset:512
    ds_read_b128 v[96:99], v172
    ds_read_b64_tr_b16 v[32:33], v182 offset:28672
    ds_read_b64_tr_b16 v[34:35], v182 offset:28928
    ds_read_b64_tr_b16 v[92:93], v171 offset:2048
    ds_read_b64_tr_b16 v[94:95], v171 offset:2560
    ds_read_b128 v[100:103], v173
    ds_read_b64_tr_b16 v[36:37], v182 offset:29696
    ds_read_b64_tr_b16 v[38:39], v182 offset:29952
    v_mfma_f32_32x32x16_bf16 v[120:135], v[108:111], v[116:119], v[120:135]
    v_mfma_f32_32x32x16_bf16 v[72:87], v[116:119], v[44:47], v[72:87]
    ds_read_b64_tr_b16 v[104:105], v171 offset:4096
    ds_read_b64_tr_b16 v[106:107], v171 offset:4608
    ds_read_b128 v[112:115], v174
    ds_read_b64_tr_b16 v[40:41], v182 offset:30720
    ds_read_b64_tr_b16 v[42:43], v182 offset:30976
    ds_read_b64_tr_b16 v[108:109], v171 offset:6144
    ds_read_b64_tr_b16 v[110:111], v171 offset:6656
    ds_read_b128 v[116:119], v175
    ds_read_b64_tr_b16 v[44:45], v182 offset:31744
    ds_read_b64_tr_b16 v[46:47], v182 offset:32000
    s_waitcnt lgkmcnt(10)
    v_mfma_f32_32x32x16_bf16 v[120:135], v[88:91], v[96:99], v[120:135]
    s_add_u32 m0, s20, 57344
    s_nop 0
    buffer_load_dwordx4 v152, s[96:99], s16 offen lds
    v_mfma_f32_32x32x16_bf16 v[72:87], v[96:99], v[32:35], v[72:87]
    s_add_u32 m0, s20, 58368
    s_nop 0
    buffer_load_dwordx4 v153, s[96:99], s16 offen lds
    v_mfma_f32_32x32x16_bf16 v[120:135], v[92:95], v[100:103], v[120:135]
    v_mfma_f32_32x32x16_bf16 v[72:87], v[100:103], v[36:39], v[72:87]
    s_add_u32 m0, s20, 59392
    s_nop 0
    buffer_load_dwordx4 v154, s[96:99], s16 offen lds
    s_waitcnt lgkmcnt(0)
    v_mfma_f32_32x32x16_bf16 v[120:135], v[104:107], v[112:115], v[120:135]
    s_add_u32 m0, s20, 60416
    s_nop 0
    buffer_load_dwordx4 v155, s[96:99], s16 offen lds
    v_mfma_f32_32x32x16_bf16 v[72:87], v[112:115], v[40:43], v[72:87]
    s_add_u32 s16, s16, s17
    s_waitcnt vmcnt(8)
    s_barrier
    ds_read_b64_tr_b16 v[88:89], v156 offset:0
    ds_read_b64_tr_b16 v[90:91], v156 offset:512
    ds_read_b128 v[96:99], v157
    ds_read_b64_tr_b16 v[32:33], v181 offset:0
    ds_read_b64_tr_b16 v[34:35], v181 offset:256
    ds_read_b64_tr_b16 v[92:93], v156 offset:2048
    ds_read_b64_tr_b16 v[94:95], v156 offset:2560
    ds_read_b128 v[100:103], v158
    ds_read_b64_tr_b16 v[36:37], v181 offset:1024
    ds_read_b64_tr_b16 v[38:39], v181 offset:1280
    v_mfma_f32_32x32x16_bf16 v[120:135], v[108:111], v[116:119], v[120:135]
    v_mfma_f32_32x32x16_bf16 v[72:87], v[116:119], v[44:47], v[72:87]
    ds_read_b64_tr_b16 v[104:105], v156 offset:4096
    ds_read_b64_tr_b16 v[106:107], v156 offset:4608
    ds_read_b128 v[112:115], v159
    ds_read_b64_tr_b16 v[40:41], v181 offset:2048
    ds_read_b64_tr_b16 v[42:43], v181 offset:2304
    ds_read_b64_tr_b16 v[108:109], v156 offset:6144
    ds_read_b64_tr_b16 v[110:111], v156 offset:6656
    ds_read_b128 v[116:119], v160
    ds_read_b64_tr_b16 v[44:45], v181 offset:3072
    ds_read_b64_tr_b16 v[46:47], v181 offset:3328
    s_waitcnt lgkmcnt(10)
    v_mfma_f32_32x32x16_bf16 v[120:135], v[88:91], v[96:99], v[120:135]
    s_add_u32 m0, s20, 86016
    s_nop 0
    buffer_load_dwordx4 v152, s[96:99], s16 offen lds
    v_mfma_f32_32x32x16_bf16 v[72:87], v[96:99], v[32:35], v[72:87]
    s_add_u32 m0, s20, 87040
    s_nop 0
    buffer_load_dwordx4 v153, s[96:99], s16 offen lds
    v_mfma_f32_32x32x16_bf16 v[120:135], v[92:95], v[100:103], v[120:135]
    v_mfma_f32_32x32x16_bf16 v[72:87], v[100:103], v[36:39], v[72:87]
    s_add_u32 m0, s20, 88064
    s_nop 0
    buffer_load_dwordx4 v154, s[96:99], s16 offen lds
    s_waitcnt lgkmcnt(0)
    v_mfma_f32_32x32x16_bf16 v[120:135], v[104:107], v[112:115], v[120:135]
    s_add_u32 m0, s20, 89088
    s_nop 0
    buffer_load_dwordx4 v155, s[96:99], s16 offen lds
    v_mfma_f32_32x32x16_bf16 v[72:87], v[112:115], v[40:43], v[72:87]
    s_add_u32 s16, s16, s17
    s_waitcnt vmcnt(8)
    s_barrier
    ds_read_b64_tr_b16 v[88:89], v161 offset:0
    ds_read_b64_tr_b16 v[90:91], v161 offset:512
    ds_read_b128 v[96:99], v162
    ds_read_b64_tr_b16 v[32:33], v181 offset:28672
    ds_read_b64_tr_b16 v[34:35], v181 offset:28928
    ds_read_b64_tr_b16 v[92:93], v161 offset:2048
    ds_read_b64_tr_b16 v[94:95], v161 offset:2560
    ds_read_b128 v[100:103], v163
    ds_read_b64_tr_b16 v[36:37], v181 offset:29696
    ds_read_b64_tr_b16 v[38:39], v181 offset:29952
    v_mfma_f32_32x32x16_bf16 v[120:135], v[108:111], v[116:119], v[120:135]
    v_mfma_f32_32x32x16_bf16 v[72:87], v[116:119], v[44:47], v[72:87]
    ds_read_b64_tr_b16 v[104:105], v161 offset:4096
    ds_read_b64_tr_b16 v[106:107], v161 offset:4608
    ds_read_b128 v[112:115], v164
    ds_read_b64_tr_b16 v[40:41], v181 offset:30720
    ds_read_b64_tr_b16 v[42:43], v181 offset:30976
    ds_read_b64_tr_b16 v[108:109], v161 offset:6144
    ds_read_b64_tr_b16 v[110:111], v161 offset:6656
    ds_read_b128 v[116:119], v165
    ds_read_b64_tr_b16 v[44:45], v181 offset:31744
    ds_read_b64_tr_b16 v[46:47], v181 offset:32000
    s_waitcnt lgkmcnt(10)
    v_mfma_f32_32x32x16_bf16 v[120:135], v[88:91], v[96:99], v[120:135]
    s_add_u32 m0, s20, 0
    s_nop 0
    buffer_load_dwordx4 v152, s[96:99], s16 offen lds
    v_mfma_f32_32x32x16_bf16 v[72:87], v[96:99], v[32:35], v[72:87]
    s_add_u32 m0, s20, 1024
    s_nop 0
    buffer_load_dwordx4 v153, s[96:99], s16 offen lds
    v_mfma_f32_32x32x16_bf16 v[120:135], v[92:95], v[100:103], v[120:135]
    v_mfma_f32_32x32x16_bf16 v[72:87], v[100:103], v[36:39], v[72:87]
    s_add_u32 m0, s20, 2048
    s_nop 0
    buffer_load_dwordx4 v154, s[96:99], s16 offen lds
    s_waitcnt lgkmcnt(0)
    v_mfma_f32_32x32x16_bf16 v[120:135], v[104:107], v[112:115], v[120:135]
    s_add_u32 m0, s20, 3072
    s_nop 0
    buffer_load_dwordx4 v155, s[96:99], s16 offen lds
    v_mfma_f32_32x32x16_bf16 v[72:87], v[112:115], v[40:43], v[72:87]
    s_add_u32 s16, s16, s17
    s_waitcnt vmcnt(8)
    s_barrier
    ds_read_b64_tr_b16 v[88:89], v166 offset:0
    ds_read_b64_tr_b16 v[90:91], v166 offset:512
    ds_read_b128 v[96:99], v167
    ds_read_b64_tr_b16 v[32:33], v182 offset:0
    ds_read_b64_tr_b16 v[34:35], v182 offset:256
    ds_read_b64_tr_b16 v[92:93], v166 offset:2048
    ds_read_b64_tr_b16 v[94:95], v166 offset:2560
    ds_read_b128 v[100:103], v168
    ds_read_b64_tr_b16 v[36:37], v182 offset:1024
    ds_read_b64_tr_b16 v[38:39], v182 offset:1280
    v_mfma_f32_32x32x16_bf16 v[120:135], v[108:111], v[116:119], v[120:135]
    v_mfma_f32_32x32x16_bf16 v[72:87], v[116:119], v[44:47], v[72:87]
    ds_read_b64_tr_b16 v[104:105], v166 offset:4096
    ds_read_b64_tr_b16 v[106:107], v166 offset:4608
    ds_read_b128 v[112:115], v169
    ds_read_b64_tr_b16 v[40:41], v182 offset:2048
    ds_read_b64_tr_b16 v[42:43], v182 offset:2304
    ds_read_b64_tr_b16 v[108:109], v166 offset:6144
    ds_read_b64_tr_b16 v[110:111], v166 offset:6656
    ds_read_b128 v[116:119], v170
    ds_read_b64_tr_b16 v[44:45], v182 offset:3072
    ds_read_b64_tr_b16 v[46:47], v182 offset:3328
    s_waitcnt lgkmcnt(10)
    v_mfma_f32_32x32x16_bf16 v[120:135], v[88:91], v[96:99], v[120:135]
    s_add_u32 m0, s20, 28672
    s_nop 0
    buffer_load_dwordx4 v152, s[96:99], s16 offen lds
    v_mfma_f32_32x32x16_bf16 v[72:87], v[96:99], v[32:35], v[72:87]
    s_add_u32 m0, s20, 29696
    s_nop 0
    buffer_load_dwordx4 v153, s[96:99], s16 offen lds
    v_mfma_f32_32x32x16_bf16 v[120:135], v[92:95], v[100:103], v[120:135]
    v_mfma_f32_32x32x16_bf16 v[72:87], v[100:103], v[36:39], v[72:87]
    s_add_u32 m0, s20, 30720
    s_nop 0
    buffer_load_dwordx4 v154, s[96:99], s16 offen lds
    s_waitcnt lgkmcnt(0)
    v_mfma_f32_32x32x16_bf16 v[120:135], v[104:107], v[112:115], v[120:135]
    s_add_u32 m0, s20, 31744
    s_nop 0
    buffer_load_dwordx4 v155, s[96:99], s16 offen lds
    v_mfma_f32_32x32x16_bf16 v[72:87], v[112:115], v[40:43], v[72:87]
    s_add_u32 s16, s16, s17
    s_waitcnt vmcnt(8)
    s_barrier
    ds_read_b64_tr_b16 v[88:89], v171 offset:0
    ds_read_b64_tr_b16 v[90:91], v171 offset:512
    ds_read_b128 v[96:99], v172
    ds_read_b64_tr_b16 v[32:33], v182 offset:28672
    ds_read_b64_tr_b16 v[34:35], v182 offset:28928
    ds_read_b64_tr_b16 v[92:93], v171 offset:2048
    ds_read_b64_tr_b16 v[94:95], v171 offset:2560
    ds_read_b128 v[100:103], v173
    ds_read_b64_tr_b16 v[36:37], v182 offset:29696
    ds_read_b64_tr_b16 v[38:39], v182 offset:29952
    v_mfma_f32_32x32x16_bf16 v[120:135], v[108:111], v[116:119], v[120:135]
    v_mfma_f32_32x32x16_bf16 v[72:87], v[116:119], v[44:47], v[72:87]
    ds_read_b64_tr_b16 v[104:105], v171 offset:4096
    ds_read_b64_tr_b16 v[106:107], v171 offset:4608
    ds_read_b128 v[112:115], v174
    ds_read_b64_tr_b16 v[40:41], v182 offset:30720
    ds_read_b64_tr_b16 v[42:43], v182 offset:30976
    ds_read_b64_tr_b16 v[108:109], v171 offset:6144
    ds_read_b64_tr_b16 v[110:111], v171 offset:6656
    ds_read_b128 v[116:119], v175
    ds_read_b64_tr_b16 v[44:45], v182 offset:31744
    ds_read_b64_tr_b16 v[46:47], v182 offset:32000
    s_waitcnt lgkmcnt(10)
    v_mfma_f32_32x32x16_bf16 v[120:135], v[88:91], v[96:99], v[120:135]
    s_add_u32 m0, s20, 57344
    s_nop 0
    buffer_load_dwordx4 v152, s[96:99], s16 offen lds
    v_mfma_f32_32x32x16_bf16 v[72:87], v[96:99], v[32:35], v[72:87]
    s_add_u32 m0, s20, 58368
    s_nop 0
    buffer_load_dwordx4 v153, s[96:99], s16 offen lds
    v_mfma_f32_32x32x16_bf16 v[120:135], v[92:95], v[100:103], v[120:135]
    v_mfma_f32_32x32x16_bf16 v[72:87], v[100:103], v[36:39], v[72:87]
    s_add_u32 m0, s20, 59392
    s_nop 0
    buffer_load_dwordx4 v154, s[96:99], s16 offen lds
    s_waitcnt lgkmcnt(0)
    v_mfma_f32_32x32x16_bf16 v[120:135], v[104:107], v[112:115], v[120:135]
    s_add_u32 m0, s20, 60416
    s_nop 0
    buffer_load_dwordx4 v155, s[96:99], s16 offen lds
    v_mfma_f32_32x32x16_bf16 v[72:87], v[112:115], v[40:43], v[72:87]
    s_add_u32 s16, s16, s17
    s_waitcnt vmcnt(8)
    s_barrier
    ds_read_b64_tr_b16 v[88:89], v156 offset:0
    ds_read_b64_tr_b16 v[90:91], v156 offset:512
    ds_read_b128 v[96:99], v157
    ds_read_b64_tr_b16 v[32:33], v181 offset:0
    ds_read_b64_tr_b16 v[34:35], v181 offset:256
    ds_read_b64_tr_b16 v[92:93], v156 offset:2048
    ds_read_b64_tr_b16 v[94:95], v156 offset:2560
    ds_read_b128 v[100:103], v158
    ds_read_b64_tr_b16 v[36:37], v181 offset:1024
    ds_read_b64_tr_b16 v[38:39], v181 offset:1280
    v_mfma_f32_32x32x16_bf16 v[120:135], v[108:111], v[116:119], v[120:135]
    v_mfma_f32_32x32x16_bf16 v[72:87], v[116:119], v[44:47], v[72:87]
    ds_read_b64_tr_b16 v[104:105], v156 offset:4096
    ds_read_b64_tr_b16 v[106:107], v156 offset:4608
    ds_read_b128 v[112:115], v159
    ds_read_b64_tr_b16 v[40:41], v181 offset:2048
    ds_read_b64_tr_b16 v[42:43], v181 offset:2304
    ds_read_b64_tr_b16 v[108:109], v156 offset:6144
    ds_read_b64_tr_b16 v[110:111], v156 offset:6656
    ds_read_b128 v[116:119], v160
    ds_read_b64_tr_b16 v[44:45], v181 offset:3072
    ds_read_b64_tr_b16 v[46:47], v181 offset:3328
    s_waitcnt lgkmcnt(10)
    v_mfma_f32_32x32x16_bf16 v[120:135], v[88:91], v[96:99], v[120:135]
    s_add_u32 m0, s20, 86016
    s_nop 0
    buffer_load_dwordx4 v152, s[96:99], s16 offen lds
    v_mfma_f32_32x32x16_bf16 v[72:87], v[96:99], v[32:35], v[72:87]
    s_add_u32 m0, s20, 87040
    s_nop 0
    buffer_load_dwordx4 v153, s[96:99], s16 offen lds
    v_mfma_f32_32x32x16_bf16 v[120:135], v[92:95], v[100:103], v[120:135]
    v_mfma_f32_32x32x16_bf16 v[72:87], v[100:103], v[36:39], v[72:87]
    s_add_u32 m0, s20, 88064
    s_nop 0
    buffer_load_dwordx4 v154, s[96:99], s16 offen lds
    s_waitcnt lgkmcnt(0)
    v_mfma_f32_32x32x16_bf16 v[120:135], v[104:107], v[112:115], v[120:135]
    s_add_u32 m0, s20, 89088
    s_nop 0
    buffer_load_dwordx4 v155, s[96:99], s16 offen lds
    v_mfma_f32_32x32x16_bf16 v[72:87], v[112:115], v[40:43], v[72:87]
    s_add_u32 s16, s16, s17
    s_waitcnt vmcnt(8)
    s_barrier
    ds_read_b64_tr_b16 v[88:89], v161 offset:0
    ds_read_b64_tr_b16 v[90:91], v161 offset:512
    ds_read_b128 v[96:99], v162
    ds_read_b64_tr_b16 v[32:33], v181 offset:28672
    ds_read_b64_tr_b16 v[34:35], v181 offset:28928
    ds_read_b64_tr_b16 v[92:93], v161 offset:2048
    ds_read_b64_tr_b16 v[94:95], v161 offset:2560
    ds_read_b128 v[100:103], v163
    ds_read_b64_tr_b16 v[36:37], v181 offset:29696
    ds_read_b64_tr_b16 v[38:39], v181 offset:29952
    v_mfma_f32_32x32x16_bf16 v[120:135], v[108:111], v[116:119], v[120:135]
    v_mfma_f32_32x32x16_bf16 v[72:87], v[116:119], v[44:47], v[72:87]
    ds_read_b64_tr_b16 v[104:105], v161 offset:4096
    ds_read_b64_tr_b16 v[106:107], v161 offset:4608
    ds_read_b128 v[112:115], v164
    ds_read_b64_tr_b16 v[40:41], v181 offset:30720
    ds_read_b64_tr_b16 v[42:43], v181 offset:30976
    ds_read_b64_tr_b16 v[108:109], v161 offset:6144
    ds_read_b64_tr_b16 v[110:111], v161 offset:6656
    ds_read_b128 v[116:119], v165
    ds_read_b64_tr_b16 v[44:45], v181 offset:31744
    ds_read_b64_tr_b16 v[46:47], v181 offset:32000
    s_waitcnt lgkmcnt(10)
    v_mfma_f32_32x32x16_bf16 v[120:135], v[88:91], v[96:99], v[120:135]
    v_mfma_f32_32x32x16_bf16 v[72:87], v[96:99], v[32:35], v[72:87]
    v_mfma_f32_32x32x16_bf16 v[120:135], v[92:95], v[100:103], v[120:135]
    v_mfma_f32_32x32x16_bf16 v[72:87], v[100:103], v[36:39], v[72:87]
    s_waitcnt lgkmcnt(0)
    v_mfma_f32_32x32x16_bf16 v[120:135], v[104:107], v[112:115], v[120:135]
    v_mfma_f32_32x32x16_bf16 v[72:87], v[112:115], v[40:43], v[72:87]
    s_waitcnt vmcnt(4)
    s_barrier
    ds_read_b64_tr_b16 v[88:89], v166 offset:0
    ds_read_b64_tr_b16 v[90:91], v166 offset:512
    ds_read_b128 v[96:99], v167
    ds_read_b64_tr_b16 v[32:33], v182 offset:0
    ds_read_b64_tr_b16 v[34:35], v182 offset:256
    ds_read_b64_tr_b16 v[92:93], v166 offset:2048
    ds_read_b64_tr_b16 v[94:95], v166 offset:2560
    ds_read_b128 v[100:103], v168
    ds_read_b64_tr_b16 v[36:37], v182 offset:1024
    ds_read_b64_tr_b16 v[38:39], v182 offset:1280
    v_mfma_f32_32x32x16_bf16 v[120:135], v[108:111], v[116:119], v[120:135]
    v_mfma_f32_32x32x16_bf16 v[72:87], v[116:119], v[44:47], v[72:87]
    ds_read_b64_tr_b16 v[104:105], v166 offset:4096
    ds_read_b64_tr_b16 v[106:107], v166 offset:4608
    ds_read_b128 v[112:115], v169
    ds_read_b64_tr_b16 v[40:41], v182 offset:2048
    ds_read_b64_tr_b16 v[42:43], v182 offset:2304
    ds_read_b64_tr_b16 v[108:109], v166 offset:6144
    ds_read_b64_tr_b16 v[110:111], v166 offset:6656
    ds_read_b128 v[116:119], v170
    ds_read_b64_tr_b16 v[44:45], v182 offset:3072
    ds_read_b64_tr_b16 v[46:47], v182 offset:3328
    s_waitcnt lgkmcnt(10)
    v_mfma_f32_32x32x16_bf16 v[120:135], v[88:91], v[96:99], v[120:135]
    v_mfma_f32_32x32x16_bf16 v[72:87], v[96:99], v[32:35], v[72:87]
    v_mfma_f32_32x32x16_bf16 v[120:135], v[92:95], v[100:103], v[120:135]
    v_mfma_f32_32x32x16_bf16 v[72:87], v[100:103], v[36:39], v[72:87]
    s_waitcnt lgkmcnt(0)
    v_mfma_f32_32x32x16_bf16 v[120:135], v[104:107], v[112:115], v[120:135]
    v_mfma_f32_32x32x16_bf16 v[72:87], v[112:115], v[40:43], v[72:87]
    s_waitcnt vmcnt(0)
    s_barrier
    ds_read_b64_tr_b16 v[88:89], v171 offset:0
    ds_read_b64_tr_b16 v[90:91], v171 offset:512
    ds_read_b128 v[96:99], v172
    ds_read_b64_tr_b16 v[32:33], v182 offset:28672
    ds_read_b64_tr_b16 v[34:35], v182 offset:28928
    ds_read_b64_tr_b16 v[92:93], v171 offset:2048
    ds_read_b64_tr_b16 v[94:95], v171 offset:2560
    ds_read_b128 v[100:103], v173
    ds_read_b64_tr_b16 v[36:37], v182 offset:29696
    ds_read_b64_tr_b16 v[38:39], v182 offset:29952
    v_mfma_f32_32x32x16_bf16 v[120:135], v[108:111], v[116:119], v[120:135]
    v_mfma_f32_32x32x16_bf16 v[72:87], v[116:119], v[44:47], v[72:87]
    v_lshlrev_b32 v6, 5, v2
    s_lshr_b32 s31, s2, 6
    s_lshl_b32 s31, s31, 5
    s_and_b32 s23, s2, 31
    s_add_u32 s31, s31, s23
    s_bitcmp0_b32 s2, 5
    s_cbranch_scc1 L_sj_emvPV
    s_lshl_b32 s64, s31, 3
    s_add_u32 s64, s64, s22
    s_sub_u32 s31, 2048, s64
    s_lshl_b32 s23, s64, 11
    s_lshl_b32 s31, s31, 11
    s_mov_b32 s19, 1048576
    buffer_load_dwordx4 v[200:203], v6, s[80:83], s23 offen
    buffer_load_dwordx4 v[204:207], v6, s[80:83], s23 offen offset:16
    buffer_load_dwordx4 v[208:211], v6, s[80:83], s31 offen
    buffer_load_dwordx4 v[212:215], v6, s[80:83], s31 offen offset:16
    buffer_load_dwordx4 v[216:219], v6, s[84:87], s19 offen
    buffer_load_dwordx4 v[220:223], v6, s[84:87], s19 offen offset:16
    s_branch L_sj_1PV
L_sj_emvPV:
    s_lshl_b32 s64, s31, 2
    s_add_u32 s64, s64, s22
    s_cmp_ge_u32 s22, 4
    s_cselect_b32 s64, 0x10000, s64
    s_lshl_b32 s31, s31, 3
    s_add_u32 s31, s31, s22
    s_cmp_eq_u32 s31, 4
    s_cselect_b32 s64, 512, s64
    s_lshl_b32 s23, s64, 11
    s_mov_b32 s19, 2097152
    buffer_load_dwordx4 v[200:203], v6, s[84:87], s23 offen
    buffer_load_dwordx4 v[204:207], v6, s[84:87], s23 offen offset:16
    buffer_load_dwordx4 v[216:219], v6, s[80:83], s19 offen
    buffer_load_dwordx4 v[220:223], v6, s[80:83], s19 offen offset:16
L_sj_1PV:
    ds_read_b64_tr_b16 v[104:105], v171 offset:4096
    ds_read_b64_tr_b16 v[106:107], v171 offset:4608
    ds_read_b128 v[112:115], v174
    ds_read_b64_tr_b16 v[40:41], v182 offset:30720
    ds_read_b64_tr_b16 v[42:43], v182 offset:30976
    ds_read_b64_tr_b16 v[108:109], v171 offset:6144
    ds_read_b64_tr_b16 v[110:111], v171 offset:6656
    ds_read_b128 v[116:119], v175
    ds_read_b64_tr_b16 v[44:45], v182 offset:31744
    ds_read_b64_tr_b16 v[46:47], v182 offset:32000
    s_waitcnt lgkmcnt(10)
    v_mfma_f32_32x32x16_bf16 v[120:135], v[88:91], v[96:99], v[120:135]
    v_mfma_f32_32x32x16_bf16 v[72:87], v[96:99], v[32:35], v[72:87]
    v_mfma_f32_32x32x16_bf16 v[120:135], v[92:95], v[100:103], v[120:135]
    v_mfma_f32_32x32x16_bf16 v[72:87], v[100:103], v[36:39], v[72:87]
    s_waitcnt lgkmcnt(0)
    v_mfma_f32_32x32x16_bf16 v[120:135], v[104:107], v[112:115], v[120:135]
    v_mfma_f32_32x32x16_bf16 v[72:87], v[112:115], v[40:43], v[72:87]
    v_mfma_f32_32x32x16_bf16 v[120:135], v[108:111], v[116:119], v[120:135]
    v_mfma_f32_32x32x16_bf16 v[72:87], v[116:119], v[44:47], v[72:87]
    s_mov_b32 s23, 1048744942
    s_nop 11
    v_cvt_pk_bf16_f32 v88, v72, v73
    v_cvt_pk_bf16_f32 v89, v74, v75
    v_cvt_pk_bf16_f32 v90, v76, v77
    v_cvt_pk_bf16_f32 v91, v78, v79
    v_cvt_pk_bf16_f32 v92, v80, v81
    v_cvt_pk_bf16_f32 v93, v82, v83
    v_cvt_pk_bf16_f32 v94, v84, v85
    v_cvt_pk_bf16_f32 v95, v86, v87
    v_add_u32 v3, s24, v9
    buffer_store_dwordx4 v[88:91], v3, s[12:15], 0 offen offset:2048
    buffer_store_dwordx4 v[92:95], v3, s[12:15], 0 offen offset:3072
    v_mul_f32 v120, s23, v120
    v_mul_f32 v121, s23, v121
    v_mul_f32 v122, s23, v122
    v_mul_f32 v123, s23, v123
    v_mul_f32 v124, s23, v124
    v_mul_f32 v125, s23, v125
    v_mul_f32 v126, s23, v126
    v_mul_f32 v127, s23, v127
    v_mul_f32 v128, s23, v128
    v_mul_f32 v129, s23, v129
    v_mul_f32 v130, s23, v130
    v_mul_f32 v131, s23, v131
    v_mul_f32 v132, s23, v132
    v_mul_f32 v133, s23, v133
    v_mul_f32 v134, s23, v134
    v_mul_f32 v135, s23, v135
    v_cvt_pk_bf16_f32 v16, v120, v121
    v_cvt_pk_bf16_f32 v17, v122, v123
    v_cvt_pk_bf16_f32 v18, v124, v125
    v_cvt_pk_bf16_f32 v19, v126, v127
    v_cvt_pk_bf16_f32 v20, v128, v129
    v_cvt_pk_bf16_f32 v21, v130, v131
    v_cvt_pk_bf16_f32 v22, v132, v133
    v_cvt_pk_bf16_f32 v23, v134, v135
    buffer_store_dwordx4 v[16:19], v9, s[12:15], s26 offen
    buffer_store_dwordx4 v[20:23], v9, s[12:15], s26 offen offset:1024
    s_waitcnt vmcnt(4)
    v_lshlrev_b32 v6, 5, v2
    v_mov_b32 v7, 0
    s_bitcmp0_b32 s2, 5
    s_cbranch_scc1 L_sj_emv2PV
    v_lshlrev_b32 v240, 16, v200
    v_and_b32 v241, 0xffff0000, v200
    v_lshlrev_b32 v242, 16, v208
    v_and_b32 v243, 0xffff0000, v208
    v_add_f32 v244, v240, v242
    v_add_f32 v245, v241, v243
    v_sub_f32 v246, v240, v242
    v_sub_f32 v247, v241, v243
    v_cvt_pk_bf16_f32 v224, v244, v245
    v_cvt_pk_bf16_f32 v232, v246, v247
    v_dot2c_f32_bf16 v7, v224, v216
    v_lshlrev_b32 v240, 16, v201
    v_and_b32 v241, 0xffff0000, v201
    v_lshlrev_b32 v242, 16, v209
    v_and_b32 v243, 0xffff0000, v209
    v_add_f32 v244, v240, v242
    v_add_f32 v245, v241, v243
    v_sub_f32 v246, v240, v242
    v_sub_f32 v247, v241, v243
    v_cvt_pk_bf16_f32 v225, v244, v245
    v_cvt_pk_bf16_f32 v233, v246, v247
    v_dot2c_f32_bf16 v7, v225, v217
    v_lshlrev_b32 v240, 16, v202
    v_and_b32 v241, 0xffff0000, v202
    v_lshlrev_b32 v242, 16, v210
    v_and_b32 v243, 0xffff0000, v210
    v_add_f32 v244, v240, v242
    v_add_f32 v245, v241, v243
    v_sub_f32 v246, v240, v242
    v_sub_f32 v247, v241, v243
    v_cvt_pk_bf16_f32 v226, v244, v245
    v_cvt_pk_bf16_f32 v234, v246, v247
    v_dot2c_f32_bf16 v7, v226, v218
    v_lshlrev_b32 v240, 16, v203
    v_and_b32 v241, 0xffff0000, v203
    v_lshlrev_b32 v242, 16, v211
    v_and_b32 v243, 0xffff0000, v211
    v_add_f32 v244, v240, v242
    v_add_f32 v245, v241, v243
    v_sub_f32 v246, v240, v242
    v_sub_f32 v247, v241, v243
    v_cvt_pk_bf16_f32 v227, v244, v245
    v_cvt_pk_bf16_f32 v235, v246, v247
    v_dot2c_f32_bf16 v7, v227, v219
    v_lshlrev_b32 v240, 16, v204
    v_and_b32 v241, 0xffff0000, v204
    v_lshlrev_b32 v242, 16, v212
    v_and_b32 v243, 0xffff0000, v212
    v_add_f32 v244, v240, v242
    v_add_f32 v245, v241, v243
    v_sub_f32 v246, v240, v242
    v_sub_f32 v247, v241, v243
    v_cvt_pk_bf16_f32 v228, v244, v245
    v_cvt_pk_bf16_f32 v236, v246, v247
    v_dot2c_f32_bf16 v7, v228, v220
    v_lshlrev_b32 v240, 16, v205
    v_and_b32 v241, 0xffff0000, v205
    v_lshlrev_b32 v242, 16, v213
    v_and_b32 v243, 0xffff0000, v213
    v_add_f32 v244, v240, v242
    v_add_f32 v245, v241, v243
    v_sub_f32 v246, v240, v242
    v_sub_f32 v247, v241, v243
    v_cvt_pk_bf16_f32 v229, v244, v245
    v_cvt_pk_bf16_f32 v237, v246, v247
    v_dot2c_f32_bf16 v7, v229, v221
    v_lshlrev_b32 v240, 16, v206
    v_and_b32 v241, 0xffff0000, v206
    v_lshlrev_b32 v242, 16, v214
    v_and_b32 v243, 0xffff0000, v214
    v_add_f32 v244, v240, v242
    v_add_f32 v245, v241, v243
    v_sub_f32 v246, v240, v242
    v_sub_f32 v247, v241, v243
    v_cvt_pk_bf16_f32 v230, v244, v245
    v_cvt_pk_bf16_f32 v238, v246, v247
    v_dot2c_f32_bf16 v7, v230, v222
    v_lshlrev_b32 v240, 16, v207
    v_and_b32 v241, 0xffff0000, v207
    v_lshlrev_b32 v242, 16, v215
    v_and_b32 v243, 0xffff0000, v215
    v_add_f32 v244, v240, v242
    v_add_f32 v245, v241, v243
    v_sub_f32 v246, v240, v242
    v_sub_f32 v247, v241, v243
    v_cvt_pk_bf16_f32 v231, v244, v245
    v_cvt_pk_bf16_f32 v239, v246, v247
    v_dot2c_f32_bf16 v7, v231, v223
    s_lshl_b32 s23, s64, 11
    s_add_u32 s31, s23, 30408704
    s_add_u32 s23, s23, 27262976
    buffer_store_dwordx4 v[224:227], v6, s[12:15], s23 offen
    buffer_store_dwordx4 v[228:231], v6, s[12:15], s23 offen offset:16
    buffer_store_dwordx4 v[232:235], v6, s[12:15], s31 offen
    buffer_store_dwordx4 v[236:239], v6, s[12:15], s31 offen offset:16
    s_nop 1
    v_add_f32_dpp v7, v7, v7 row_ror:8 row_mask:0xf bank_mask:0xf
    s_nop 1
    v_add_f32_dpp v7, v7, v7 row_ror:4 row_mask:0xf bank_mask:0xf
    s_nop 1
    v_add_f32_dpp v7, v7, v7 row_ror:2 row_mask:0xf bank_mask:0xf
    s_nop 1
    v_add_f32_dpp v7, v7, v7 row_ror:1 row_mask:0xf bank_mask:0xf
    v_mov_b32 v3, v7
    s_nop 1
    v_permlane16_swap_b32 v7, v3
    s_nop 1
    v_add_f32 v7, v7, v3
    v_mov_b32 v3, v7
    s_nop 1
    v_permlane32_swap_b32 v7, v3
    s_nop 1
    v_add_f32 v7, v7, v3
    v_cvt_pk_bf16_f32 v7, v7, v7
    s_lshl_b32 s23, s64, 1
    s_add_u32 s23, s23, 34668544
    v_mov_b32 v4, 0
    s_mov_b64 exec, 1
    buffer_store_short v7, v4, s[12:15], s23 offen
    s_mov_b64 exec, -1
    s_branch L_sj_donePV
L_sj_emv2PV:
    s_cmp_gt_u32 s64, 512
    s_cbranch_scc1 L_sj_donePV
    v_dot2c_f32_bf16 v7, v200, v216
    v_dot2c_f32_bf16 v7, v201, v217
    v_dot2c_f32_bf16 v7, v202, v218
    v_dot2c_f32_bf16 v7, v203, v219
    v_dot2c_f32_bf16 v7, v204, v220
    v_dot2c_f32_bf16 v7, v205, v221
    v_dot2c_f32_bf16 v7, v206, v222
    v_dot2c_f32_bf16 v7, v207, v223
    s_nop 3
    s_nop 1
    v_add_f32_dpp v7, v7, v7 row_ror:8 row_mask:0xf bank_mask:0xf
    s_nop 1
    v_add_f32_dpp v7, v7, v7 row_ror:4 row_mask:0xf bank_mask:0xf
    s_nop 1
    v_add_f32_dpp v7, v7, v7 row_ror:2 row_mask:0xf bank_mask:0xf
    s_nop 1
    v_add_f32_dpp v7, v7, v7 row_ror:1 row_mask:0xf bank_mask:0xf
    v_mov_b32 v3, v7
    s_nop 1
    v_permlane16_swap_b32 v7, v3
    s_nop 1
    v_add_f32 v7, v7, v3
    v_mov_b32 v3, v7
    s_nop 1
    v_permlane32_swap_b32 v7, v3
    s_nop 1
    v_add_f32 v7, v7, v3
    v_mov_b32 v5, 0
    v_cvt_pk_bf16_f32 v7, v7, v5
    v_cmp_eq_u32 vcc, 0, v2
    s_mul_i32 s23, s64, 2176
    s_add_u32 s31, s23, 35653632
    s_add_u32 s23, s23, 33556480
    v_cndmask_b32 v7, v5, v7, vcc
    v_lshlrev_b32 v4, 2, v2
    s_mov_b32 exec_hi, 0
    buffer_store_dword v7, v4, s[12:15], s23 offen
    buffer_store_dword v5, v4, s[12:15], s31 offen
    s_mov_b64 exec, -1
L_sj_donePV:
    s_branch L_qg_done
L_qg_F:
    s_add_u32 s16, s16, s17
    s_add_u32 s16, s16, s17
    s_add_u32 s16, s16, s17
    v_mov_b32 v248, 0
    s_lshr_b32 s23, s2, 3
    s_lshl_b32 s30, s23, 15
    s_and_b32 s31, s2, 3
    s_lshl_b32 s31, s31, 20
    s_add_u32 s30, s30, s31
    s_add_u32 s30, s30, 512
    v_lshlrev_b32 v251, 7, v2
    v_lshrrev_b32 v4, 2, v2
    v_and_b32 v5, 3, v2
    v_lshlrev_b32 v5, 7, v5
    v_lshl_add_u32 v252, v4, 11, v5
    v_lshrrev_b32 v4, 3, v2
    v_and_b32 v5, 7, v2
    v_lshlrev_b32 v5, 7, v5
    v_lshl_add_u32 v253, v4, 11, v5
    s_lshl_b32 s31, s23, 14
    s_and_b32 s23, s2, 4
    s_lshl_b32 s23, s23, 8
    s_add_u32 s31, s31, s23
    s_add_u32 s31, s31, 524288
    s_mov_b32 s100, s30
    s_mov_b32 s101, s31
    s_cmp_lg_u32 s22, 7
    s_cbranch_scc1 L_not7
    s_and_b32 s54, s2, 127
    s_lshl_b32 s54, s54, 13
    s_lshr_b32 s23, s2, 3
    s_and_b32 s23, s23, 7
    s_lshl_b32 s23, s23, 13
    buffer_load_dword v249, v251, s[96:99], s23 offen
    buffer_load_dword v249, v252, s[44:47], s100 offen
    s_add_u32 s100, s100, 512
    buffer_load_dword v249, v253, s[36:39], s101 offen
    s_add_u32 s101, s101, 524288
    buffer_load_dword v249, v252, s[44:47], s100 offen
    s_add_u32 s100, s100, 512
    buffer_load_dword v249, v253, s[36:39], s101 offen
    s_add_u32 s101, s101, 524288
    buffer_load_dword v249, v252, s[44:47], s100 offen
    s_add_u32 s100, s100, 512
    buffer_load_dword v249, v253, s[36:39], s101 offen
    s_add_u32 s101, s101, 524288
L_not7:
    v_lshlrev_b32 v9, 4, v2
    v_bfe_u32 v3, v2, 2, 2
    v_lshrrev_b32 v4, 5, v2
    v_lshl_add_u32 v4, v4, 3, v3
    v_bfe_u32 v5, v2, 4, 1
    v_and_b32 v6, 3, v2
    v_lshlrev_b32 v6, 3, v6
    v_lshl_add_u32 v6, v5, 5, v6
    v_lshl_add_u32 v7, v4, 6, v6
    v_lshl_add_u32 v4, v4, 7, v6
    v_lshrrev_b32 v3, 1, v3
    v_lshrrev_b32 v5, 2, v1
    v_xor_b32 v3, v3, v5
    v_lshl_add_u32 v4, v3, 6, v4
    v_add_u32 v181, 24576, v7
    v_add_u32 v182, 81920, v7
    v_add_u32 v183, 139264, v7
    v_add_u32 v156, 0, v4
    v_add_u32 v161, 28672, v4
    v_add_u32 v166, 57344, v4
    v_add_u32 v171, 86016, v4
    s_mov_b32 s27, 0
    s_and_b32 s25, s22, 3
    s_lshl_b32 s25, s25, 5
    v_and_b32 v3, 31, v2
    v_bfe_u32 v4, v3, 1, 3
    v_lshrrev_b32 v5, 5, v2
    v_xor_b32 v4, v4, v5
    v_xor_b32 v4, s27, v4
    v_add_u32 v3, s25, v3
    v_lshlrev_b32 v3, 7, v3
    v_lshl_add_u32 v3, v4, 4, v3
    v_add_u32 v157, 8192, v3
    v_xor_b32 v158, 32, v157
    v_xor_b32 v159, 64, v157
    v_xor_b32 v160, 96, v157
    v_add_u32 v162, 36864, v3
    v_xor_b32 v163, 32, v162
    v_xor_b32 v164, 64, v162
    v_xor_b32 v165, 96, v162
    v_add_u32 v167, 65536, v3
    v_xor_b32 v168, 32, v167
    v_xor_b32 v169, 64, v167
    v_xor_b32 v170, 96, v167
    v_add_u32 v172, 94208, v3
    v_xor_b32 v173, 32, v172
    v_xor_b32 v174, 64, v172
    v_xor_b32 v175, 96, v172
    v_mov_b32 v120, 0
    v_mov_b32 v121, 0
    v_mov_b32 v122, 0
    v_mov_b32 v123, 0
    v_mov_b32 v124, 0
    v_mov_b32 v125, 0
    v_mov_b32 v126, 0
    v_mov_b32 v127, 0
    v_mov_b32 v128, 0
    v_mov_b32 v129, 0
    v_mov_b32 v130, 0
    v_mov_b32 v131, 0
    v_mov_b32 v132, 0
    v_mov_b32 v133, 0
    v_mov_b32 v134, 0
    v_mov_b32 v135, 0
    s_barrier
    ds_read_b64_tr_b16 v[88:89], v156 offset:0
    ds_read_b64_tr_b16 v[90:91], v156 offset:512
    ds_read_b128 v[96:99], v157
    ds_read_b64_tr_b16 v[92:93], v156 offset:2048
    ds_read_b64_tr_b16 v[94:95], v156 offset:2560
    ds_read_b128 v[100:103], v158
    ds_read_b64_tr_b16 v[104:105], v156 offset:4096
    ds_read_b64_tr_b16 v[106:107], v156 offset:4608
    ds_read_b128 v[112:115], v159
    ds_read_b64_tr_b16 v[108:109], v156 offset:6144
    ds_read_b64_tr_b16 v[110:111], v156 offset:6656
    ds_read_b128 v[116:119], v160
    s_waitcnt lgkmcnt(6)
    v_mfma_f32_32x32x16_bf16 v[120:135], v[88:91], v[96:99], v[120:135]
    v_mfma_f32_32x32x16_bf16 v[120:135], v[92:95], v[100:103], v[120:135]
    s_waitcnt lgkmcnt(0)
    v_mfma_f32_32x32x16_bf16 v[120:135], v[104:107], v[112:115], v[120:135]
    s_add_u32 s16, s16, s17
    s_barrier
    ds_read_b64_tr_b16 v[88:89], v161 offset:0
    ds_read_b64_tr_b16 v[90:91], v161 offset:512
    ds_read_b128 v[96:99], v162
    ds_read_b64_tr_b16 v[92:93], v161 offset:2048
    ds_read_b64_tr_b16 v[94:95], v161 offset:2560
    ds_read_b128 v[100:103], v163
    v_mfma_f32_32x32x16_bf16 v[120:135], v[108:111], v[116:119], v[120:135]
    ds_read_b64_tr_b16 v[104:105], v161 offset:4096
    ds_read_b64_tr_b16 v[106:107], v161 offset:4608
    ds_read_b128 v[112:115], v164
    ds_read_b64_tr_b16 v[108:109], v161 offset:6144
    ds_read_b64_tr_b16 v[110:111], v161 offset:6656
    ds_read_b128 v[116:119], v165
    s_waitcnt lgkmcnt(6)
    v_mfma_f32_32x32x16_bf16 v[120:135], v[88:91], v[96:99], v[120:135]
    v_mfma_f32_32x32x16_bf16 v[120:135], v[92:95], v[100:103], v[120:135]
    s_waitcnt lgkmcnt(0)
    v_mfma_f32_32x32x16_bf16 v[120:135], v[104:107], v[112:115], v[120:135]
    s_add_u32 s16, s16, s17
    s_barrier
    ds_read_b64_tr_b16 v[88:89], v166 offset:0
    ds_read_b64_tr_b16 v[90:91], v166 offset:512
    ds_read_b128 v[96:99], v167
    ds_read_b64_tr_b16 v[92:93], v166 offset:2048
    ds_read_b64_tr_b16 v[94:95], v166 offset:2560
    ds_read_b128 v[100:103], v168
    v_mfma_f32_32x32x16_bf16 v[120:135], v[108:111], v[116:119], v[120:135]
    ds_read_b64_tr_b16 v[104:105], v166 offset:4096
    ds_read_b64_tr_b16 v[106:107], v166 offset:4608
    ds_read_b128 v[112:115], v169
    ds_read_b64_tr_b16 v[108:109], v166 offset:6144
    ds_read_b64_tr_b16 v[110:111], v166 offset:6656
    ds_read_b128 v[116:119], v170
    s_waitcnt lgkmcnt(6)
    v_mfma_f32_32x32x16_bf16 v[120:135], v[88:91], v[96:99], v[120:135]
    v_mfma_f32_32x32x16_bf16 v[120:135], v[92:95], v[100:103], v[120:135]
    s_waitcnt lgkmcnt(0)
    v_mfma_f32_32x32x16_bf16 v[120:135], v[104:107], v[112:115], v[120:135]
    s_add_u32 s16, s16, s17
    s_barrier
    ds_read_b64_tr_b16 v[88:89], v171 offset:0
    ds_read_b64_tr_b16 v[90:91], v171 offset:512
    ds_read_b128 v[96:99], v172
    ds_read_b64_tr_b16 v[92:93], v171 offset:2048
    ds_read_b64_tr_b16 v[94:95], v171 offset:2560
    ds_read_b128 v[100:103], v173
    v_mfma_f32_32x32x16_bf16 v[120:135], v[108:111], v[116:119], v[120:135]
    ds_read_b64_tr_b16 v[104:105], v171 offset:4096
    ds_read_b64_tr_b16 v[106:107], v171 offset:4608
    ds_read_b128 v[112:115], v174
    ds_read_b64_tr_b16 v[108:109], v171 offset:6144
    ds_read_b64_tr_b16 v[110:111], v171 offset:6656
    ds_read_b128 v[116:119], v175
    s_waitcnt lgkmcnt(6)
    v_mfma_f32_32x32x16_bf16 v[120:135], v[88:91], v[96:99], v[120:135]
    v_mfma_f32_32x32x16_bf16 v[120:135], v[92:95], v[100:103], v[120:135]
    s_waitcnt lgkmcnt(0)
    v_mfma_f32_32x32x16_bf16 v[120:135], v[104:107], v[112:115], v[120:135]
    s_add_u32 s16, s16, s17
    s_barrier
    ds_read_b64_tr_b16 v[88:89], v156 offset:0
    ds_read_b64_tr_b16 v[90:91], v156 offset:512
    ds_read_b128 v[96:99], v157
    ds_read_b64_tr_b16 v[92:93], v156 offset:2048
    ds_read_b64_tr_b16 v[94:95], v156 offset:2560
    ds_read_b128 v[100:103], v158
    v_mfma_f32_32x32x16_bf16 v[120:135], v[108:111], v[116:119], v[120:135]
    ds_read_b64_tr_b16 v[104:105], v156 offset:4096
    ds_read_b64_tr_b16 v[106:107], v156 offset:4608
    ds_read_b128 v[112:115], v159
    ds_read_b64_tr_b16 v[108:109], v156 offset:6144
    ds_read_b64_tr_b16 v[110:111], v156 offset:6656
    ds_read_b128 v[116:119], v160
    s_waitcnt lgkmcnt(6)
    v_mfma_f32_32x32x16_bf16 v[120:135], v[88:91], v[96:99], v[120:135]
    v_mfma_f32_32x32x16_bf16 v[120:135], v[92:95], v[100:103], v[120:135]
    s_waitcnt lgkmcnt(0)
    v_mfma_f32_32x32x16_bf16 v[120:135], v[104:107], v[112:115], v[120:135]
    s_add_u32 s16, s16, s17
    s_barrier
    ds_read_b64_tr_b16 v[88:89], v161 offset:0
    ds_read_b64_tr_b16 v[90:91], v161 offset:512
    ds_read_b128 v[96:99], v162
    ds_read_b64_tr_b16 v[92:93], v161 offset:2048
    ds_read_b64_tr_b16 v[94:95], v161 offset:2560
    ds_read_b128 v[100:103], v163
    v_mfma_f32_32x32x16_bf16 v[120:135], v[108:111], v[116:119], v[120:135]
    ds_read_b64_tr_b16 v[104:105], v161 offset:4096
    ds_read_b64_tr_b16 v[106:107], v161 offset:4608
    ds_read_b128 v[112:115], v164
    ds_read_b64_tr_b16 v[108:109], v161 offset:6144
    ds_read_b64_tr_b16 v[110:111], v161 offset:6656
    ds_read_b128 v[116:119], v165
    s_waitcnt lgkmcnt(6)
    v_mfma_f32_32x32x16_bf16 v[120:135], v[88:91], v[96:99], v[120:135]
    v_mfma_f32_32x32x16_bf16 v[120:135], v[92:95], v[100:103], v[120:135]
    s_waitcnt lgkmcnt(0)
    v_mfma_f32_32x32x16_bf16 v[120:135], v[104:107], v[112:115], v[120:135]
    s_add_u32 s16, s16, s17
    s_barrier
    ds_read_b64_tr_b16 v[88:89], v166 offset:0
    ds_read_b64_tr_b16 v[90:91], v166 offset:512
    ds_read_b128 v[96:99], v167
    ds_read_b64_tr_b16 v[92:93], v166 offset:2048
    ds_read_b64_tr_b16 v[94:95], v166 offset:2560
    ds_read_b128 v[100:103], v168
    v_mfma_f32_32x32x16_bf16 v[120:135], v[108:111], v[116:119], v[120:135]
    ds_read_b64_tr_b16 v[104:105], v166 offset:4096
    ds_read_b64_tr_b16 v[106:107], v166 offset:4608
    ds_read_b128 v[112:115], v169
    ds_read_b64_tr_b16 v[108:109], v166 offset:6144
    ds_read_b64_tr_b16 v[110:111], v166 offset:6656
    ds_read_b128 v[116:119], v170
    s_waitcnt lgkmcnt(6)
    v_mfma_f32_32x32x16_bf16 v[120:135], v[88:91], v[96:99], v[120:135]
    v_mfma_f32_32x32x16_bf16 v[120:135], v[92:95], v[100:103], v[120:135]
    s_waitcnt lgkmcnt(0)
    v_mfma_f32_32x32x16_bf16 v[120:135], v[104:107], v[112:115], v[120:135]
    s_add_u32 s16, s16, s17
    s_barrier
    ds_read_b64_tr_b16 v[88:89], v171 offset:0
    ds_read_b64_tr_b16 v[90:91], v171 offset:512
    ds_read_b128 v[96:99], v172
    ds_read_b64_tr_b16 v[92:93], v171 offset:2048
    ds_read_b64_tr_b16 v[94:95], v171 offset:2560
    ds_read_b128 v[100:103], v173
    v_mfma_f32_32x32x16_bf16 v[120:135], v[108:111], v[116:119], v[120:135]
    ds_read_b64_tr_b16 v[104:105], v171 offset:4096
    ds_read_b64_tr_b16 v[106:107], v171 offset:4608
    ds_read_b128 v[112:115], v174
    ds_read_b64_tr_b16 v[108:109], v171 offset:6144
    ds_read_b64_tr_b16 v[110:111], v171 offset:6656
    ds_read_b128 v[116:119], v175
    s_waitcnt lgkmcnt(6)
    v_mfma_f32_32x32x16_bf16 v[120:135], v[88:91], v[96:99], v[120:135]
    v_mfma_f32_32x32x16_bf16 v[120:135], v[92:95], v[100:103], v[120:135]
    s_waitcnt lgkmcnt(0)
    v_mfma_f32_32x32x16_bf16 v[120:135], v[104:107], v[112:115], v[120:135]
    s_add_u32 s16, s16, s17
    s_barrier
    ds_read_b64_tr_b16 v[88:89], v156 offset:0
    ds_read_b64_tr_b16 v[90:91], v156 offset:512
    ds_read_b128 v[96:99], v157
    ds_read_b64_tr_b16 v[92:93], v156 offset:2048
    ds_read_b64_tr_b16 v[94:95], v156 offset:2560
    ds_read_b128 v[100:103], v158
    v_mfma_f32_32x32x16_bf16 v[120:135], v[108:111], v[116:119], v[120:135]
    ds_read_b64_tr_b16 v[104:105], v156 offset:4096
    ds_read_b64_tr_b16 v[106:107], v156 offset:4608
    ds_read_b128 v[112:115], v159
    ds_read_b64_tr_b16 v[108:109], v156 offset:6144
    ds_read_b64_tr_b16 v[110:111], v156 offset:6656
    ds_read_b128 v[116:119], v160
    s_waitcnt lgkmcnt(6)
    v_mfma_f32_32x32x16_bf16 v[120:135], v[88:91], v[96:99], v[120:135]
    v_mfma_f32_32x32x16_bf16 v[120:135], v[92:95], v[100:103], v[120:135]
    s_waitcnt lgkmcnt(0)
    v_mfma_f32_32x32x16_bf16 v[120:135], v[104:107], v[112:115], v[120:135]
    s_add_u32 s16, s16, s17
    s_barrier
    ds_read_b64_tr_b16 v[88:89], v161 offset:0
    ds_read_b64_tr_b16 v[90:91], v161 offset:512
    ds_read_b128 v[96:99], v162
    ds_read_b64_tr_b16 v[92:93], v161 offset:2048
    ds_read_b64_tr_b16 v[94:95], v161 offset:2560
    ds_read_b128 v[100:103], v163
    v_mfma_f32_32x32x16_bf16 v[120:135], v[108:111], v[116:119], v[120:135]
    ds_read_b64_tr_b16 v[104:105], v161 offset:4096
    ds_read_b64_tr_b16 v[106:107], v161 offset:4608
    ds_read_b128 v[112:115], v164
    ds_read_b64_tr_b16 v[108:109], v161 offset:6144
    ds_read_b64_tr_b16 v[110:111], v161 offset:6656
    ds_read_b128 v[116:119], v165
    s_waitcnt lgkmcnt(6)
    v_mfma_f32_32x32x16_bf16 v[120:135], v[88:91], v[96:99], v[120:135]
    v_mfma_f32_32x32x16_bf16 v[120:135], v[92:95], v[100:103], v[120:135]
    s_waitcnt lgkmcnt(0)
    v_mfma_f32_32x32x16_bf16 v[120:135], v[104:107], v[112:115], v[120:135]
    s_add_u32 s16, s16, s17
    s_barrier
    ds_read_b64_tr_b16 v[88:89], v166 offset:0
    ds_read_b64_tr_b16 v[90:91], v166 offset:512
    ds_read_b128 v[96:99], v167
    ds_read_b64_tr_b16 v[92:93], v166 offset:2048
    ds_read_b64_tr_b16 v[94:95], v166 offset:2560
    ds_read_b128 v[100:103], v168
    v_mfma_f32_32x32x16_bf16 v[120:135], v[108:111], v[116:119], v[120:135]
    ds_read_b64_tr_b16 v[104:105], v166 offset:4096
    ds_read_b64_tr_b16 v[106:107], v166 offset:4608
    ds_read_b128 v[112:115], v169
    ds_read_b64_tr_b16 v[108:109], v166 offset:6144
    ds_read_b64_tr_b16 v[110:111], v166 offset:6656
    ds_read_b128 v[116:119], v170
    s_waitcnt lgkmcnt(6)
    v_mfma_f32_32x32x16_bf16 v[120:135], v[88:91], v[96:99], v[120:135]
    v_mfma_f32_32x32x16_bf16 v[120:135], v[92:95], v[100:103], v[120:135]
    s_waitcnt lgkmcnt(0)
    v_mfma_f32_32x32x16_bf16 v[120:135], v[104:107], v[112:115], v[120:135]
    s_add_u32 s16, s16, s17
    s_barrier
    ds_read_b64_tr_b16 v[88:89], v171 offset:0
    ds_read_b64_tr_b16 v[90:91], v171 offset:512
    ds_read_b128 v[96:99], v172
    ds_read_b64_tr_b16 v[92:93], v171 offset:2048
    ds_read_b64_tr_b16 v[94:95], v171 offset:2560
    ds_read_b128 v[100:103], v173
    v_mfma_f32_32x32x16_bf16 v[120:135], v[108:111], v[116:119], v[120:135]
    ds_read_b64_tr_b16 v[104:105], v171 offset:4096
    ds_read_b64_tr_b16 v[106:107], v171 offset:4608
    ds_read_b128 v[112:115], v174
    ds_read_b64_tr_b16 v[108:109], v171 offset:6144
    ds_read_b64_tr_b16 v[110:111], v171 offset:6656
    ds_read_b128 v[116:119], v175
    s_waitcnt lgkmcnt(6)
    v_mfma_f32_32x32x16_bf16 v[120:135], v[88:91], v[96:99], v[120:135]
    v_mfma_f32_32x32x16_bf16 v[120:135], v[92:95], v[100:103], v[120:135]
    s_waitcnt lgkmcnt(0)
    v_mfma_f32_32x32x16_bf16 v[120:135], v[104:107], v[112:115], v[120:135]
    s_add_u32 s16, s16, s17
    s_barrier
    ds_read_b64_tr_b16 v[88:89], v156 offset:0
    ds_read_b64_tr_b16 v[90:91], v156 offset:512
    ds_read_b128 v[96:99], v157
    ds_read_b64_tr_b16 v[92:93], v156 offset:2048
    ds_read_b64_tr_b16 v[94:95], v156 offset:2560
    ds_read_b128 v[100:103], v158
    v_mfma_f32_32x32x16_bf16 v[120:135], v[108:111], v[116:119], v[120:135]
    ds_read_b64_tr_b16 v[104:105], v156 offset:4096
    ds_read_b64_tr_b16 v[106:107], v156 offset:4608
    ds_read_b128 v[112:115], v159
    ds_read_b64_tr_b16 v[108:109], v156 offset:6144
    ds_read_b64_tr_b16 v[110:111], v156 offset:6656
    ds_read_b128 v[116:119], v160
    s_waitcnt lgkmcnt(6)
    v_mfma_f32_32x32x16_bf16 v[120:135], v[88:91], v[96:99], v[120:135]
    v_mfma_f32_32x32x16_bf16 v[120:135], v[92:95], v[100:103], v[120:135]
    s_waitcnt lgkmcnt(0)
    v_mfma_f32_32x32x16_bf16 v[120:135], v[104:107], v[112:115], v[120:135]
    s_add_u32 s16, s16, s17
    s_barrier
    ds_read_b64_tr_b16 v[88:89], v161 offset:0
    ds_read_b64_tr_b16 v[90:91], v161 offset:512
    ds_read_b128 v[96:99], v162
    ds_read_b64_tr_b16 v[92:93], v161 offset:2048
    ds_read_b64_tr_b16 v[94:95], v161 offset:2560
    ds_read_b128 v[100:103], v163
    v_mfma_f32_32x32x16_bf16 v[120:135], v[108:111], v[116:119], v[120:135]
    ds_read_b64_tr_b16 v[104:105], v161 offset:4096
    ds_read_b64_tr_b16 v[106:107], v161 offset:4608
    ds_read_b128 v[112:115], v164
    ds_read_b64_tr_b16 v[108:109], v161 offset:6144
    ds_read_b64_tr_b16 v[110:111], v161 offset:6656
    ds_read_b128 v[116:119], v165
    s_waitcnt lgkmcnt(6)
    v_mfma_f32_32x32x16_bf16 v[120:135], v[88:91], v[96:99], v[120:135]
    v_mfma_f32_32x32x16_bf16 v[120:135], v[92:95], v[100:103], v[120:135]
    s_waitcnt lgkmcnt(0)
    v_mfma_f32_32x32x16_bf16 v[120:135], v[104:107], v[112:115], v[120:135]
    s_barrier
    ds_read_b64_tr_b16 v[88:89], v166 offset:0
    ds_read_b64_tr_b16 v[90:91], v166 offset:512
    ds_read_b128 v[96:99], v167
    ds_read_b64_tr_b16 v[92:93], v166 offset:2048
    ds_read_b64_tr_b16 v[94:95], v166 offset:2560
    ds_read_b128 v[100:103], v168
    v_mfma_f32_32x32x16_bf16 v[120:135], v[108:111], v[116:119], v[120:135]
    s_cmp_lg_u32 s22, 7
    s_cbranch_scc1 L_qt6
    buffer_load_dword v249, v251, s[8:11], s54 offen
    s_add_u32 s54, s54, 0
L_qt6:
    ds_read_b64_tr_b16 v[104:105], v166 offset:4096
    ds_read_b64_tr_b16 v[106:107], v166 offset:4608
    ds_read_b128 v[112:115], v169
    ds_read_b64_tr_b16 v[108:109], v166 offset:6144
    ds_read_b64_tr_b16 v[110:111], v166 offset:6656
    ds_read_b128 v[116:119], v170
    s_waitcnt lgkmcnt(6)
    v_mfma_f32_32x32x16_bf16 v[120:135], v[88:91], v[96:99], v[120:135]
    v_mfma_f32_32x32x16_bf16 v[120:135], v[92:95], v[100:103], v[120:135]
    s_waitcnt lgkmcnt(0)
    v_mfma_f32_32x32x16_bf16 v[120:135], v[104:107], v[112:115], v[120:135]
    s_barrier
    ds_read_b64_tr_b16 v[88:89], v171 offset:0
    ds_read_b64_tr_b16 v[90:91], v171 offset:512
    ds_read_b128 v[96:99], v172
    ds_read_b64_tr_b16 v[92:93], v171 offset:2048
    ds_read_b64_tr_b16 v[94:95], v171 offset:2560
    ds_read_b128 v[100:103], v173
    v_mfma_f32_32x32x16_bf16 v[120:135], v[108:111], v[116:119], v[120:135]
    v_lshlrev_b32 v6, 5, v2
    s_lshr_b32 s31, s2, 6
    s_lshl_b32 s31, s31, 5
    s_and_b32 s23, s2, 31
    s_add_u32 s31, s31, s23
    s_bitcmp0_b32 s2, 5
    s_cbranch_scc1 L_sj_emvF
    s_lshl_b32 s64, s31, 3
    s_add_u32 s64, s64, s22
    s_sub_u32 s31, 2048, s64
    s_lshl_b32 s23, s64, 11
    s_lshl_b32 s31, s31, 11
    s_mov_b32 s19, 1048576
    buffer_load_dwordx4 v[200:203], v6, s[80:83], s23 offen
    buffer_load_dwordx4 v[204:207], v6, s[80:83], s23 offen offset:16
    buffer_load_dwordx4 v[208:211], v6, s[80:83], s31 offen
    buffer_load_dwordx4 v[212:215], v6, s[80:83], s31 offen offset:16
    buffer_load_dwordx4 v[216:219], v6, s[84:87], s19 offen
    buffer_load_dwordx4 v[220:223], v6, s[84:87], s19 offen offset:16
    s_branch L_sj_1F
L_sj_emvF:
    s_lshl_b32 s64, s31, 2
    s_add_u32 s64, s64, s22
    s_cmp_ge_u32 s22, 4
    s_cselect_b32 s64, 0x10000, s64
    s_lshl_b32 s31, s31, 3
    s_add_u32 s31, s31, s22
    s_cmp_eq_u32 s31, 4
    s_cselect_b32 s64, 512, s64
    s_lshl_b32 s23, s64, 11
    s_mov_b32 s19, 2097152
    buffer_load_dwordx4 v[200:203], v6, s[84:87], s23 offen
    buffer_load_dwordx4 v[204:207], v6, s[84:87], s23 offen offset:16
    buffer_load_dwordx4 v[216:219], v6, s[80:83], s19 offen
    buffer_load_dwordx4 v[220:223], v6, s[80:83], s19 offen offset:16
L_sj_1F:
    ds_read_b64_tr_b16 v[104:105], v171 offset:4096
    ds_read_b64_tr_b16 v[106:107], v171 offset:4608
    ds_read_b128 v[112:115], v174
    ds_read_b64_tr_b16 v[108:109], v171 offset:6144
    ds_read_b64_tr_b16 v[110:111], v171 offset:6656
    ds_read_b128 v[116:119], v175
    s_waitcnt lgkmcnt(6)
    v_mfma_f32_32x32x16_bf16 v[120:135], v[88:91], v[96:99], v[120:135]
    v_mfma_f32_32x32x16_bf16 v[120:135], v[92:95], v[100:103], v[120:135]
    s_waitcnt lgkmcnt(0)
    v_mfma_f32_32x32x16_bf16 v[120:135], v[104:107], v[112:115], v[120:135]
    v_mfma_f32_32x32x16_bf16 v[120:135], v[108:111], v[116:119], v[120:135]
    s_mov_b32 s23, 1048744942
    s_nop 11
    v_mul_f32 v120, s23, v120
    v_mul_f32 v121, s23, v121
    v_mul_f32 v122, s23, v122
    v_mul_f32 v123, s23, v123
    v_mul_f32 v124, s23, v124
    v_mul_f32 v125, s23, v125
    v_mul_f32 v126, s23, v126
    v_mul_f32 v127, s23, v127
    v_mul_f32 v128, s23, v128
    v_mul_f32 v129, s23, v129
    v_mul_f32 v130, s23, v130
    v_mul_f32 v131, s23, v131
    v_mul_f32 v132, s23, v132
    v_mul_f32 v133, s23, v133
    v_mul_f32 v134, s23, v134
    v_mul_f32 v135, s23, v135
    v_cvt_pk_bf16_f32 v16, v120, v121
    v_cvt_pk_bf16_f32 v17, v122, v123
    v_cvt_pk_bf16_f32 v18, v124, v125
    v_cvt_pk_bf16_f32 v19, v126, v127
    v_cvt_pk_bf16_f32 v20, v128, v129
    v_cvt_pk_bf16_f32 v21, v130, v131
    v_cvt_pk_bf16_f32 v22, v132, v133
    v_cvt_pk_bf16_f32 v23, v134, v135
    buffer_store_dwordx4 v[16:19], v9, s[12:15], s26 offen
    buffer_store_dwordx4 v[20:23], v9, s[12:15], s26 offen offset:1024
    s_waitcnt vmcnt(2)
    v_lshlrev_b32 v6, 5, v2
    v_mov_b32 v7, 0
    s_bitcmp0_b32 s2, 5
    s_cbranch_scc1 L_sj_emv2F
    v_lshlrev_b32 v240, 16, v200
    v_and_b32 v241, 0xffff0000, v200
    v_lshlrev_b32 v242, 16, v208
    v_and_b32 v243, 0xffff0000, v208
    v_add_f32 v244, v240, v242
    v_add_f32 v245, v241, v243
    v_sub_f32 v246, v240, v242
    v_sub_f32 v247, v241, v243
    v_cvt_pk_bf16_f32 v224, v244, v245
    v_cvt_pk_bf16_f32 v232, v246, v247
    v_dot2c_f32_bf16 v7, v224, v216
    v_lshlrev_b32 v240, 16, v201
    v_and_b32 v241, 0xffff0000, v201
    v_lshlrev_b32 v242, 16, v209
    v_and_b32 v243, 0xffff0000, v209
    v_add_f32 v244, v240, v242
    v_add_f32 v245, v241, v243
    v_sub_f32 v246, v240, v242
    v_sub_f32 v247, v241, v243
    v_cvt_pk_bf16_f32 v225, v244, v245
    v_cvt_pk_bf16_f32 v233, v246, v247
    v_dot2c_f32_bf16 v7, v225, v217
    v_lshlrev_b32 v240, 16, v202
    v_and_b32 v241, 0xffff0000, v202
    v_lshlrev_b32 v242, 16, v210
    v_and_b32 v243, 0xffff0000, v210
    v_add_f32 v244, v240, v242
    v_add_f32 v245, v241, v243
    v_sub_f32 v246, v240, v242
    v_sub_f32 v247, v241, v243
    v_cvt_pk_bf16_f32 v226, v244, v245
    v_cvt_pk_bf16_f32 v234, v246, v247
    v_dot2c_f32_bf16 v7, v226, v218
    v_lshlrev_b32 v240, 16, v203
    v_and_b32 v241, 0xffff0000, v203
    v_lshlrev_b32 v242, 16, v211
    v_and_b32 v243, 0xffff0000, v211
    v_add_f32 v244, v240, v242
    v_add_f32 v245, v241, v243
    v_sub_f32 v246, v240, v242
    v_sub_f32 v247, v241, v243
    v_cvt_pk_bf16_f32 v227, v244, v245
    v_cvt_pk_bf16_f32 v235, v246, v247
    v_dot2c_f32_bf16 v7, v227, v219
    v_lshlrev_b32 v240, 16, v204
    v_and_b32 v241, 0xffff0000, v204
    v_lshlrev_b32 v242, 16, v212
    v_and_b32 v243, 0xffff0000, v212
    v_add_f32 v244, v240, v242
    v_add_f32 v245, v241, v243
    v_sub_f32 v246, v240, v242
    v_sub_f32 v247, v241, v243
    v_cvt_pk_bf16_f32 v228, v244, v245
    v_cvt_pk_bf16_f32 v236, v246, v247
    v_dot2c_f32_bf16 v7, v228, v220
    v_lshlrev_b32 v240, 16, v205
    v_and_b32 v241, 0xffff0000, v205
    v_lshlrev_b32 v242, 16, v213
    v_and_b32 v243, 0xffff0000, v213
    v_add_f32 v244, v240, v242
    v_add_f32 v245, v241, v243
    v_sub_f32 v246, v240, v242
    v_sub_f32 v247, v241, v243
    v_cvt_pk_bf16_f32 v229, v244, v245
    v_cvt_pk_bf16_f32 v237, v246, v247
    v_dot2c_f32_bf16 v7, v229, v221
    v_lshlrev_b32 v240, 16, v206
    v_and_b32 v241, 0xffff0000, v206
    v_lshlrev_b32 v242, 16, v214
    v_and_b32 v243, 0xffff0000, v214
    v_add_f32 v244, v240, v242
    v_add_f32 v245, v241, v243
    v_sub_f32 v246, v240, v242
    v_sub_f32 v247, v241, v243
    v_cvt_pk_bf16_f32 v230, v244, v245
    v_cvt_pk_bf16_f32 v238, v246, v247
    v_dot2c_f32_bf16 v7, v230, v222
    v_lshlrev_b32 v240, 16, v207
    v_and_b32 v241, 0xffff0000, v207
    v_lshlrev_b32 v242, 16, v215
    v_and_b32 v243, 0xffff0000, v215
    v_add_f32 v244, v240, v242
    v_add_f32 v245, v241, v243
    v_sub_f32 v246, v240, v242
    v_sub_f32 v247, v241, v243
    v_cvt_pk_bf16_f32 v231, v244, v245
    v_cvt_pk_bf16_f32 v239, v246, v247
    v_dot2c_f32_bf16 v7, v231, v223
    s_lshl_b32 s23, s64, 11
    s_add_u32 s31, s23, 30408704
    s_add_u32 s23, s23, 27262976
    buffer_store_dwordx4 v[224:227], v6, s[12:15], s23 offen
    buffer_store_dwordx4 v[228:231], v6, s[12:15], s23 offen offset:16
    buffer_store_dwordx4 v[232:235], v6, s[12:15], s31 offen
    buffer_store_dwordx4 v[236:239], v6, s[12:15], s31 offen offset:16
    s_nop 1
    v_add_f32_dpp v7, v7, v7 row_ror:8 row_mask:0xf bank_mask:0xf
    s_nop 1
    v_add_f32_dpp v7, v7, v7 row_ror:4 row_mask:0xf bank_mask:0xf
    s_nop 1
    v_add_f32_dpp v7, v7, v7 row_ror:2 row_mask:0xf bank_mask:0xf
    s_nop 1
    v_add_f32_dpp v7, v7, v7 row_ror:1 row_mask:0xf bank_mask:0xf
    v_mov_b32 v3, v7
    s_nop 1
    v_permlane16_swap_b32 v7, v3
    s_nop 1
    v_add_f32 v7, v7, v3
    v_mov_b32 v3, v7
    s_nop 1
    v_permlane32_swap_b32 v7, v3
    s_nop 1
    v_add_f32 v7, v7, v3
    v_cvt_pk_bf16_f32 v7, v7, v7
    s_lshl_b32 s23, s64, 1
    s_add_u32 s23, s23, 34668544
    v_mov_b32 v4, 0
    s_mov_b64 exec, 1
    buffer_store_short v7, v4, s[12:15], s23 offen
    s_mov_b64 exec, -1
    s_branch L_sj_doneF
L_sj_emv2F:
    s_cmp_gt_u32 s64, 512
    s_cbranch_scc1 L_sj_doneF
    v_dot2c_f32_bf16 v7, v200, v216
    v_dot2c_f32_bf16 v7, v201, v217
    v_dot2c_f32_bf16 v7, v202, v218
    v_dot2c_f32_bf16 v7, v203, v219
    v_dot2c_f32_bf16 v7, v204, v220
    v_dot2c_f32_bf16 v7, v205, v221
    v_dot2c_f32_bf16 v7, v206, v222
    v_dot2c_f32_bf16 v7, v207, v223
    s_nop 3
    s_nop 1
    v_add_f32_dpp v7, v7, v7 row_ror:8 row_mask:0xf bank_mask:0xf
    s_nop 1
    v_add_f32_dpp v7, v7, v7 row_ror:4 row_mask:0xf bank_mask:0xf
    s_nop 1
    v_add_f32_dpp v7, v7, v7 row_ror:2 row_mask:0xf bank_mask:0xf
    s_nop 1
    v_add_f32_dpp v7, v7, v7 row_ror:1 row_mask:0xf bank_mask:0xf
    v_mov_b32 v3, v7
    s_nop 1
    v_permlane16_swap_b32 v7, v3
    s_nop 1
    v_add_f32 v7, v7, v3
    v_mov_b32 v3, v7
    s_nop 1
    v_permlane32_swap_b32 v7, v3
    s_nop 1
    v_add_f32 v7, v7, v3
    v_mov_b32 v5, 0
    v_cvt_pk_bf16_f32 v7, v7, v5
    v_cmp_eq_u32 vcc, 0, v2
    s_mul_i32 s23, s64, 2176
    s_add_u32 s31, s23, 35653632
    s_add_u32 s23, s23, 33556480
    v_cndmask_b32 v7, v5, v7, vcc
    v_lshlrev_b32 v4, 2, v2
    s_mov_b32 exec_hi, 0
    buffer_store_dword v7, v4, s[12:15], s23 offen
    buffer_store_dword v5, v4, s[12:15], s31 offen
    s_mov_b64 exec, -1
L_sj_doneF:
    s_branch L_qg_done
L_qg_D:
    s_add_u32 m0, s20, 0
    s_nop 0
    buffer_load_dwordx4 v152, s[96:99], s16 offen lds
    s_add_u32 m0, s20, 1024
    s_nop 0
    buffer_load_dwordx4 v153, s[96:99], s16 offen lds
    s_add_u32 m0, s20, 2048
    s_nop 0
    buffer_load_dwordx4 v154, s[96:99], s16 offen lds
    s_add_u32 m0, s20, 3072
    s_nop 0
    buffer_load_dwordx4 v155, s[96:99], s16 offen lds
    s_add_u32 s16, s16, s17
    s_add_u32 m0, s20, 28672
    s_nop 0
    buffer_load_dwordx4 v152, s[96:99], s16 offen lds
    s_add_u32 m0, s20, 29696
    s_nop 0
    buffer_load_dwordx4 v153, s[96:99], s16 offen lds
    s_add_u32 m0, s20, 30720
    s_nop 0
    buffer_load_dwordx4 v154, s[96:99], s16 offen lds
    s_add_u32 m0, s20, 31744
    s_nop 0
    buffer_load_dwordx4 v155, s[96:99], s16 offen lds
    s_add_u32 s16, s16, s17
    s_add_u32 m0, s20, 57344
    s_nop 0
    buffer_load_dwordx4 v152, s[96:99], s16 offen lds
    s_add_u32 m0, s20, 58368
    s_nop 0
    buffer_load_dwordx4 v153, s[96:99], s16 offen lds
    s_add_u32 m0, s20, 59392
    s_nop 0
    buffer_load_dwordx4 v154, s[96:99], s16 offen lds
    s_add_u32 m0, s20, 60416
    s_nop 0
    buffer_load_dwordx4 v155, s[96:99], s16 offen lds
    s_add_u32 s16, s16, s17
    v_lshlrev_b32 v9, 4, v2
    v_bfe_u32 v3, v2, 2, 2
    v_lshrrev_b32 v4, 5, v2
    v_lshl_add_u32 v4, v4, 3, v3
    v_bfe_u32 v5, v2, 4, 1
    v_and_b32 v6, 3, v2
    v_lshlrev_b32 v6, 3, v6
    v_lshl_add_u32 v6, v5, 5, v6
    v_lshl_add_u32 v7, v4, 6, v6
    v_lshl_add_u32 v4, v4, 7, v6
    v_lshrrev_b32 v3, 1, v3
    v_lshrrev_b32 v5, 2, v1
    v_xor_b32 v3, v3, v5
    v_lshl_add_u32 v4, v3, 6, v4
    v_add_u32 v181, 24576, v7
    v_add_u32 v182, 81920, v7
    v_add_u32 v183, 139264, v7
    v_add_u32 v156, 0, v4
    v_add_u32 v161, 28672, v4
    v_add_u32 v166, 57344, v4
    v_add_u32 v171, 86016, v4
    s_mov_b32 s27, 0
    s_and_b32 s25, s22, 3
    s_lshl_b32 s25, s25, 5
    v_and_b32 v3, 31, v2
    v_bfe_u32 v4, v3, 1, 3
    v_lshrrev_b32 v5, 5, v2
    v_xor_b32 v4, v4, v5
    v_xor_b32 v4, s27, v4
    v_add_u32 v3, s25, v3
    v_lshlrev_b32 v3, 7, v3
    v_lshl_add_u32 v3, v4, 4, v3
    v_add_u32 v157, 8192, v3
    v_xor_b32 v158, 32, v157
    v_xor_b32 v159, 64, v157
    v_xor_b32 v160, 96, v157
    v_add_u32 v162, 36864, v3
    v_xor_b32 v163, 32, v162
    v_xor_b32 v164, 64, v162
    v_xor_b32 v165, 96, v162
    v_add_u32 v167, 65536, v3
    v_xor_b32 v168, 32, v167
    v_xor_b32 v169, 64, v167
    v_xor_b32 v170, 96, v167
    v_add_u32 v172, 94208, v3
    v_xor_b32 v173, 32, v172
    v_xor_b32 v174, 64, v172
    v_xor_b32 v175, 96, v172
    v_mov_b32 v120, 0
    v_mov_b32 v121, 0
    v_mov_b32 v122, 0
    v_mov_b32 v123, 0
    v_mov_b32 v124, 0
    v_mov_b32 v125, 0
    v_mov_b32 v126, 0
    v_mov_b32 v127, 0
    v_mov_b32 v128, 0
    v_mov_b32 v129, 0
    v_mov_b32 v130, 0
    v_mov_b32 v131, 0
    v_mov_b32 v132, 0
    v_mov_b32 v133, 0
    v_mov_b32 v134, 0
    v_mov_b32 v135, 0
    s_waitcnt vmcnt(8)
    s_barrier
    ds_read_b64_tr_b16 v[88:89], v156 offset:0
    ds_read_b64_tr_b16 v[90:91], v156 offset:512
    ds_read_b128 v[96:99], v157
    ds_read_b64_tr_b16 v[92:93], v156 offset:2048
    ds_read_b64_tr_b16 v[94:95], v156 offset:2560
    ds_read_b128 v[100:103], v158
    ds_read_b64_tr_b16 v[104:105], v156 offset:4096
    ds_read_b64_tr_b16 v[106:107], v156 offset:4608
    ds_read_b128 v[112:115], v159
    ds_read_b64_tr_b16 v[108:109], v156 offset:6144
    ds_read_b64_tr_b16 v[110:111], v156 offset:6656
    ds_read_b128 v[116:119], v160
    s_waitcnt lgkmcnt(6)
    v_mfma_f32_32x32x16_bf16 v[120:135], v[88:91], v[96:99], v[120:135]
    s_add_u32 m0, s20, 86016
    s_nop 0
    buffer_load_dwordx4 v152, s[96:99], s16 offen lds
    s_add_u32 m0, s20, 87040
    s_nop 0
    buffer_load_dwordx4 v153, s[96:99], s16 offen lds
    v_mfma_f32_32x32x16_bf16 v[120:135], v[92:95], v[100:103], v[120:135]
    s_add_u32 m0, s20, 88064
    s_nop 0
    buffer_load_dwordx4 v154, s[96:99], s16 offen lds
    s_waitcnt lgkmcnt(0)
    v_mfma_f32_32x32x16_bf16 v[120:135], v[104:107], v[112:115], v[120:135]
    s_add_u32 m0, s20, 89088
    s_nop 0
    buffer_load_dwordx4 v155, s[96:99], s16 offen lds
    s_add_u32 s16, s16, s17
    s_waitcnt vmcnt(8)
    s_barrier
    ds_read_b64_tr_b16 v[88:89], v161 offset:0
    ds_read_b64_tr_b16 v[90:91], v161 offset:512
    ds_read_b128 v[96:99], v162
    ds_read_b64_tr_b16 v[92:93], v161 offset:2048
    ds_read_b64_tr_b16 v[94:95], v161 offset:2560
    ds_read_b128 v[100:103], v163
    v_mfma_f32_32x32x16_bf16 v[120:135], v[108:111], v[116:119], v[120:135]
    ds_read_b64_tr_b16 v[104:105], v161 offset:4096
    ds_read_b64_tr_b16 v[106:107], v161 offset:4608
    ds_read_b128 v[112:115], v164
    ds_read_b64_tr_b16 v[108:109], v161 offset:6144
    ds_read_b64_tr_b16 v[110:111], v161 offset:6656
    ds_read_b128 v[116:119], v165
    s_waitcnt lgkmcnt(6)
    v_mfma_f32_32x32x16_bf16 v[120:135], v[88:91], v[96:99], v[120:135]
    s_add_u32 m0, s20, 0
    s_nop 0
    buffer_load_dwordx4 v152, s[96:99], s16 offen lds
    s_add_u32 m0, s20, 1024
    s_nop 0
    buffer_load_dwordx4 v153, s[96:99], s16 offen lds
    v_mfma_f32_32x32x16_bf16 v[120:135], v[92:95], v[100:103], v[120:135]
    s_add_u32 m0, s20, 2048
    s_nop 0
    buffer_load_dwordx4 v154, s[96:99], s16 offen lds
    s_waitcnt lgkmcnt(0)
    v_mfma_f32_32x32x16_bf16 v[120:135], v[104:107], v[112:115], v[120:135]
    s_add_u32 m0, s20, 3072
    s_nop 0
    buffer_load_dwordx4 v155, s[96:99], s16 offen lds
    s_add_u32 s16, s16, s17
    s_waitcnt vmcnt(8)
    s_barrier
    ds_read_b64_tr_b16 v[88:89], v166 offset:0
    ds_read_b64_tr_b16 v[90:91], v166 offset:512
    ds_read_b128 v[96:99], v167
    ds_read_b64_tr_b16 v[92:93], v166 offset:2048
    ds_read_b64_tr_b16 v[94:95], v166 offset:2560
    ds_read_b128 v[100:103], v168
    v_mfma_f32_32x32x16_bf16 v[120:135], v[108:111], v[116:119], v[120:135]
    ds_read_b64_tr_b16 v[104:105], v166 offset:4096
    ds_read_b64_tr_b16 v[106:107], v166 offset:4608
    ds_read_b128 v[112:115], v169
    ds_read_b64_tr_b16 v[108:109], v166 offset:6144
    ds_read_b64_tr_b16 v[110:111], v166 offset:6656
    ds_read_b128 v[116:119], v170
    s_waitcnt lgkmcnt(6)
    v_mfma_f32_32x32x16_bf16 v[120:135], v[88:91], v[96:99], v[120:135]
    s_add_u32 m0, s20, 28672
    s_nop 0
    buffer_load_dwordx4 v152, s[96:99], s16 offen lds
    s_add_u32 m0, s20, 29696
    s_nop 0
    buffer_load_dwordx4 v153, s[96:99], s16 offen lds
    v_mfma_f32_32x32x16_bf16 v[120:135], v[92:95], v[100:103], v[120:135]
    s_add_u32 m0, s20, 30720
    s_nop 0
    buffer_load_dwordx4 v154, s[96:99], s16 offen lds
    s_waitcnt lgkmcnt(0)
    v_mfma_f32_32x32x16_bf16 v[120:135], v[104:107], v[112:115], v[120:135]
    s_add_u32 m0, s20, 31744
    s_nop 0
    buffer_load_dwordx4 v155, s[96:99], s16 offen lds
    s_add_u32 s16, s16, s17
    s_waitcnt vmcnt(8)
    s_barrier
    ds_read_b64_tr_b16 v[88:89], v171 offset:0
    ds_read_b64_tr_b16 v[90:91], v171 offset:512
    ds_read_b128 v[96:99], v172
    ds_read_b64_tr_b16 v[92:93], v171 offset:2048
    ds_read_b64_tr_b16 v[94:95], v171 offset:2560
    ds_read_b128 v[100:103], v173
    v_mfma_f32_32x32x16_bf16 v[120:135], v[108:111], v[116:119], v[120:135]
    ds_read_b64_tr_b16 v[104:105], v171 offset:4096
    ds_read_b64_tr_b16 v[106:107], v171 offset:4608
    ds_read_b128 v[112:115], v174
    ds_read_b64_tr_b16 v[108:109], v171 offset:6144
    ds_read_b64_tr_b16 v[110:111], v171 offset:6656
    ds_read_b128 v[116:119], v175
    s_waitcnt lgkmcnt(6)
    v_mfma_f32_32x32x16_bf16 v[120:135], v[88:91], v[96:99], v[120:135]
    s_add_u32 m0, s20, 57344
    s_nop 0
    buffer_load_dwordx4 v152, s[96:99], s16 offen lds
    s_add_u32 m0, s20, 58368
    s_nop 0
    buffer_load_dwordx4 v153, s[96:99], s16 offen lds
    v_mfma_f32_32x32x16_bf16 v[120:135], v[92:95], v[100:103], v[120:135]
    s_add_u32 m0, s20, 59392
    s_nop 0
    buffer_load_dwordx4 v154, s[96:99], s16 offen lds
    s_waitcnt lgkmcnt(0)
    v_mfma_f32_32x32x16_bf16 v[120:135], v[104:107], v[112:115], v[120:135]
    s_add_u32 m0, s20, 60416
    s_nop 0
    buffer_load_dwordx4 v155, s[96:99], s16 offen lds
    s_add_u32 s16, s16, s17
    s_waitcnt vmcnt(8)
    s_barrier
    ds_read_b64_tr_b16 v[88:89], v156 offset:0
    ds_read_b64_tr_b16 v[90:91], v156 offset:512
    ds_read_b128 v[96:99], v157
    ds_read_b64_tr_b16 v[92:93], v156 offset:2048
    ds_read_b64_tr_b16 v[94:95], v156 offset:2560
    ds_read_b128 v[100:103], v158
    v_mfma_f32_32x32x16_bf16 v[120:135], v[108:111], v[116:119], v[120:135]
    ds_read_b64_tr_b16 v[104:105], v156 offset:4096
    ds_read_b64_tr_b16 v[106:107], v156 offset:4608
    ds_read_b128 v[112:115], v159
    ds_read_b64_tr_b16 v[108:109], v156 offset:6144
    ds_read_b64_tr_b16 v[110:111], v156 offset:6656
    ds_read_b128 v[116:119], v160
    s_waitcnt lgkmcnt(6)
    v_mfma_f32_32x32x16_bf16 v[120:135], v[88:91], v[96:99], v[120:135]
    s_add_u32 m0, s20, 86016
    s_nop 0
    buffer_load_dwordx4 v152, s[96:99], s16 offen lds
    s_add_u32 m0, s20, 87040
    s_nop 0
    buffer_load_dwordx4 v153, s[96:99], s16 offen lds
    v_mfma_f32_32x32x16_bf16 v[120:135], v[92:95], v[100:103], v[120:135]
    s_add_u32 m0, s20, 88064
    s_nop 0
    buffer_load_dwordx4 v154, s[96:99], s16 offen lds
    s_waitcnt lgkmcnt(0)
    v_mfma_f32_32x32x16_bf16 v[120:135], v[104:107], v[112:115], v[120:135]
    s_add_u32 m0, s20, 89088
    s_nop 0
    buffer_load_dwordx4 v155, s[96:99], s16 offen lds
    s_add_u32 s16, s16, s17
    s_waitcnt vmcnt(8)
    s_barrier
    ds_read_b64_tr_b16 v[88:89], v161 offset:0
    ds_read_b64_tr_b16 v[90:91], v161 offset:512
    ds_read_b128 v[96:99], v162
    ds_read_b64_tr_b16 v[92:93], v161 offset:2048
    ds_read_b64_tr_b16 v[94:95], v161 offset:2560
    ds_read_b128 v[100:103], v163
    v_mfma_f32_32x32x16_bf16 v[120:135], v[108:111], v[116:119], v[120:135]
    ds_read_b64_tr_b16 v[104:105], v161 offset:4096
    ds_read_b64_tr_b16 v[106:107], v161 offset:4608
    ds_read_b128 v[112:115], v164
    ds_read_b64_tr_b16 v[108:109], v161 offset:6144
    ds_read_b64_tr_b16 v[110:111], v161 offset:6656
    ds_read_b128 v[116:119], v165
    s_waitcnt lgkmcnt(6)
    v_mfma_f32_32x32x16_bf16 v[120:135], v[88:91], v[96:99], v[120:135]
    s_add_u32 m0, s20, 0
    s_nop 0
    buffer_load_dwordx4 v152, s[96:99], s16 offen lds
    s_add_u32 m0, s20, 1024
    s_nop 0
    buffer_load_dwordx4 v153, s[96:99], s16 offen lds
    v_mfma_f32_32x32x16_bf16 v[120:135], v[92:95], v[100:103], v[120:135]
    s_add_u32 m0, s20, 2048
    s_nop 0
    buffer_load_dwordx4 v154, s[96:99], s16 offen lds
    s_waitcnt lgkmcnt(0)
    v_mfma_f32_32x32x16_bf16 v[120:135], v[104:107], v[112:115], v[120:135]
    s_add_u32 m0, s20, 3072
    s_nop 0
    buffer_load_dwordx4 v155, s[96:99], s16 offen lds
    s_add_u32 s16, s16, s17
    s_waitcnt vmcnt(8)
    s_barrier
    ds_read_b64_tr_b16 v[88:89], v166 offset:0
    ds_read_b64_tr_b16 v[90:91], v166 offset:512
    ds_read_b128 v[96:99], v167
    ds_read_b64_tr_b16 v[92:93], v166 offset:2048
    ds_read_b64_tr_b16 v[94:95], v166 offset:2560
    ds_read_b128 v[100:103], v168
    v_mfma_f32_32x32x16_bf16 v[120:135], v[108:111], v[116:119], v[120:135]
    ds_read_b64_tr_b16 v[104:105], v166 offset:4096
    ds_read_b64_tr_b16 v[106:107], v166 offset:4608
    ds_read_b128 v[112:115], v169
    ds_read_b64_tr_b16 v[108:109], v166 offset:6144
    ds_read_b64_tr_b16 v[110:111], v166 offset:6656
    ds_read_b128 v[116:119], v170
    s_waitcnt lgkmcnt(6)
    v_mfma_f32_32x32x16_bf16 v[120:135], v[88:91], v[96:99], v[120:135]
    s_add_u32 m0, s20, 28672
    s_nop 0
    buffer_load_dwordx4 v152, s[96:99], s16 offen lds
    s_add_u32 m0, s20, 29696
    s_nop 0
    buffer_load_dwordx4 v153, s[96:99], s16 offen lds
    v_mfma_f32_32x32x16_bf16 v[120:135], v[92:95], v[100:103], v[120:135]
    s_add_u32 m0, s20, 30720
    s_nop 0
    buffer_load_dwordx4 v154, s[96:99], s16 offen lds
    s_waitcnt lgkmcnt(0)
    v_mfma_f32_32x32x16_bf16 v[120:135], v[104:107], v[112:115], v[120:135]
    s_add_u32 m0, s20, 31744
    s_nop 0
    buffer_load_dwordx4 v155, s[96:99], s16 offen lds
    s_add_u32 s16, s16, s17
    s_waitcnt vmcnt(8)
    s_barrier
    ds_read_b64_tr_b16 v[88:89], v171 offset:0
    ds_read_b64_tr_b16 v[90:91], v171 offset:512
    ds_read_b128 v[96:99], v172
    ds_read_b64_tr_b16 v[92:93], v171 offset:2048
    ds_read_b64_tr_b16 v[94:95], v171 offset:2560
    ds_read_b128 v[100:103], v173
    v_mfma_f32_32x32x16_bf16 v[120:135], v[108:111], v[116:119], v[120:135]
    ds_read_b64_tr_b16 v[104:105], v171 offset:4096
    ds_read_b64_tr_b16 v[106:107], v171 offset:4608
    ds_read_b128 v[112:115], v174
    ds_read_b64_tr_b16 v[108:109], v171 offset:6144
    ds_read_b64_tr_b16 v[110:111], v171 offset:6656
    ds_read_b128 v[116:119], v175
    s_waitcnt lgkmcnt(6)
    v_mfma_f32_32x32x16_bf16 v[120:135], v[88:91], v[96:99], v[120:135]
    s_add_u32 m0, s20, 57344
    s_nop 0
    buffer_load_dwordx4 v152, s[96:99], s16 offen lds
    s_add_u32 m0, s20, 58368
    s_nop 0
    buffer_load_dwordx4 v153, s[96:99], s16 offen lds
    v_mfma_f32_32x32x16_bf16 v[120:135], v[92:95], v[100:103], v[120:135]
    s_add_u32 m0, s20, 59392
    s_nop 0
    buffer_load_dwordx4 v154, s[96:99], s16 offen lds
    s_waitcnt lgkmcnt(0)
    v_mfma_f32_32x32x16_bf16 v[120:135], v[104:107], v[112:115], v[120:135]
    s_add_u32 m0, s20, 60416
    s_nop 0
    buffer_load_dwordx4 v155, s[96:99], s16 offen lds
    s_add_u32 s16, s16, s17
    s_waitcnt vmcnt(8)
    s_barrier
    ds_read_b64_tr_b16 v[88:89], v156 offset:0
    ds_read_b64_tr_b16 v[90:91], v156 offset:512
    ds_read_b128 v[96:99], v157
    ds_read_b64_tr_b16 v[92:93], v156 offset:2048
    ds_read_b64_tr_b16 v[94:95], v156 offset:2560
    ds_read_b128 v[100:103], v158
    v_mfma_f32_32x32x16_bf16 v[120:135], v[108:111], v[116:119], v[120:135]
    ds_read_b64_tr_b16 v[104:105], v156 offset:4096
    ds_read_b64_tr_b16 v[106:107], v156 offset:4608
    ds_read_b128 v[112:115], v159
    ds_read_b64_tr_b16 v[108:109], v156 offset:6144
    ds_read_b64_tr_b16 v[110:111], v156 offset:6656
    ds_read_b128 v[116:119], v160
    s_waitcnt lgkmcnt(6)
    v_mfma_f32_32x32x16_bf16 v[120:135], v[88:91], v[96:99], v[120:135]
    s_add_u32 m0, s20, 86016
    s_nop 0
    buffer_load_dwordx4 v152, s[96:99], s16 offen lds
    s_add_u32 m0, s20, 87040
    s_nop 0
    buffer_load_dwordx4 v153, s[96:99], s16 offen lds
    v_mfma_f32_32x32x16_bf16 v[120:135], v[92:95], v[100:103], v[120:135]
    s_add_u32 m0, s20, 88064
    s_nop 0
    buffer_load_dwordx4 v154, s[96:99], s16 offen lds
    s_waitcnt lgkmcnt(0)
    v_mfma_f32_32x32x16_bf16 v[120:135], v[104:107], v[112:115], v[120:135]
    s_add_u32 m0, s20, 89088
    s_nop 0
    buffer_load_dwordx4 v155, s[96:99], s16 offen lds
    s_add_u32 s16, s16, s17
    s_waitcnt vmcnt(8)
    s_barrier
    ds_read_b64_tr_b16 v[88:89], v161 offset:0
    ds_read_b64_tr_b16 v[90:91], v161 offset:512
    ds_read_b128 v[96:99], v162
    ds_read_b64_tr_b16 v[92:93], v161 offset:2048
    ds_read_b64_tr_b16 v[94:95], v161 offset:2560
    ds_read_b128 v[100:103], v163
    v_mfma_f32_32x32x16_bf16 v[120:135], v[108:111], v[116:119], v[120:135]
    ds_read_b64_tr_b16 v[104:105], v161 offset:4096
    ds_read_b64_tr_b16 v[106:107], v161 offset:4608
    ds_read_b128 v[112:115], v164
    ds_read_b64_tr_b16 v[108:109], v161 offset:6144
    ds_read_b64_tr_b16 v[110:111], v161 offset:6656
    ds_read_b128 v[116:119], v165
    s_waitcnt lgkmcnt(6)
    v_mfma_f32_32x32x16_bf16 v[120:135], v[88:91], v[96:99], v[120:135]
    s_add_u32 m0, s20, 0
    s_nop 0
    buffer_load_dwordx4 v152, s[96:99], s16 offen lds
    s_add_u32 m0, s20, 1024
    s_nop 0
    buffer_load_dwordx4 v153, s[96:99], s16 offen lds
    v_mfma_f32_32x32x16_bf16 v[120:135], v[92:95], v[100:103], v[120:135]
    s_add_u32 m0, s20, 2048
    s_nop 0
    buffer_load_dwordx4 v154, s[96:99], s16 offen lds
    s_waitcnt lgkmcnt(0)
    v_mfma_f32_32x32x16_bf16 v[120:135], v[104:107], v[112:115], v[120:135]
    s_add_u32 m0, s20, 3072
    s_nop 0
    buffer_load_dwordx4 v155, s[96:99], s16 offen lds
    s_add_u32 s16, s16, s17
    s_waitcnt vmcnt(8)
    s_barrier
    ds_read_b64_tr_b16 v[88:89], v166 offset:0
    ds_read_b64_tr_b16 v[90:91], v166 offset:512
    ds_read_b128 v[96:99], v167
    ds_read_b64_tr_b16 v[92:93], v166 offset:2048
    ds_read_b64_tr_b16 v[94:95], v166 offset:2560
    ds_read_b128 v[100:103], v168
    v_mfma_f32_32x32x16_bf16 v[120:135], v[108:111], v[116:119], v[120:135]
    ds_read_b64_tr_b16 v[104:105], v166 offset:4096
    ds_read_b64_tr_b16 v[106:107], v166 offset:4608
    ds_read_b128 v[112:115], v169
    ds_read_b64_tr_b16 v[108:109], v166 offset:6144
    ds_read_b64_tr_b16 v[110:111], v166 offset:6656
    ds_read_b128 v[116:119], v170
    s_waitcnt lgkmcnt(6)
    v_mfma_f32_32x32x16_bf16 v[120:135], v[88:91], v[96:99], v[120:135]
    s_add_u32 m0, s20, 28672
    s_nop 0
    buffer_load_dwordx4 v152, s[96:99], s16 offen lds
    s_add_u32 m0, s20, 29696
    s_nop 0
    buffer_load_dwordx4 v153, s[96:99], s16 offen lds
    v_mfma_f32_32x32x16_bf16 v[120:135], v[92:95], v[100:103], v[120:135]
    s_add_u32 m0, s20, 30720
    s_nop 0
    buffer_load_dwordx4 v154, s[96:99], s16 offen lds
    s_waitcnt lgkmcnt(0)
    v_mfma_f32_32x32x16_bf16 v[120:135], v[104:107], v[112:115], v[120:135]
    s_add_u32 m0, s20, 31744
    s_nop 0
    buffer_load_dwordx4 v155, s[96:99], s16 offen lds
    s_add_u32 s16, s16, s17
    s_waitcnt vmcnt(8)
    s_barrier
    ds_read_b64_tr_b16 v[88:89], v171 offset:0
    ds_read_b64_tr_b16 v[90:91], v171 offset:512
    ds_read_b128 v[96:99], v172
    ds_read_b64_tr_b16 v[92:93], v171 offset:2048
    ds_read_b64_tr_b16 v[94:95], v171 offset:2560
    ds_read_b128 v[100:103], v173
    v_mfma_f32_32x32x16_bf16 v[120:135], v[108:111], v[116:119], v[120:135]
    ds_read_b64_tr_b16 v[104:105], v171 offset:4096
    ds_read_b64_tr_b16 v[106:107], v171 offset:4608
    ds_read_b128 v[112:115], v174
    ds_read_b64_tr_b16 v[108:109], v171 offset:6144
    ds_read_b64_tr_b16 v[110:111], v171 offset:6656
    ds_read_b128 v[116:119], v175
    s_waitcnt lgkmcnt(6)
    v_mfma_f32_32x32x16_bf16 v[120:135], v[88:91], v[96:99], v[120:135]
    s_add_u32 m0, s20, 57344
    s_nop 0
    buffer_load_dwordx4 v152, s[96:99], s16 offen lds
    s_add_u32 m0, s20, 58368
    s_nop 0
    buffer_load_dwordx4 v153, s[96:99], s16 offen lds
    v_mfma_f32_32x32x16_bf16 v[120:135], v[92:95], v[100:103], v[120:135]
    s_add_u32 m0, s20, 59392
    s_nop 0
    buffer_load_dwordx4 v154, s[96:99], s16 offen lds
    s_waitcnt lgkmcnt(0)
    v_mfma_f32_32x32x16_bf16 v[120:135], v[104:107], v[112:115], v[120:135]
    s_add_u32 m0, s20, 60416
    s_nop 0
    buffer_load_dwordx4 v155, s[96:99], s16 offen lds
    s_add_u32 s16, s16, s17
    s_waitcnt vmcnt(8)
    s_barrier
    ds_read_b64_tr_b16 v[88:89], v156 offset:0
    ds_read_b64_tr_b16 v[90:91], v156 offset:512
    ds_read_b128 v[96:99], v157
    ds_read_b64_tr_b16 v[92:93], v156 offset:2048
    ds_read_b64_tr_b16 v[94:95], v156 offset:2560
    ds_read_b128 v[100:103], v158
    v_mfma_f32_32x32x16_bf16 v[120:135], v[108:111], v[116:119], v[120:135]
    ds_read_b64_tr_b16 v[104:105], v156 offset:4096
    ds_read_b64_tr_b16 v[106:107], v156 offset:4608
    ds_read_b128 v[112:115], v159
    ds_read_b64_tr_b16 v[108:109], v156 offset:6144
    ds_read_b64_tr_b16 v[110:111], v156 offset:6656
    ds_read_b128 v[116:119], v160
    s_waitcnt lgkmcnt(6)
    v_mfma_f32_32x32x16_bf16 v[120:135], v[88:91], v[96:99], v[120:135]
    s_add_u32 m0, s20, 86016
    s_nop 0
    buffer_load_dwordx4 v152, s[96:99], s16 offen lds
    s_add_u32 m0, s20, 87040
    s_nop 0
    buffer_load_dwordx4 v153, s[96:99], s16 offen lds
    v_mfma_f32_32x32x16_bf16 v[120:135], v[92:95], v[100:103], v[120:135]
    s_add_u32 m0, s20, 88064
    s_nop 0
    buffer_load_dwordx4 v154, s[96:99], s16 offen lds
    s_waitcnt lgkmcnt(0)
    v_mfma_f32_32x32x16_bf16 v[120:135], v[104:107], v[112:115], v[120:135]
    s_add_u32 m0, s20, 89088
    s_nop 0
    buffer_load_dwordx4 v155, s[96:99], s16 offen lds
    s_add_u32 s16, s16, s17
    s_waitcnt vmcnt(8)
    s_barrier
    ds_read_b64_tr_b16 v[88:89], v161 offset:0
    ds_read_b64_tr_b16 v[90:91], v161 offset:512
    ds_read_b128 v[96:99], v162
    ds_read_b64_tr_b16 v[92:93], v161 offset:2048
    ds_read_b64_tr_b16 v[94:95], v161 offset:2560
    ds_read_b128 v[100:103], v163
    v_mfma_f32_32x32x16_bf16 v[120:135], v[108:111], v[116:119], v[120:135]
    ds_read_b64_tr_b16 v[104:105], v161 offset:4096
    ds_read_b64_tr_b16 v[106:107], v161 offset:4608
    ds_read_b128 v[112:115], v164
    ds_read_b64_tr_b16 v[108:109], v161 offset:6144
    ds_read_b64_tr_b16 v[110:111], v161 offset:6656
    ds_read_b128 v[116:119], v165
    s_waitcnt lgkmcnt(6)
    v_mfma_f32_32x32x16_bf16 v[120:135], v[88:91], v[96:99], v[120:135]
    v_mfma_f32_32x32x16_bf16 v[120:135], v[92:95], v[100:103], v[120:135]
    s_waitcnt lgkmcnt(0)
    v_mfma_f32_32x32x16_bf16 v[120:135], v[104:107], v[112:115], v[120:135]
    s_waitcnt vmcnt(4)
    s_barrier
    ds_read_b64_tr_b16 v[88:89], v166 offset:0
    ds_read_b64_tr_b16 v[90:91], v166 offset:512
    ds_read_b128 v[96:99], v167
    ds_read_b64_tr_b16 v[92:93], v166 offset:2048
    ds_read_b64_tr_b16 v[94:95], v166 offset:2560
    ds_read_b128 v[100:103], v168
    v_mfma_f32_32x32x16_bf16 v[120:135], v[108:111], v[116:119], v[120:135]
    ds_read_b64_tr_b16 v[104:105], v166 offset:4096
    ds_read_b64_tr_b16 v[106:107], v166 offset:4608
    ds_read_b128 v[112:115], v169
    ds_read_b64_tr_b16 v[108:109], v166 offset:6144
    ds_read_b64_tr_b16 v[110:111], v166 offset:6656
    ds_read_b128 v[116:119], v170
    s_waitcnt lgkmcnt(6)
    v_mfma_f32_32x32x16_bf16 v[120:135], v[88:91], v[96:99], v[120:135]
    v_mfma_f32_32x32x16_bf16 v[120:135], v[92:95], v[100:103], v[120:135]
    s_waitcnt lgkmcnt(0)
    v_mfma_f32_32x32x16_bf16 v[120:135], v[104:107], v[112:115], v[120:135]
    s_waitcnt vmcnt(0)
    s_barrier
    ds_read_b64_tr_b16 v[88:89], v171 offset:0
    ds_read_b64_tr_b16 v[90:91], v171 offset:512
    ds_read_b128 v[96:99], v172
    ds_read_b64_tr_b16 v[92:93], v171 offset:2048
    ds_read_b64_tr_b16 v[94:95], v171 offset:2560
    ds_read_b128 v[100:103], v173
    v_mfma_f32_32x32x16_bf16 v[120:135], v[108:111], v[116:119], v[120:135]
    v_lshlrev_b32 v6, 5, v2
    s_lshr_b32 s31, s2, 6
    s_lshl_b32 s31, s31, 5
    s_and_b32 s23, s2, 31
    s_add_u32 s31, s31, s23
    s_bitcmp0_b32 s2, 5
    s_cbranch_scc1 L_sj_emvD
    s_lshl_b32 s64, s31, 3
    s_add_u32 s64, s64, s22
    s_sub_u32 s31, 2048, s64
    s_lshl_b32 s23, s64, 11
    s_lshl_b32 s31, s31, 11
    s_mov_b32 s19, 1048576
    buffer_load_dwordx4 v[200:203], v6, s[80:83], s23 offen
    buffer_load_dwordx4 v[204:207], v6, s[80:83], s23 offen offset:16
    buffer_load_dwordx4 v[208:211], v6, s[80:83], s31 offen
    buffer_load_dwordx4 v[212:215], v6, s[80:83], s31 offen offset:16
    buffer_load_dwordx4 v[216:219], v6, s[84:87], s19 offen
    buffer_load_dwordx4 v[220:223], v6, s[84:87], s19 offen offset:16
    s_branch L_sj_1D
L_sj_emvD:
    s_lshl_b32 s64, s31, 2
    s_add_u32 s64, s64, s22
    s_cmp_ge_u32 s22, 4
    s_cselect_b32 s64, 0x10000, s64
    s_lshl_b32 s31, s31, 3
    s_add_u32 s31, s31, s22
    s_cmp_eq_u32 s31, 4
    s_cselect_b32 s64, 512, s64
    s_lshl_b32 s23, s64, 11
    s_mov_b32 s19, 2097152
    buffer_load_dwordx4 v[200:203], v6, s[84:87], s23 offen
    buffer_load_dwordx4 v[204:207], v6, s[84:87], s23 offen offset:16
    buffer_load_dwordx4 v[216:219], v6, s[80:83], s19 offen
    buffer_load_dwordx4 v[220:223], v6, s[80:83], s19 offen offset:16
L_sj_1D:
    ds_read_b64_tr_b16 v[104:105], v171 offset:4096
    ds_read_b64_tr_b16 v[106:107], v171 offset:4608
    ds_read_b128 v[112:115], v174
    ds_read_b64_tr_b16 v[108:109], v171 offset:6144
    ds_read_b64_tr_b16 v[110:111], v171 offset:6656
    ds_read_b128 v[116:119], v175
    s_waitcnt lgkmcnt(6)
    v_mfma_f32_32x32x16_bf16 v[120:135], v[88:91], v[96:99], v[120:135]
    v_mfma_f32_32x32x16_bf16 v[120:135], v[92:95], v[100:103], v[120:135]
    s_waitcnt lgkmcnt(0)
    v_mfma_f32_32x32x16_bf16 v[120:135], v[104:107], v[112:115], v[120:135]
    v_mfma_f32_32x32x16_bf16 v[120:135], v[108:111], v[116:119], v[120:135]
    s_mov_b32 s23, 1048744942
    s_nop 11
    v_mul_f32 v120, s23, v120
    v_mul_f32 v121, s23, v121
    v_mul_f32 v122, s23, v122
    v_mul_f32 v123, s23, v123
    v_mul_f32 v124, s23, v124
    v_mul_f32 v125, s23, v125
    v_mul_f32 v126, s23, v126
    v_mul_f32 v127, s23, v127
    v_mul_f32 v128, s23, v128
    v_mul_f32 v129, s23, v129
    v_mul_f32 v130, s23, v130
    v_mul_f32 v131, s23, v131
    v_mul_f32 v132, s23, v132
    v_mul_f32 v133, s23, v133
    v_mul_f32 v134, s23, v134
    v_mul_f32 v135, s23, v135
    v_cvt_pk_bf16_f32 v16, v120, v121
    v_cvt_pk_bf16_f32 v17, v122, v123
    v_cvt_pk_bf16_f32 v18, v124, v125
    v_cvt_pk_bf16_f32 v19, v126, v127
    v_cvt_pk_bf16_f32 v20, v128, v129
    v_cvt_pk_bf16_f32 v21, v130, v131
    v_cvt_pk_bf16_f32 v22, v132, v133
    v_cvt_pk_bf16_f32 v23, v134, v135
    buffer_store_dwordx4 v[16:19], v9, s[12:15], s26 offen
    buffer_store_dwordx4 v[20:23], v9, s[12:15], s26 offen offset:1024
    s_waitcnt vmcnt(2)
    v_lshlrev_b32 v6, 5, v2
    v_mov_b32 v7, 0
    s_bitcmp0_b32 s2, 5
    s_cbranch_scc1 L_sj_emv2D
    v_lshlrev_b32 v240, 16, v200
    v_and_b32 v241, 0xffff0000, v200
    v_lshlrev_b32 v242, 16, v208
    v_and_b32 v243, 0xffff0000, v208
    v_add_f32 v244, v240, v242
    v_add_f32 v245, v241, v243
    v_sub_f32 v246, v240, v242
    v_sub_f32 v247, v241, v243
    v_cvt_pk_bf16_f32 v224, v244, v245
    v_cvt_pk_bf16_f32 v232, v246, v247
    v_dot2c_f32_bf16 v7, v224, v216
    v_lshlrev_b32 v240, 16, v201
    v_and_b32 v241, 0xffff0000, v201
    v_lshlrev_b32 v242, 16, v209
    v_and_b32 v243, 0xffff0000, v209
    v_add_f32 v244, v240, v242
    v_add_f32 v245, v241, v243
    v_sub_f32 v246, v240, v242
    v_sub_f32 v247, v241, v243
    v_cvt_pk_bf16_f32 v225, v244, v245
    v_cvt_pk_bf16_f32 v233, v246, v247
    v_dot2c_f32_bf16 v7, v225, v217
    v_lshlrev_b32 v240, 16, v202
    v_and_b32 v241, 0xffff0000, v202
    v_lshlrev_b32 v242, 16, v210
    v_and_b32 v243, 0xffff0000, v210
    v_add_f32 v244, v240, v242
    v_add_f32 v245, v241, v243
    v_sub_f32 v246, v240, v242
    v_sub_f32 v247, v241, v243
    v_cvt_pk_bf16_f32 v226, v244, v245
    v_cvt_pk_bf16_f32 v234, v246, v247
    v_dot2c_f32_bf16 v7, v226, v218
    v_lshlrev_b32 v240, 16, v203
    v_and_b32 v241, 0xffff0000, v203
    v_lshlrev_b32 v242, 16, v211
    v_and_b32 v243, 0xffff0000, v211
    v_add_f32 v244, v240, v242
    v_add_f32 v245, v241, v243
    v_sub_f32 v246, v240, v242
    v_sub_f32 v247, v241, v243
    v_cvt_pk_bf16_f32 v227, v244, v245
    v_cvt_pk_bf16_f32 v235, v246, v247
    v_dot2c_f32_bf16 v7, v227, v219
    v_lshlrev_b32 v240, 16, v204
    v_and_b32 v241, 0xffff0000, v204
    v_lshlrev_b32 v242, 16, v212
    v_and_b32 v243, 0xffff0000, v212
    v_add_f32 v244, v240, v242
    v_add_f32 v245, v241, v243
    v_sub_f32 v246, v240, v242
    v_sub_f32 v247, v241, v243
    v_cvt_pk_bf16_f32 v228, v244, v245
    v_cvt_pk_bf16_f32 v236, v246, v247
    v_dot2c_f32_bf16 v7, v228, v220
    v_lshlrev_b32 v240, 16, v205
    v_and_b32 v241, 0xffff0000, v205
    v_lshlrev_b32 v242, 16, v213
    v_and_b32 v243, 0xffff0000, v213
    v_add_f32 v244, v240, v242
    v_add_f32 v245, v241, v243
    v_sub_f32 v246, v240, v242
    v_sub_f32 v247, v241, v243
    v_cvt_pk_bf16_f32 v229, v244, v245
    v_cvt_pk_bf16_f32 v237, v246, v247
    v_dot2c_f32_bf16 v7, v229, v221
    v_lshlrev_b32 v240, 16, v206
    v_and_b32 v241, 0xffff0000, v206
    v_lshlrev_b32 v242, 16, v214
    v_and_b32 v243, 0xffff0000, v214
    v_add_f32 v244, v240, v242
    v_add_f32 v245, v241, v243
    v_sub_f32 v246, v240, v242
    v_sub_f32 v247, v241, v243
    v_cvt_pk_bf16_f32 v230, v244, v245
    v_cvt_pk_bf16_f32 v238, v246, v247
    v_dot2c_f32_bf16 v7, v230, v222
    v_lshlrev_b32 v240, 16, v207
    v_and_b32 v241, 0xffff0000, v207
    v_lshlrev_b32 v242, 16, v215
    v_and_b32 v243, 0xffff0000, v215
    v_add_f32 v244, v240, v242
    v_add_f32 v245, v241, v243
    v_sub_f32 v246, v240, v242
    v_sub_f32 v247, v241, v243
    v_cvt_pk_bf16_f32 v231, v244, v245
    v_cvt_pk_bf16_f32 v239, v246, v247
    v_dot2c_f32_bf16 v7, v231, v223
    s_lshl_b32 s23, s64, 11
    s_add_u32 s31, s23, 30408704
    s_add_u32 s23, s23, 27262976
    buffer_store_dwordx4 v[224:227], v6, s[12:15], s23 offen
    buffer_store_dwordx4 v[228:231], v6, s[12:15], s23 offen offset:16
    buffer_store_dwordx4 v[232:235], v6, s[12:15], s31 offen
    buffer_store_dwordx4 v[236:239], v6, s[12:15], s31 offen offset:16
    s_nop 1
    v_add_f32_dpp v7, v7, v7 row_ror:8 row_mask:0xf bank_mask:0xf
    s_nop 1
    v_add_f32_dpp v7, v7, v7 row_ror:4 row_mask:0xf bank_mask:0xf
    s_nop 1
    v_add_f32_dpp v7, v7, v7 row_ror:2 row_mask:0xf bank_mask:0xf
    s_nop 1
    v_add_f32_dpp v7, v7, v7 row_ror:1 row_mask:0xf bank_mask:0xf
    v_mov_b32 v3, v7
    s_nop 1
    v_permlane16_swap_b32 v7, v3
    s_nop 1
    v_add_f32 v7, v7, v3
    v_mov_b32 v3, v7
    s_nop 1
    v_permlane32_swap_b32 v7, v3
    s_nop 1
    v_add_f32 v7, v7, v3
    v_cvt_pk_bf16_f32 v7, v7, v7
    s_lshl_b32 s23, s64, 1
    s_add_u32 s23, s23, 34668544
    v_mov_b32 v4, 0
    s_mov_b64 exec, 1
    buffer_store_short v7, v4, s[12:15], s23 offen
    s_mov_b64 exec, -1
    s_branch L_sj_doneD
L_sj_emv2D:
    s_cmp_gt_u32 s64, 512
    s_cbranch_scc1 L_sj_doneD
    v_dot2c_f32_bf16 v7, v200, v216
    v_dot2c_f32_bf16 v7, v201, v217
    v_dot2c_f32_bf16 v7, v202, v218
    v_dot2c_f32_bf16 v7, v203, v219
    v_dot2c_f32_bf16 v7, v204, v220
    v_dot2c_f32_bf16 v7, v205, v221
    v_dot2c_f32_bf16 v7, v206, v222
    v_dot2c_f32_bf16 v7, v207, v223
    s_nop 3
    s_nop 1
    v_add_f32_dpp v7, v7, v7 row_ror:8 row_mask:0xf bank_mask:0xf
    s_nop 1
    v_add_f32_dpp v7, v7, v7 row_ror:4 row_mask:0xf bank_mask:0xf
    s_nop 1
    v_add_f32_dpp v7, v7, v7 row_ror:2 row_mask:0xf bank_mask:0xf
    s_nop 1
    v_add_f32_dpp v7, v7, v7 row_ror:1 row_mask:0xf bank_mask:0xf
    v_mov_b32 v3, v7
    s_nop 1
    v_permlane16_swap_b32 v7, v3
    s_nop 1
    v_add_f32 v7, v7, v3
    v_mov_b32 v3, v7
    s_nop 1
    v_permlane32_swap_b32 v7, v3
    s_nop 1
    v_add_f32 v7, v7, v3
    v_mov_b32 v5, 0
    v_cvt_pk_bf16_f32 v7, v7, v5
    v_cmp_eq_u32 vcc, 0, v2
    s_mul_i32 s23, s64, 2176
    s_add_u32 s31, s23, 35653632
    s_add_u32 s23, s23, 33556480
    v_cndmask_b32 v7, v5, v7, vcc
    v_lshlrev_b32 v4, 2, v2
    s_mov_b32 exec_hi, 0
    buffer_store_dword v7, v4, s[12:15], s23 offen
    buffer_store_dword v5, v4, s[12:15], s31 offen
    s_mov_b64 exec, -1
L_sj_doneD:
L_qg_done:
L_k1_end:
    s_endpgm
.globl k2_kernel
.p2align 8
.type k2_kernel,@function
k2_kernel:
    s_cmp_ge_u32 s2, 256
    s_cbranch_scc1 L_k2_end
    s_load_dwordx4 s[32:35], s[0:1], 0
    s_load_dwordx2 s[50:51], s[0:1], 64
    s_load_dwordx2 s[52:53], s[0:1], 72
    s_load_dwordx2 s[88:89], s[0:1], 32
    s_load_dwordx4 s[92:95], s[0:1], 48
    s_load_dwordx2 s[48:49], s[0:1], 96
    s_waitcnt lgkmcnt(0)
    s_mov_b32 s12, s48
    s_mov_b32 s13, s49
    s_mov_b32 s14, 41943040
    s_mov_b32 s15, 0x00020000
    s_mov_b32 s36, s34
    s_mov_b32 s37, s35
    s_mov_b32 s38, 2097152
    s_mov_b32 s39, 0x00020000
    s_mov_b32 s44, s32
    s_mov_b32 s45, s33
    s_mov_b32 s46, 4194304
    s_mov_b32 s47, 0x00020000
    s_and_b32 s30, s2, 7
    s_lshr_b32 s31, s2, 3
    s_and_b32 s54, s30, 3
    s_lshl_b32 s54, s54, 2
    s_and_b32 s55, s31, 3
    s_add_u32 s54, s54, s55
    s_lshr_b32 s55, s30, 2
    s_lshl_b32 s55, s55, 3
    s_lshr_b32 s56, s31, 2
    s_add_u32 s55, s55, s56
    s_lshl_b32 s16, s55, 7
    s_lshl_b32 s17, s54, 18
    s_add_u32 s26, s17, s16
    v_lshrrev_b32 v1, 6, v0
    s_nop 0
    v_readfirstlane_b32 s22, v1
    v_and_b32 v2, 63, v0
    s_nop 2
    s_lshl_b32 s18, s22, 10
    v_lshlrev_b32 v3, 4, v2
    s_lshl_b32 s23, s2, 14
    s_lshl_b32 s30, s22, 11
    s_add_u32 s23, s23, s30
    buffer_load_dwordx4 v[16:19], v3, s[12:15], s23 offen
    buffer_load_dwordx4 v[20:23], v3, s[12:15], s23 offen offset:1024
    v_lshlrev_b32 v9, 4, v2
    v_lshl_add_u32 v12, v1, 10, v9
    v_add_u32 v12, 4194304, v12
    v_add_u32 v13, 8192, v12
    v_add_u32 v14, 16384, v12
    v_add_u32 v15, 24576, v12
    s_add_u32 m0, s18, 0
    s_mov_b32 s19, 0
    buffer_load_dwordx4 v12, s[12:15], s19 offen lds
    s_add_u32 m0, s18, 8192
    s_mov_b32 s19, 0
    buffer_load_dwordx4 v13, s[12:15], s19 offen lds
    s_add_u32 m0, s18, 16384
    s_mov_b32 s19, 0
    buffer_load_dwordx4 v14, s[12:15], s19 offen lds
    s_add_u32 m0, s18, 24576
    s_mov_b32 s19, 0
    buffer_load_dwordx4 v15, s[12:15], s19 offen lds
    s_add_u32 m0, s18, 32768
    s_mov_b32 s19, 32768
    buffer_load_dwordx4 v12, s[12:15], s19 offen lds
    s_add_u32 m0, s18, 40960
    s_mov_b32 s19, 32768
    buffer_load_dwordx4 v13, s[12:15], s19 offen lds
    s_add_u32 m0, s18, 49152
    s_mov_b32 s19, 32768
    buffer_load_dwordx4 v14, s[12:15], s19 offen lds
    s_add_u32 m0, s18, 57344
    s_mov_b32 s19, 32768
    buffer_load_dwordx4 v15, s[12:15], s19 offen lds
    v_and_b32 v5, 31, v2
    v_and_b32 v4, 3, v1
    v_lshl_add_u32 v4, v4, 5, v5
    v_lshrrev_b32 v5, 5, v2
    v_lshlrev_b32 v5, 4, v5
    v_lshl_add_u32 v8, v4, 11, v5
    v_lshrrev_b32 v5, 2, v1
    v_lshl_add_u32 v8, v5, 6, v8
    s_mov_b32 s28, 1837105152
    s_mov_b32 s29, 2071986176
    v_mov_b32 v10, v9
    v_add_u32 v11, 65536, v9
    s_and_b32 s30, s2, 7
    s_lshr_b32 s31, s2, 3
    s_and_b32 s31, s31, 15
    s_and_b32 s54, s30, 3
    s_lshl_b32 s54, s54, 2
    s_and_b32 s55, s31, 3
    s_add_u32 s54, s54, s55
    s_lshr_b32 s55, s30, 2
    s_lshl_b32 s55, s55, 2
    s_lshr_b32 s56, s31, 2
    s_add_u32 s55, s55, s56
    s_cmp_ge_u32 s2, 128
    s_cselect_b32 s8, s52, s50
    s_cselect_b32 s9, s53, s51
    s_cselect_b32 s56, 3145728, 0
    s_cselect_b32 s57, 2097152, 0
    s_add_u32 s56, s56, 27262976
    s_add_u32 s57, s57, 33554432
    s_mov_b32 s10, 2097152
    s_mov_b32 s11, 0x00020000
    s_mov_b32 s4, s48
    s_mov_b32 s5, s49
    s_mov_b32 s6, 41943040
    s_mov_b32 s7, 0x00020000
    s_lshl_b32 s40, s54, 17
    s_add_u32 s40, s40, s56
    s_add_u32 s42, s40, 128
    s_lshl_b32 s41, s55, 17
    s_add_u32 s43, s41, 128
    s_mul_i32 s21, s55, 139264
    s_add_u32 s21, s21, s57
    s_lshl_b32 s23, s54, 7
    s_add_u32 s21, s21, s23
    v_lshrrev_b32 v3, 3, v2
    v_lshl_add_u32 v3, v1, 3, v3
    v_bfe_u32 v4, v3, 1, 3
    v_and_b32 v5, 7, v2
    v_xor_b32 v4, v4, v5
    v_lshlrev_b32 v4, 4, v4
    s_mov_b32 s23, 2048
    v_mul_lo_u32 v3, v3, s23
    v_add_u32 v68, v3, v4
    s_lshr_b32 s25, s22, 2
    s_and_b32 s27, s22, 2
    s_lshl_b32 s27, s27, 1
    s_lshl_b32 s25, s25, 7
    v_and_b32 v3, 31, v2
    v_bfe_u32 v4, v3, 1, 3
    v_lshrrev_b32 v5, 5, v2
    v_xor_b32 v4, v4, v5
    v_xor_b32 v4, s27, v4
    v_add_u32 v3, s25, v3
    v_lshlrev_b32 v3, 7, v3
    v_lshl_add_u32 v3, v4, 4, v3
    v_add_u32 v24, 98304, v3
    v_xor_b32 v25, 32, v24
    v_add_u32 v28, 131072, v3
    v_xor_b32 v29, 32, v28
    s_and_b32 s23, s22, 1
    s_lshl_b32 s23, s23, 5
    s_add_u32 s25, s25, s23
    v_and_b32 v3, 31, v2
    v_bfe_u32 v4, v3, 1, 3
    v_lshrrev_b32 v5, 5, v2
    v_xor_b32 v4, v4, v5
    v_xor_b32 v4, s27, v4
    v_add_u32 v3, s25, v3
    v_lshlrev_b32 v3, 7, v3
    v_lshl_add_u32 v3, v4, 4, v3
    v_add_u32 v26, 106496, v3
    v_xor_b32 v27, 32, v26
    v_add_u32 v30, 139264, v3
    v_xor_b32 v31, 32, v30
    v_mov_b32 v200, 0
    v_mov_b32 v201, 0
    v_mov_b32 v202, 0
    v_mov_b32 v203, 0
    v_mov_b32 v204, 0
    v_mov_b32 v205, 0
    v_mov_b32 v206, 0
    v_mov_b32 v207, 0
    v_mov_b32 v208, 0
    v_mov_b32 v209, 0
    v_mov_b32 v210, 0
    v_mov_b32 v211, 0
    v_mov_b32 v212, 0
    v_mov_b32 v213, 0
    v_mov_b32 v214, 0
    v_mov_b32 v215, 0
    v_mov_b32 v216, 0
    v_mov_b32 v217, 0
    v_mov_b32 v218, 0
    v_mov_b32 v219, 0
    v_mov_b32 v220, 0
    v_mov_b32 v221, 0
    v_mov_b32 v222, 0
    v_mov_b32 v223, 0
    v_mov_b32 v224, 0
    v_mov_b32 v225, 0
    v_mov_b32 v226, 0
    v_mov_b32 v227, 0
    v_mov_b32 v228, 0
    v_mov_b32 v229, 0
    v_mov_b32 v230, 0
    v_mov_b32 v231, 0
    s_lshl_b32 s58, s2, 3
    s_add_u32 s58, s58, s22
    s_lshr_b32 s61, s58, 1
    s_bitcmp1_b32 s58, 0
    s_cselect_b32 s76, s94, s92
    s_cselect_b32 s77, s95, s93
    s_cselect_b32 s60, 1.0, -1.0
    s_mov_b32 s78, 8388608
    s_mov_b32 s79, 0x00020000
    s_sub_u32 s62, 2048, s61
    s_and_b32 s62, s62, 2047
    s_lshl_b32 s61, s61, 12
    s_lshl_b32 s62, s62, 12
    s_bitcmp1_b32 s58, 0
    s_mov_b32 s59, 0xbf80
    s_cselect_b32 s59, 0x3f80, s59
    v_and_b32 v3, 15, v2
    v_bfe_u32 v4, v2, 4, 1
    v_lshlrev_b32 v4, 3, v4
    v_cmp_gt_u32 vcc, 32, v2
    v_mov_b32 v5, s59
    v_mov_b32 v6, 0x3f80
    v_sub_u32 v7, 15, v3
    v_cndmask_b32 v5, v5, v6, vcc
    v_cndmask_b32 v7, v7, v3, vcc
    v_sub_u32 v3, v3, v4
    v_sub_u32 v7, v7, v4
    v_and_b32 v4, 1, v3
    v_lshlrev_b32 v4, 4, v4
    v_lshlrev_b32 v4, v4, v5
    v_lshrrev_b32 v6, 1, v3
    v_cmp_eq_u32 vcc, 0, v6
    s_nop 1
    v_cndmask_b32 v192, 0, v4, vcc
    v_cmp_eq_u32 vcc, 1, v6
    s_nop 1
    v_cndmask_b32 v193, 0, v4, vcc
    v_cmp_eq_u32 vcc, 2, v6
    s_nop 1
    v_cndmask_b32 v194, 0, v4, vcc
    v_cmp_eq_u32 vcc, 3, v6
    s_nop 1
    v_cndmask_b32 v195, 0, v4, vcc
    v_and_b32 v4, 1, v7
    v_lshlrev_b32 v4, 4, v4
    v_lshlrev_b32 v4, v4, v5
    v_lshrrev_b32 v6, 1, v7
    v_cmp_eq_u32 vcc, 0, v6
    s_nop 1
    v_cndmask_b32 v196, 0, v4, vcc
    v_cmp_eq_u32 vcc, 1, v6
    s_nop 1
    v_cndmask_b32 v197, 0, v4, vcc
    v_cmp_eq_u32 vcc, 2, v6
    s_nop 1
    v_cndmask_b32 v198, 0, v4, vcc
    v_cmp_eq_u32 vcc, 3, v6
    s_nop 1
    v_cndmask_b32 v199, 0, v4, vcc
    v_and_b32 v3, 15, v2
    v_lshlrev_b32 v3, 5, v3
    v_bfe_u32 v4, v2, 4, 1
    v_lshlrev_b32 v4, 4, v4
    v_add_u32 v5, v3, v4
    v_sub_u32 v6, v4, v3
    v_add_u32 v6, 4064, v6
    v_add_u32 v7, 2, v5
    v_cmp_gt_u32 vcc, 32, v2
    v_mov_b32 v3, s62
    v_mov_b32 v4, s61
    v_cndmask_b32 v6, v6, v7, vcc
    v_cndmask_b32 v3, v3, v4, vcc
    v_add_u32 v71, s61, v6
    v_add_u32 v69, v3, v5
    s_mov_b32 s63, 0
    v_lshrrev_b32 v4, 2, v2
    v_lshrrev_b32 v5, 4, v2
    v_xor_b32 v4, v4, v5
    v_and_b32 v4, 1, v4
    v_cmp_eq_u32 vcc, 0, v4
    v_mov_b32 v5, 0x3f803f80
    s_nop 1
    v_cndmask_b32 v56, 0, v5, vcc
    v_mov_b32 v57, v56
    v_mov_b32 v58, v56
    v_mov_b32 v59, v56
    v_mov_b32 v136, 0
    v_mov_b32 v137, 0
    v_mov_b32 v138, 0
    v_mov_b32 v139, 0
    v_mov_b32 v140, 0
    v_mov_b32 v141, 0
    v_mov_b32 v142, 0
    v_mov_b32 v143, 0
    v_mov_b32 v144, 0
    v_mov_b32 v145, 0
    v_mov_b32 v146, 0
    v_mov_b32 v147, 0
    v_mov_b32 v148, 0
    v_mov_b32 v149, 0
    v_mov_b32 v150, 0
    v_mov_b32 v151, 0
    v_mov_b32 v64, 0
    v_mov_b32 v65, 0
    v_mov_b32 v66, 0
    v_mov_b32 v67, 0
    v_mov_b32 v70, 0
    s_add_u32 m0, s18, 98304
    s_nop 0
    buffer_load_dwordx4 v68, s[4:7], s40 offen lds
    s_add_u32 s40, s40, 256
    s_add_u32 m0, s18, 106496
    s_nop 0
    buffer_load_dwordx4 v68, s[8:11], s41 offen lds
    s_add_u32 s41, s41, 256
    s_add_u32 m0, s18, 114688
    s_nop 0
    buffer_load_dwordx4 v68, s[4:7], s42 offen lds
    s_add_u32 s42, s42, 256
    s_add_u32 m0, s18, 122880
    s_nop 0
    buffer_load_dwordx4 v68, s[8:11], s43 offen lds
    s_add_u32 s43, s43, 256
    s_add_u32 m0, s18, 131072
    s_nop 0
    buffer_load_dwordx4 v68, s[4:7], s40 offen lds
    s_add_u32 s40, s40, 256
    s_add_u32 m0, s18, 139264
    s_nop 0
    buffer_load_dwordx4 v68, s[8:11], s41 offen lds
    s_add_u32 s41, s41, 256
    s_add_u32 m0, s18, 147456
    s_nop 0
    buffer_load_dwordx4 v68, s[4:7], s42 offen lds
    s_add_u32 s42, s42, 256
    s_add_u32 m0, s18, 155648
    s_nop 0
    buffer_load_dwordx4 v68, s[8:11], s43 offen lds
    s_add_u32 s43, s43, 256
    s_waitcnt vmcnt(12)
    s_barrier
    ds_read_b128 v[32:35], v10
    ds_read_b128 v[36:39], v10 offset:1024
    s_waitcnt lgkmcnt(0)
    v_mfma_f32_32x32x16_bf16 v[88:103], v[32:35], v[16:19], 0
    v_mfma_f32_32x32x16_bf16 v[88:103], v[36:39], v[20:23], v[88:103]
    ds_read_b128 v[32:35], v10 offset:4096
    ds_read_b128 v[36:39], v10 offset:5120
    ds_read_b128 v[44:47], v10 offset:3072
    ds_read_b128 v[40:43], v10 offset:2048
    s_nop 11
    v_max3_f32 v5, v88, v89, v90
    v_max3_f32 v5, v91, v92, v5
    v_max3_f32 v5, v93, v94, v5
    v_max3_f32 v5, v95, v96, v5
    v_max3_f32 v5, v97, v98, v5
    v_max3_f32 v5, v99, v100, v5
    v_max3_f32 v5, v101, v102, v5
    v_max_f32 v5, v103, v5
    v_mov_b32 v6, v5
    s_nop 1
    v_permlane32_swap_b32 v5, v6
    s_nop 1
    v_max_f32 v5, v5, v6
    v_add_f32 v5, 1120403456, v5
    v_sub_f32 v72, 0, v5
    v_sub_f32 v73, 0, v5
    v_sub_f32 v74, 0, v5
    v_sub_f32 v75, 0, v5
    v_sub_f32 v76, 0, v5
    v_sub_f32 v77, 0, v5
    v_sub_f32 v78, 0, v5
    v_sub_f32 v79, 0, v5
    v_sub_f32 v80, 0, v5
    v_sub_f32 v81, 0, v5
    v_sub_f32 v82, 0, v5
    v_sub_f32 v83, 0, v5
    v_sub_f32 v84, 0, v5
    v_sub_f32 v85, 0, v5
    v_sub_f32 v86, 0, v5
    v_sub_f32 v87, 0, v5
    v_sub_f32 v88, v88, v5
    v_sub_f32 v89, v89, v5
    v_sub_f32 v90, v90, v5
    v_sub_f32 v91, v91, v5
    v_sub_f32 v92, v92, v5
    v_sub_f32 v93, v93, v5
    v_sub_f32 v94, v94, v5
    v_sub_f32 v95, v95, v5
    v_sub_f32 v96, v96, v5
    v_sub_f32 v97, v97, v5
    v_sub_f32 v98, v98, v5
    v_sub_f32 v99, v99, v5
    v_sub_f32 v100, v100, v5
    v_sub_f32 v101, v101, v5
    v_sub_f32 v102, v102, v5
    v_sub_f32 v103, v103, v5
    s_waitcnt lgkmcnt(2)
    v_mfma_f32_32x32x16_bf16 v[104:119], v[32:35], v[16:19], v[72:87]
    v_exp_f32 v88, v88
    v_exp_f32 v89, v89
    v_exp_f32 v90, v90
    v_exp_f32 v91, v91
    s_waitcnt lgkmcnt(0)
    v_exp_f32 v92, v92
    v_exp_f32 v93, v93
    v_exp_f32 v94, v94
    v_exp_f32 v95, v95
    v_cvt_pk_bf16_f32 v48, v88, v89
    v_cvt_pk_bf16_f32 v49, v90, v91
    v_cvt_pk_bf16_f32 v50, v92, v93
    v_cvt_pk_bf16_f32 v51, v94, v95
    v_mfma_f32_32x32x16_bf16 v[104:119], v[36:39], v[20:23], v[104:119]
    ds_read_b128 v[32:35], v10 offset:8192
    ds_read_b128 v[36:39], v10 offset:9216
    v_exp_f32 v96, v96
    v_exp_f32 v97, v97
    v_exp_f32 v98, v98
    v_exp_f32 v99, v99
    v_mfma_f32_32x32x16_bf16 v[120:135], v[40:43], v[48:51], v[136:151]
    ds_read_b128 v[44:47], v10 offset:3072
    ds_read_b128 v[40:43], v10 offset:6144
    v_exp_f32 v100, v100
    v_exp_f32 v101, v101
    v_exp_f32 v102, v102
    v_exp_f32 v103, v103
    v_mfma_f32_16x16x32_bf16 v[60:63], v[56:59], v[48:51], v[64:67]
    v_cvt_pk_bf16_f32 v52, v96, v97
    v_cvt_pk_bf16_f32 v53, v98, v99
    v_cvt_pk_bf16_f32 v54, v100, v101
    v_cvt_pk_bf16_f32 v55, v102, v103
    s_waitcnt lgkmcnt(2)
    v_mfma_f32_32x32x16_bf16 v[88:103], v[32:35], v[16:19], v[72:87]
    v_exp_f32 v104, v104
    v_exp_f32 v105, v105
    v_exp_f32 v106, v106
    v_exp_f32 v107, v107
    s_waitcnt lgkmcnt(0)
    v_mfma_f32_32x32x16_bf16 v[120:135], v[44:47], v[52:55], v[120:135]
    v_exp_f32 v108, v108
    v_exp_f32 v109, v109
    v_exp_f32 v110, v110
    v_exp_f32 v111, v111
    v_mfma_f32_16x16x32_bf16 v[60:63], v[56:59], v[52:55], v[60:63]
    v_cvt_pk_bf16_f32 v48, v104, v105
    v_cvt_pk_bf16_f32 v49, v106, v107
    v_cvt_pk_bf16_f32 v50, v108, v109
    v_cvt_pk_bf16_f32 v51, v110, v111
    v_mfma_f32_32x32x16_bf16 v[88:103], v[36:39], v[20:23], v[88:103]
    ds_read_b128 v[32:35], v10 offset:12288
    ds_read_b128 v[36:39], v10 offset:13312
    v_exp_f32 v112, v112
    v_exp_f32 v113, v113
    v_exp_f32 v114, v114
    v_exp_f32 v115, v115
    v_mfma_f32_32x32x16_bf16 v[120:135], v[40:43], v[48:51], v[120:135]
    ds_read_b128 v[44:47], v10 offset:7168
    ds_read_b128 v[40:43], v10 offset:10240
    v_exp_f32 v116, v116
    v_exp_f32 v117, v117
    v_exp_f32 v118, v118
    v_exp_f32 v119, v119
    v_mfma_f32_16x16x32_bf16 v[60:63], v[56:59], v[48:51], v[60:63]
    v_cvt_pk_bf16_f32 v52, v112, v113
    v_cvt_pk_bf16_f32 v53, v114, v115
    v_cvt_pk_bf16_f32 v54, v116, v117
    v_cvt_pk_bf16_f32 v55, v118, v119
    s_waitcnt lgkmcnt(2)
    v_mfma_f32_32x32x16_bf16 v[104:119], v[32:35], v[16:19], v[72:87]
    v_exp_f32 v88, v88
    v_exp_f32 v89, v89
    v_exp_f32 v90, v90
    v_exp_f32 v91, v91
    s_waitcnt lgkmcnt(0)
    v_mfma_f32_32x32x16_bf16 v[120:135], v[44:47], v[52:55], v[120:135]
    v_exp_f32 v92, v92
    v_exp_f32 v93, v93
    v_exp_f32 v94, v94
    v_exp_f32 v95, v95
    v_mfma_f32_16x16x32_bf16 v[60:63], v[56:59], v[52:55], v[60:63]
    v_cvt_pk_bf16_f32 v48, v88, v89
    v_cvt_pk_bf16_f32 v49, v90, v91
    v_cvt_pk_bf16_f32 v50, v92, v93
    v_cvt_pk_bf16_f32 v51, v94, v95
    v_mfma_f32_32x32x16_bf16 v[104:119], v[36:39], v[20:23], v[104:119]
    ds_read_b128 v[32:35], v10 offset:16384
    ds_read_b128 v[36:39], v10 offset:17408
    v_exp_f32 v96, v96
    v_exp_f32 v97, v97
    v_exp_f32 v98, v98
    v_exp_f32 v99, v99
    v_mfma_f32_32x32x16_bf16 v[120:135], v[40:43], v[48:51], v[120:135]
    ds_read_b128 v[44:47], v10 offset:11264
    ds_read_b128 v[40:43], v10 offset:14336
    v_exp_f32 v100, v100
    v_exp_f32 v101, v101
    v_exp_f32 v102, v102
    v_exp_f32 v103, v103
    v_mfma_f32_16x16x32_bf16 v[60:63], v[56:59], v[48:51], v[60:63]
    v_cvt_pk_bf16_f32 v52, v96, v97
    v_cvt_pk_bf16_f32 v53, v98, v99
    v_cvt_pk_bf16_f32 v54, v100, v101
    v_cvt_pk_bf16_f32 v55, v102, v103
    s_waitcnt vmcnt(0)
    s_barrier
    s_waitcnt lgkmcnt(2)
    v_mfma_f32_32x32x16_bf16 v[88:103], v[32:35], v[16:19], v[72:87]
    v_exp_f32 v104, v104
    v_exp_f32 v105, v105
    v_exp_f32 v106, v106
    v_exp_f32 v107, v107
    s_waitcnt lgkmcnt(0)
    v_mfma_f32_32x32x16_bf16 v[120:135], v[44:47], v[52:55], v[120:135]
    v_exp_f32 v108, v108
    v_exp_f32 v109, v109
    v_exp_f32 v110, v110
    v_exp_f32 v111, v111
    v_mfma_f32_16x16x32_bf16 v[60:63], v[56:59], v[52:55], v[60:63]
    v_cvt_pk_bf16_f32 v48, v104, v105
    v_cvt_pk_bf16_f32 v49, v106, v107
    v_cvt_pk_bf16_f32 v50, v108, v109
    v_cvt_pk_bf16_f32 v51, v110, v111
    v_mfma_f32_32x32x16_bf16 v[88:103], v[36:39], v[20:23], v[88:103]
    ds_read_b128 v[32:35], v10 offset:20480
    ds_read_b128 v[36:39], v10 offset:21504
    v_exp_f32 v112, v112
    v_exp_f32 v113, v113
    v_exp_f32 v114, v114
    v_exp_f32 v115, v115
    v_mfma_f32_32x32x16_bf16 v[120:135], v[40:43], v[48:51], v[120:135]
    ds_read_b128 v[44:47], v10 offset:15360
    ds_read_b128 v[40:43], v10 offset:18432
    v_exp_f32 v116, v116
    v_exp_f32 v117, v117
    v_exp_f32 v118, v118
    v_exp_f32 v119, v119
    v_mfma_f32_16x16x32_bf16 v[60:63], v[56:59], v[48:51], v[60:63]
    ds_read_b128 v[232:235], v24
    ds_read_b128 v[236:239], v24 offset:4096
    ds_read_b128 v[240:243], v26
    ds_read_b128 v[244:247], v25
    ds_read_b128 v[248:251], v25 offset:4096
    ds_read_b128 v[252:255], v27
    v_cvt_pk_bf16_f32 v52, v112, v113
    v_cvt_pk_bf16_f32 v53, v114, v115
    v_cvt_pk_bf16_f32 v54, v116, v117
    v_cvt_pk_bf16_f32 v55, v118, v119
    s_waitcnt lgkmcnt(8)
    v_mfma_f32_32x32x16_bf16 v[104:119], v[32:35], v[16:19], v[72:87]
    v_exp_f32 v88, v88
    v_exp_f32 v89, v89
    v_exp_f32 v90, v90
    v_exp_f32 v91, v91
    s_waitcnt lgkmcnt(0)
    buffer_load_dwordx4 v[152:155], v69, s[76:79], 0 offen offset:0
    v_mfma_f32_32x32x16_bf16 v[120:135], v[44:47], v[52:55], v[120:135]
    v_exp_f32 v92, v92
    v_exp_f32 v93, v93
    v_mfma_f32_32x32x16_bf16 v[200:215], v[232:235], v[240:243], v[200:215]
    v_exp_f32 v94, v94
    v_exp_f32 v95, v95
    v_mfma_f32_16x16x32_bf16 v[60:63], v[56:59], v[52:55], v[60:63]
    v_cvt_pk_bf16_f32 v48, v88, v89
    v_cvt_pk_bf16_f32 v49, v90, v91
    v_cvt_pk_bf16_f32 v50, v92, v93
    v_cvt_pk_bf16_f32 v51, v94, v95
    v_mfma_f32_32x32x16_bf16 v[104:119], v[36:39], v[20:23], v[104:119]
    ds_read_b128 v[32:35], v10 offset:24576
    ds_read_b128 v[36:39], v10 offset:25600
    v_exp_f32 v96, v96
    v_exp_f32 v97, v97
    v_mfma_f32_32x32x16_bf16 v[216:231], v[236:239], v[240:243], v[216:231]
    v_exp_f32 v98, v98
    v_exp_f32 v99, v99
    v_mfma_f32_32x32x16_bf16 v[120:135], v[40:43], v[48:51], v[120:135]
    ds_read_b128 v[44:47], v10 offset:19456
    ds_read_b128 v[40:43], v10 offset:22528
    v_exp_f32 v100, v100
    v_exp_f32 v101, v101
    v_mfma_f32_32x32x16_bf16 v[200:215], v[244:247], v[252:255], v[200:215]
    v_exp_f32 v102, v102
    v_exp_f32 v103, v103
    v_mfma_f32_16x16x32_bf16 v[60:63], v[56:59], v[48:51], v[60:63]
    v_cvt_pk_bf16_f32 v52, v96, v97
    v_cvt_pk_bf16_f32 v53, v98, v99
    v_cvt_pk_bf16_f32 v54, v100, v101
    v_cvt_pk_bf16_f32 v55, v102, v103
    v_mfma_f32_32x32x16_bf16 v[216:231], v[248:251], v[252:255], v[216:231]
    s_waitcnt lgkmcnt(2)
    v_mfma_f32_32x32x16_bf16 v[88:103], v[32:35], v[16:19], v[72:87]
    v_exp_f32 v104, v104
    v_exp_f32 v105, v105
    v_exp_f32 v106, v106
    v_exp_f32 v107, v107
    s_waitcnt lgkmcnt(0)
    v_mfma_f32_32x32x16_bf16 v[120:135], v[44:47], v[52:55], v[120:135]
    v_exp_f32 v108, v108
    v_exp_f32 v109, v109
    v_exp_f32 v110, v110
    v_exp_f32 v111, v111
    v_mfma_f32_16x16x32_bf16 v[60:63], v[56:59], v[52:55], v[60:63]
    v_cvt_pk_bf16_f32 v48, v104, v105
    v_cvt_pk_bf16_f32 v49, v106, v107
    v_cvt_pk_bf16_f32 v50, v108, v109
    v_cvt_pk_bf16_f32 v51, v110, v111
    v_mfma_f32_32x32x16_bf16 v[88:103], v[36:39], v[20:23], v[88:103]
    ds_read_b128 v[32:35], v10 offset:28672
    ds_read_b128 v[36:39], v10 offset:29696
    v_exp_f32 v112, v112
    v_exp_f32 v113, v113
    v_exp_f32 v114, v114
    v_exp_f32 v115, v115
    v_mfma_f32_32x32x16_bf16 v[120:135], v[40:43], v[48:51], v[120:135]
    ds_read_b128 v[44:47], v10 offset:23552
    ds_read_b128 v[40:43], v10 offset:26624
    v_exp_f32 v116, v116
    v_exp_f32 v117, v117
    v_exp_f32 v118, v118
    v_exp_f32 v119, v119
    v_mfma_f32_16x16x32_bf16 v[60:63], v[56:59], v[48:51], v[60:63]
    v_cvt_pk_bf16_f32 v52, v112, v113
    v_cvt_pk_bf16_f32 v53, v114, v115
    v_cvt_pk_bf16_f32 v54, v116, v117
    v_cvt_pk_bf16_f32 v55, v118, v119
    s_waitcnt vmcnt(0)
    s_barrier
    s_waitcnt lgkmcnt(2)
    v_mfma_f32_32x32x16_bf16 v[104:119], v[32:35], v[16:19], v[72:87]
    v_exp_f32 v88, v88
    v_exp_f32 v89, v89
    v_exp_f32 v90, v90
    v_exp_f32 v91, v91
    s_waitcnt lgkmcnt(0)
    s_add_u32 m0, s18, 65536
    s_mov_b32 s19, 65536
    buffer_load_dwordx4 v12, s[12:15], s19 offen lds
    v_mfma_f32_16x16x32_bf16 v[164:167], v[192:195], v[152:155], 0
    v_mfma_f32_32x32x16_bf16 v[120:135], v[44:47], v[52:55], v[120:135]
    v_exp_f32 v92, v92
    v_exp_f32 v93, v93
    v_exp_f32 v94, v94
    v_exp_f32 v95, v95
    s_add_u32 m0, s18, 73728
    s_mov_b32 s19, 65536
    buffer_load_dwordx4 v13, s[12:15], s19 offen lds
    v_mfma_f32_16x16x32_bf16 v[60:63], v[56:59], v[52:55], v[60:63]
    v_cvt_pk_bf16_f32 v48, v88, v89
    v_cvt_pk_bf16_f32 v49, v90, v91
    v_cvt_pk_bf16_f32 v50, v92, v93
    v_cvt_pk_bf16_f32 v51, v94, v95
    v_mfma_f32_32x32x16_bf16 v[104:119], v[36:39], v[20:23], v[104:119]
    s_add_u32 m0, s18, 81920
    s_mov_b32 s19, 65536
    buffer_load_dwordx4 v14, s[12:15], s19 offen lds
    ds_read_b128 v[32:35], v10 offset:32768
    ds_read_b128 v[36:39], v10 offset:33792
    v_exp_f32 v96, v96
    v_exp_f32 v97, v97
    v_exp_f32 v98, v98
    v_exp_f32 v99, v99
    v_mfma_f32_32x32x16_bf16 v[120:135], v[40:43], v[48:51], v[120:135]
    ds_read_b128 v[44:47], v10 offset:27648
    ds_read_b128 v[40:43], v10 offset:30720
    v_exp_f32 v100, v100
    v_exp_f32 v101, v101
    v_exp_f32 v102, v102
    v_exp_f32 v103, v103
    s_add_u32 m0, s18, 90112
    s_mov_b32 s19, 65536
    buffer_load_dwordx4 v15, s[12:15], s19 offen lds
    v_mfma_f32_16x16x32_bf16 v[60:63], v[56:59], v[48:51], v[60:63]
    ds_read_b128 v[232:235], v28
    ds_read_b128 v[236:239], v28 offset:4096
    ds_read_b128 v[240:243], v30
    ds_read_b128 v[244:247], v29
    ds_read_b128 v[248:251], v29 offset:4096
    ds_read_b128 v[252:255], v31
    v_cvt_pk_bf16_f32 v52, v96, v97
    v_cvt_pk_bf16_f32 v53, v98, v99
    v_cvt_pk_bf16_f32 v54, v100, v101
    v_cvt_pk_bf16_f32 v55, v102, v103
    s_waitcnt lgkmcnt(8)
    v_mfma_f32_32x32x16_bf16 v[88:103], v[32:35], v[16:19], v[72:87]
    v_exp_f32 v104, v104
    v_exp_f32 v105, v105
    v_exp_f32 v106, v106
    v_exp_f32 v107, v107
    s_waitcnt lgkmcnt(0)
    v_max3_f32 v70, |v164|, |v165|, v70
    v_max3_f32 v70, |v166|, |v167|, v70
    buffer_load_dwordx4 v[152:155], v69, s[76:79], 0 offen offset:512
    v_mfma_f32_32x32x16_bf16 v[120:135], v[44:47], v[52:55], v[120:135]
    ds_read_b128 v[44:47], v10 offset:31744
    v_exp_f32 v108, v108
    v_exp_f32 v109, v109
    v_mfma_f32_32x32x16_bf16 v[200:215], v[232:235], v[240:243], v[200:215]
    v_exp_f32 v110, v110
    v_exp_f32 v111, v111
    buffer_load_dwordx4 v[156:159], v69, s[76:79], 0 offen offset:1024
    v_mfma_f32_16x16x32_bf16 v[60:63], v[56:59], v[52:55], v[60:63]
    v_cvt_pk_bf16_f32 v48, v104, v105
    v_cvt_pk_bf16_f32 v49, v106, v107
    v_cvt_pk_bf16_f32 v50, v108, v109
    v_cvt_pk_bf16_f32 v51, v110, v111
    v_mfma_f32_32x32x16_bf16 v[88:103], v[36:39], v[20:23], v[88:103]
    buffer_load_dwordx4 v[160:163], v69, s[76:79], 0 offen offset:1536
    ds_read_b128 v[32:35], v10 offset:36864
    ds_read_b128 v[36:39], v10 offset:37888
    v_exp_f32 v112, v112
    v_exp_f32 v113, v113
    v_mfma_f32_32x32x16_bf16 v[216:231], v[236:239], v[240:243], v[216:231]
    v_exp_f32 v114, v114
    v_exp_f32 v115, v115
    v_mfma_f32_32x32x16_bf16 v[120:135], v[40:43], v[48:51], v[120:135]
    ds_read_b128 v[40:43], v10 offset:34816
    v_exp_f32 v116, v116
    v_exp_f32 v117, v117
    v_mfma_f32_32x32x16_bf16 v[200:215], v[244:247], v[252:255], v[200:215]
    v_exp_f32 v118, v118
    v_exp_f32 v119, v119
    v_mfma_f32_16x16x32_bf16 v[60:63], v[56:59], v[48:51], v[60:63]
    v_cvt_pk_bf16_f32 v52, v112, v113
    v_cvt_pk_bf16_f32 v53, v114, v115
    v_cvt_pk_bf16_f32 v54, v116, v117
    v_cvt_pk_bf16_f32 v55, v118, v119
    v_mfma_f32_32x32x16_bf16 v[216:231], v[248:251], v[252:255], v[216:231]
    s_waitcnt lgkmcnt(3)
    s_nop 0
    v_mfma_f32_32x32x16_bf16 v[120:135], v[44:47], v[52:55], v[120:135]
    v_mfma_f32_16x16x32_bf16 v[60:63], v[56:59], v[52:55], v[60:63]
    s_nop 7
    v_cmp_nlt_f32 vcc, v60, s28
    s_nop 1
    s_cbranch_vccnz L_at0_slow
L_at0_ret:
    s_waitcnt lgkmcnt(2)
    v_mfma_f32_32x32x16_bf16 v[104:119], v[32:35], v[16:19], v[72:87]
    v_exp_f32 v88, v88
    v_exp_f32 v89, v89
    v_exp_f32 v90, v90
    v_exp_f32 v91, v91
    s_waitcnt lgkmcnt(0)
    s_add_u32 m0, s18, 98304
    s_nop 0
    buffer_load_dwordx4 v68, s[4:7], s40 offen lds
    s_add_u32 s40, s40, 256
    v_exp_f32 v92, v92
    v_exp_f32 v93, v93
    v_exp_f32 v94, v94
    v_exp_f32 v95, v95
    s_add_u32 m0, s18, 106496
    s_nop 0
    buffer_load_dwordx4 v68, s[8:11], s41 offen lds
    s_add_u32 s41, s41, 256
    v_cvt_pk_bf16_f32 v48, v88, v89
    v_cvt_pk_bf16_f32 v49, v90, v91
    v_cvt_pk_bf16_f32 v50, v92, v93
    v_cvt_pk_bf16_f32 v51, v94, v95
    v_mfma_f32_32x32x16_bf16 v[104:119], v[36:39], v[20:23], v[104:119]
    s_add_u32 m0, s18, 114688
    s_nop 0
    buffer_load_dwordx4 v68, s[4:7], s42 offen lds
    s_add_u32 s42, s42, 256
    ds_read_b128 v[32:35], v10 offset:40960
    ds_read_b128 v[36:39], v10 offset:41984
    v_exp_f32 v96, v96
    v_exp_f32 v97, v97
    v_exp_f32 v98, v98
    v_exp_f32 v99, v99
    v_mfma_f32_32x32x16_bf16 v[136:151], v[40:43], v[48:51], v[120:135]
    ds_read_b128 v[44:47], v10 offset:35840
    ds_read_b128 v[40:43], v10 offset:38912
    v_exp_f32 v100, v100
    v_exp_f32 v101, v101
    v_exp_f32 v102, v102
    v_exp_f32 v103, v103
    s_add_u32 m0, s18, 122880
    s_nop 0
    buffer_load_dwordx4 v68, s[8:11], s43 offen lds
    s_add_u32 s43, s43, 256
    v_mfma_f32_16x16x32_bf16 v[64:67], v[56:59], v[48:51], v[60:63]
    v_cvt_pk_bf16_f32 v52, v96, v97
    v_cvt_pk_bf16_f32 v53, v98, v99
    v_cvt_pk_bf16_f32 v54, v100, v101
    v_cvt_pk_bf16_f32 v55, v102, v103
    s_waitcnt lgkmcnt(2)
    v_mfma_f32_32x32x16_bf16 v[88:103], v[32:35], v[16:19], v[72:87]
    v_exp_f32 v104, v104
    v_exp_f32 v105, v105
    v_exp_f32 v106, v106
    v_exp_f32 v107, v107
    s_waitcnt lgkmcnt(0)
    v_mfma_f32_32x32x16_bf16 v[136:151], v[44:47], v[52:55], v[136:151]
    v_exp_f32 v108, v108
    v_exp_f32 v109, v109
    v_exp_f32 v110, v110
    v_exp_f32 v111, v111
    v_mfma_f32_16x16x32_bf16 v[64:67], v[56:59], v[52:55], v[64:67]
    v_cvt_pk_bf16_f32 v48, v104, v105
    v_cvt_pk_bf16_f32 v49, v106, v107
    v_cvt_pk_bf16_f32 v50, v108, v109
    v_cvt_pk_bf16_f32 v51, v110, v111
    v_mfma_f32_32x32x16_bf16 v[88:103], v[36:39], v[20:23], v[88:103]
    ds_read_b128 v[32:35], v10 offset:45056
    ds_read_b128 v[36:39], v10 offset:46080
    v_exp_f32 v112, v112
    v_exp_f32 v113, v113
    v_exp_f32 v114, v114
    v_exp_f32 v115, v115
    v_mfma_f32_32x32x16_bf16 v[136:151], v[40:43], v[48:51], v[136:151]
    ds_read_b128 v[44:47], v10 offset:39936
    ds_read_b128 v[40:43], v10 offset:43008
    v_exp_f32 v116, v116
    v_exp_f32 v117, v117
    v_exp_f32 v118, v118
    v_exp_f32 v119, v119
    v_mfma_f32_16x16x32_bf16 v[64:67], v[56:59], v[48:51], v[64:67]
    v_cvt_pk_bf16_f32 v52, v112, v113
    v_cvt_pk_bf16_f32 v53, v114, v115
    v_cvt_pk_bf16_f32 v54, v116, v117
    v_cvt_pk_bf16_f32 v55, v118, v119
    s_waitcnt lgkmcnt(2)
    v_mfma_f32_32x32x16_bf16 v[104:119], v[32:35], v[16:19], v[72:87]
    v_exp_f32 v88, v88
    v_exp_f32 v89, v89
    v_exp_f32 v90, v90
    v_exp_f32 v91, v91
    s_waitcnt lgkmcnt(0)
    v_mfma_f32_32x32x16_bf16 v[136:151], v[44:47], v[52:55], v[136:151]
    v_exp_f32 v92, v92
    v_exp_f32 v93, v93
    v_exp_f32 v94, v94
    v_exp_f32 v95, v95
    v_mfma_f32_16x16x32_bf16 v[64:67], v[56:59], v[52:55], v[64:67]
    v_cvt_pk_bf16_f32 v48, v88, v89
    v_cvt_pk_bf16_f32 v49, v90, v91
    v_cvt_pk_bf16_f32 v50, v92, v93
    v_cvt_pk_bf16_f32 v51, v94, v95
    v_mfma_f32_32x32x16_bf16 v[104:119], v[36:39], v[20:23], v[104:119]
    ds_read_b128 v[32:35], v10 offset:49152
    ds_read_b128 v[36:39], v10 offset:50176
    v_exp_f32 v96, v96
    v_exp_f32 v97, v97
    v_exp_f32 v98, v98
    v_exp_f32 v99, v99
    v_mfma_f32_32x32x16_bf16 v[136:151], v[40:43], v[48:51], v[136:151]
    ds_read_b128 v[44:47], v10 offset:44032
    ds_read_b128 v[40:43], v10 offset:47104
    v_exp_f32 v100, v100
    v_exp_f32 v101, v101
    v_exp_f32 v102, v102
    v_exp_f32 v103, v103
    v_mfma_f32_16x16x32_bf16 v[64:67], v[56:59], v[48:51], v[64:67]
    v_cvt_pk_bf16_f32 v52, v96, v97
    v_cvt_pk_bf16_f32 v53, v98, v99
    v_cvt_pk_bf16_f32 v54, v100, v101
    v_cvt_pk_bf16_f32 v55, v102, v103
    s_waitcnt lgkmcnt(2)
    v_mfma_f32_32x32x16_bf16 v[88:103], v[32:35], v[16:19], v[72:87]
    v_exp_f32 v104, v104
    v_exp_f32 v105, v105
    v_exp_f32 v106, v106
    v_exp_f32 v107, v107
    s_waitcnt lgkmcnt(0)
    v_mfma_f32_32x32x16_bf16 v[136:151], v[44:47], v[52:55], v[136:151]
    v_exp_f32 v108, v108
    v_exp_f32 v109, v109
    v_exp_f32 v110, v110
    v_exp_f32 v111, v111
    v_mfma_f32_16x16x32_bf16 v[64:67], v[56:59], v[52:55], v[64:67]
    v_cvt_pk_bf16_f32 v48, v104, v105
    v_cvt_pk_bf16_f32 v49, v106, v107
    v_cvt_pk_bf16_f32 v50, v108, v109
    v_cvt_pk_bf16_f32 v51, v110, v111
    v_mfma_f32_32x32x16_bf16 v[88:103], v[36:39], v[20:23], v[88:103]
    ds_read_b128 v[32:35], v10 offset:53248
    ds_read_b128 v[36:39], v10 offset:54272
    v_exp_f32 v112, v112
    v_exp_f32 v113, v113
    v_exp_f32 v114, v114
    v_exp_f32 v115, v115
    v_mfma_f32_32x32x16_bf16 v[136:151], v[40:43], v[48:51], v[136:151]
    ds_read_b128 v[44:47], v10 offset:48128
    ds_read_b128 v[40:43], v10 offset:51200
    v_exp_f32 v116, v116
    v_exp_f32 v117, v117
    v_exp_f32 v118, v118
    v_exp_f32 v119, v119
    v_mfma_f32_16x16x32_bf16 v[64:67], v[56:59], v[48:51], v[64:67]
    v_cvt_pk_bf16_f32 v52, v112, v113
    v_cvt_pk_bf16_f32 v53, v114, v115
    v_cvt_pk_bf16_f32 v54, v116, v117
    v_cvt_pk_bf16_f32 v55, v118, v119
    s_waitcnt lgkmcnt(2)
    v_mfma_f32_32x32x16_bf16 v[104:119], v[32:35], v[16:19], v[72:87]
    v_exp_f32 v88, v88
    v_exp_f32 v89, v89
    v_exp_f32 v90, v90
    v_exp_f32 v91, v91
    s_waitcnt lgkmcnt(0)
    v_mfma_f32_32x32x16_bf16 v[136:151], v[44:47], v[52:55], v[136:151]
    v_exp_f32 v92, v92
    v_exp_f32 v93, v93
    v_exp_f32 v94, v94
    v_exp_f32 v95, v95
    v_mfma_f32_16x16x32_bf16 v[64:67], v[56:59], v[52:55], v[64:67]
    v_cvt_pk_bf16_f32 v48, v88, v89
    v_cvt_pk_bf16_f32 v49, v90, v91
    v_cvt_pk_bf16_f32 v50, v92, v93
    v_cvt_pk_bf16_f32 v51, v94, v95
    v_mfma_f32_32x32x16_bf16 v[104:119], v[36:39], v[20:23], v[104:119]
    ds_read_b128 v[32:35], v10 offset:57344
    ds_read_b128 v[36:39], v10 offset:58368
    v_exp_f32 v96, v96
    v_exp_f32 v97, v97
    v_exp_f32 v98, v98
    v_exp_f32 v99, v99
    v_mfma_f32_32x32x16_bf16 v[136:151], v[40:43], v[48:51], v[136:151]
    ds_read_b128 v[44:47], v10 offset:52224
    ds_read_b128 v[40:43], v10 offset:55296
    v_exp_f32 v100, v100
    v_exp_f32 v101, v101
    v_exp_f32 v102, v102
    v_exp_f32 v103, v103
    v_mfma_f32_16x16x32_bf16 v[64:67], v[56:59], v[48:51], v[64:67]
    v_cvt_pk_bf16_f32 v52, v96, v97
    v_cvt_pk_bf16_f32 v53, v98, v99
    v_cvt_pk_bf16_f32 v54, v100, v101
    v_cvt_pk_bf16_f32 v55, v102, v103
    s_waitcnt lgkmcnt(2)
    v_mfma_f32_32x32x16_bf16 v[88:103], v[32:35], v[16:19], v[72:87]
    v_exp_f32 v104, v104
    v_exp_f32 v105, v105
    v_exp_f32 v106, v106
    v_exp_f32 v107, v107
    s_waitcnt lgkmcnt(0)
    v_mfma_f32_32x32x16_bf16 v[136:151], v[44:47], v[52:55], v[136:151]
    v_exp_f32 v108, v108
    v_exp_f32 v109, v109
    v_exp_f32 v110, v110
    v_exp_f32 v111, v111
    v_mfma_f32_16x16x32_bf16 v[64:67], v[56:59], v[52:55], v[64:67]
    v_cvt_pk_bf16_f32 v48, v104, v105
    v_cvt_pk_bf16_f32 v49, v106, v107
    v_cvt_pk_bf16_f32 v50, v108, v109
    v_cvt_pk_bf16_f32 v51, v110, v111
    v_mfma_f32_32x32x16_bf16 v[88:103], v[36:39], v[20:23], v[88:103]
    ds_read_b128 v[32:35], v10 offset:61440
    ds_read_b128 v[36:39], v10 offset:62464
    v_exp_f32 v112, v112
    v_exp_f32 v113, v113
    v_exp_f32 v114, v114
    v_exp_f32 v115, v115
    v_mfma_f32_32x32x16_bf16 v[136:151], v[40:43], v[48:51], v[136:151]
    ds_read_b128 v[44:47], v10 offset:56320
    ds_read_b128 v[40:43], v10 offset:59392
    v_exp_f32 v116, v116
    v_exp_f32 v117, v117
    v_exp_f32 v118, v118
    v_exp_f32 v119, v119
    v_mfma_f32_16x16x32_bf16 v[64:67], v[56:59], v[48:51], v[64:67]
    v_cvt_pk_bf16_f32 v52, v112, v113
    v_cvt_pk_bf16_f32 v53, v114, v115
    v_cvt_pk_bf16_f32 v54, v116, v117
    v_cvt_pk_bf16_f32 v55, v118, v119
    s_waitcnt vmcnt(0)
    s_barrier
    s_waitcnt lgkmcnt(2)
    v_mfma_f32_32x32x16_bf16 v[104:119], v[32:35], v[16:19], v[72:87]
    v_exp_f32 v88, v88
    v_exp_f32 v89, v89
    v_exp_f32 v90, v90
    v_exp_f32 v91, v91
    s_waitcnt lgkmcnt(0)
    s_add_u32 m0, s18, 0
    s_mov_b32 s19, 98304
    buffer_load_dwordx4 v12, s[12:15], s19 offen lds
    v_mfma_f32_16x16x32_bf16 v[164:167], v[192:195], v[152:155], 0
    v_mfma_f32_32x32x16_bf16 v[136:151], v[44:47], v[52:55], v[136:151]
    v_exp_f32 v92, v92
    v_exp_f32 v93, v93
    v_exp_f32 v94, v94
    v_exp_f32 v95, v95
    s_add_u32 m0, s18, 8192
    s_mov_b32 s19, 98304
    buffer_load_dwordx4 v13, s[12:15], s19 offen lds
    v_mfma_f32_16x16x32_bf16 v[168:171], v[192:195], v[156:159], 0
    v_mfma_f32_16x16x32_bf16 v[64:67], v[56:59], v[52:55], v[64:67]
    v_cvt_pk_bf16_f32 v48, v88, v89
    v_cvt_pk_bf16_f32 v49, v90, v91
    v_cvt_pk_bf16_f32 v50, v92, v93
    v_cvt_pk_bf16_f32 v51, v94, v95
    v_mfma_f32_32x32x16_bf16 v[104:119], v[36:39], v[20:23], v[104:119]
    s_add_u32 m0, s18, 16384
    s_mov_b32 s19, 98304
    buffer_load_dwordx4 v14, s[12:15], s19 offen lds
    v_mfma_f32_16x16x32_bf16 v[172:175], v[192:195], v[160:163], 0
    ds_read_b128 v[32:35], v11 offset:0
    ds_read_b128 v[36:39], v11 offset:1024
    v_exp_f32 v96, v96
    v_exp_f32 v97, v97
    v_exp_f32 v98, v98
    v_exp_f32 v99, v99
    v_mfma_f32_32x32x16_bf16 v[136:151], v[40:43], v[48:51], v[136:151]
    ds_read_b128 v[44:47], v10 offset:60416
    ds_read_b128 v[40:43], v10 offset:63488
    v_exp_f32 v100, v100
    v_exp_f32 v101, v101
    v_exp_f32 v102, v102
    v_exp_f32 v103, v103
    s_add_u32 m0, s18, 24576
    s_mov_b32 s19, 98304
    buffer_load_dwordx4 v15, s[12:15], s19 offen lds
    v_mfma_f32_16x16x32_bf16 v[64:67], v[56:59], v[48:51], v[64:67]
    ds_read_b128 v[232:235], v24
    ds_read_b128 v[236:239], v24 offset:4096
    ds_read_b128 v[240:243], v26
    ds_read_b128 v[244:247], v25
    ds_read_b128 v[248:251], v25 offset:4096
    ds_read_b128 v[252:255], v27
    v_cvt_pk_bf16_f32 v52, v96, v97
    v_cvt_pk_bf16_f32 v53, v98, v99
    v_cvt_pk_bf16_f32 v54, v100, v101
    v_cvt_pk_bf16_f32 v55, v102, v103
    s_waitcnt lgkmcnt(8)
    v_mfma_f32_32x32x16_bf16 v[88:103], v[32:35], v[16:19], v[72:87]
    v_exp_f32 v104, v104
    v_exp_f32 v105, v105
    v_exp_f32 v106, v106
    v_exp_f32 v107, v107
    s_waitcnt lgkmcnt(0)
    v_max3_f32 v70, |v164|, |v165|, v70
    v_max3_f32 v70, |v166|, |v167|, v70
    buffer_load_dwordx4 v[152:155], v69, s[76:79], 0 offen offset:2048
    v_mfma_f32_32x32x16_bf16 v[136:151], v[44:47], v[52:55], v[136:151]
    ds_read_b128 v[44:47], v10 offset:64512
    v_exp_f32 v108, v108
    v_exp_f32 v109, v109
    v_mfma_f32_32x32x16_bf16 v[200:215], v[232:235], v[240:243], v[200:215]
    v_exp_f32 v110, v110
    v_exp_f32 v111, v111
    v_max3_f32 v70, |v168|, |v169|, v70
    v_max3_f32 v70, |v170|, |v171|, v70
    buffer_load_dwordx4 v[156:159], v69, s[76:79], 0 offen offset:2560
    v_mfma_f32_16x16x32_bf16 v[64:67], v[56:59], v[52:55], v[64:67]
    v_cvt_pk_bf16_f32 v48, v104, v105
    v_cvt_pk_bf16_f32 v49, v106, v107
    v_cvt_pk_bf16_f32 v50, v108, v109
    v_cvt_pk_bf16_f32 v51, v110, v111
    v_mfma_f32_32x32x16_bf16 v[88:103], v[36:39], v[20:23], v[88:103]
    v_max3_f32 v70, |v172|, |v173|, v70
    v_max3_f32 v70, |v174|, |v175|, v70
    ds_read_b128 v[32:35], v11 offset:4096
    ds_read_b128 v[36:39], v11 offset:5120
    v_exp_f32 v112, v112
    v_exp_f32 v113, v113
    v_mfma_f32_32x32x16_bf16 v[216:231], v[236:239], v[240:243], v[216:231]
    v_exp_f32 v114, v114
    v_exp_f32 v115, v115
    v_mfma_f32_32x32x16_bf16 v[136:151], v[40:43], v[48:51], v[136:151]
    ds_read_b128 v[40:43], v11 offset:2048
    v_exp_f32 v116, v116
    v_exp_f32 v117, v117
    v_mfma_f32_32x32x16_bf16 v[200:215], v[244:247], v[252:255], v[200:215]
    v_exp_f32 v118, v118
    v_exp_f32 v119, v119
    v_mfma_f32_16x16x32_bf16 v[64:67], v[56:59], v[48:51], v[64:67]
    v_cvt_pk_bf16_f32 v52, v112, v113
    v_cvt_pk_bf16_f32 v53, v114, v115
    v_cvt_pk_bf16_f32 v54, v116, v117
    v_cvt_pk_bf16_f32 v55, v118, v119
    v_mfma_f32_32x32x16_bf16 v[216:231], v[248:251], v[252:255], v[216:231]
    s_waitcnt lgkmcnt(3)
    s_nop 0
    v_mfma_f32_32x32x16_bf16 v[136:151], v[44:47], v[52:55], v[136:151]
    v_mfma_f32_16x16x32_bf16 v[64:67], v[56:59], v[52:55], v[64:67]
    s_nop 7
    v_cmp_nlt_f32 vcc, v64, s28
    s_nop 1
    s_cbranch_vccnz L_at1_slow
L_at1_ret:
    s_waitcnt lgkmcnt(2)
    v_mfma_f32_32x32x16_bf16 v[104:119], v[32:35], v[16:19], v[72:87]
    v_exp_f32 v88, v88
    v_exp_f32 v89, v89
    v_exp_f32 v90, v90
    v_exp_f32 v91, v91
    s_waitcnt lgkmcnt(0)
    s_add_u32 m0, s18, 131072
    s_nop 0
    buffer_load_dwordx4 v68, s[4:7], s40 offen lds
    s_add_u32 s40, s40, 256
    v_exp_f32 v92, v92
    v_exp_f32 v93, v93
    v_exp_f32 v94, v94
    v_exp_f32 v95, v95
    s_add_u32 m0, s18, 139264
    s_nop 0
    buffer_load_dwordx4 v68, s[8:11], s41 offen lds
    s_add_u32 s41, s41, 256
    v_cvt_pk_bf16_f32 v48, v88, v89
    v_cvt_pk_bf16_f32 v49, v90, v91
    v_cvt_pk_bf16_f32 v50, v92, v93
    v_cvt_pk_bf16_f32 v51, v94, v95
    v_mfma_f32_32x32x16_bf16 v[104:119], v[36:39], v[20:23], v[104:119]
    s_add_u32 m0, s18, 147456
    s_nop 0
    buffer_load_dwordx4 v68, s[4:7], s42 offen lds
    s_add_u32 s42, s42, 256
    ds_read_b128 v[32:35], v11 offset:8192
    ds_read_b128 v[36:39], v11 offset:9216
    v_exp_f32 v96, v96
    v_exp_f32 v97, v97
    v_exp_f32 v98, v98
    v_exp_f32 v99, v99
    v_mfma_f32_32x32x16_bf16 v[120:135], v[40:43], v[48:51], v[136:151]
    ds_read_b128 v[44:47], v11 offset:3072
    ds_read_b128 v[40:43], v11 offset:6144
    v_exp_f32 v100, v100
    v_exp_f32 v101, v101
    v_exp_f32 v102, v102
    v_exp_f32 v103, v103
    s_add_u32 m0, s18, 155648
    s_nop 0
    buffer_load_dwordx4 v68, s[8:11], s43 offen lds
    s_add_u32 s43, s43, 256
    v_mfma_f32_16x16x32_bf16 v[60:63], v[56:59], v[48:51], v[64:67]
    v_cvt_pk_bf16_f32 v52, v96, v97
    v_cvt_pk_bf16_f32 v53, v98, v99
    v_cvt_pk_bf16_f32 v54, v100, v101
    v_cvt_pk_bf16_f32 v55, v102, v103
    s_waitcnt lgkmcnt(2)
    v_mfma_f32_32x32x16_bf16 v[88:103], v[32:35], v[16:19], v[72:87]
    v_exp_f32 v104, v104
    v_exp_f32 v105, v105
    v_exp_f32 v106, v106
    v_exp_f32 v107, v107
    s_waitcnt lgkmcnt(0)
    v_mfma_f32_32x32x16_bf16 v[120:135], v[44:47], v[52:55], v[120:135]
    v_exp_f32 v108, v108
    v_exp_f32 v109, v109
    v_exp_f32 v110, v110
    v_exp_f32 v111, v111
    v_mfma_f32_16x16x32_bf16 v[60:63], v[56:59], v[52:55], v[60:63]
    v_cvt_pk_bf16_f32 v48, v104, v105
    v_cvt_pk_bf16_f32 v49, v106, v107
    v_cvt_pk_bf16_f32 v50, v108, v109
    v_cvt_pk_bf16_f32 v51, v110, v111
    v_mfma_f32_32x32x16_bf16 v[88:103], v[36:39], v[20:23], v[88:103]
    ds_read_b128 v[32:35], v11 offset:12288
    ds_read_b128 v[36:39], v11 offset:13312
    v_exp_f32 v112, v112
    v_exp_f32 v113, v113
    v_exp_f32 v114, v114
    v_exp_f32 v115, v115
    v_mfma_f32_32x32x16_bf16 v[120:135], v[40:43], v[48:51], v[120:135]
    ds_read_b128 v[44:47], v11 offset:7168
    ds_read_b128 v[40:43], v11 offset:10240
    v_exp_f32 v116, v116
    v_exp_f32 v117, v117
    v_exp_f32 v118, v118
    v_exp_f32 v119, v119
    v_mfma_f32_16x16x32_bf16 v[60:63], v[56:59], v[48:51], v[60:63]
    v_cvt_pk_bf16_f32 v52, v112, v113
    v_cvt_pk_bf16_f32 v53, v114, v115
    v_cvt_pk_bf16_f32 v54, v116, v117
    v_cvt_pk_bf16_f32 v55, v118, v119
    s_waitcnt lgkmcnt(2)
    v_mfma_f32_32x32x16_bf16 v[104:119], v[32:35], v[16:19], v[72:87]
    v_exp_f32 v88, v88
    v_exp_f32 v89, v89
    v_exp_f32 v90, v90
    v_exp_f32 v91, v91
    s_waitcnt lgkmcnt(0)
    v_mfma_f32_32x32x16_bf16 v[120:135], v[44:47], v[52:55], v[120:135]
    v_exp_f32 v92, v92
    v_exp_f32 v93, v93
    v_exp_f32 v94, v94
    v_exp_f32 v95, v95
    v_mfma_f32_16x16x32_bf16 v[60:63], v[56:59], v[52:55], v[60:63]
    v_cvt_pk_bf16_f32 v48, v88, v89
    v_cvt_pk_bf16_f32 v49, v90, v91
    v_cvt_pk_bf16_f32 v50, v92, v93
    v_cvt_pk_bf16_f32 v51, v94, v95
    v_mfma_f32_32x32x16_bf16 v[104:119], v[36:39], v[20:23], v[104:119]
    ds_read_b128 v[32:35], v11 offset:16384
    ds_read_b128 v[36:39], v11 offset:17408
    v_exp_f32 v96, v96
    v_exp_f32 v97, v97
    v_exp_f32 v98, v98
    v_exp_f32 v99, v99
    v_mfma_f32_32x32x16_bf16 v[120:135], v[40:43], v[48:51], v[120:135]
    ds_read_b128 v[44:47], v11 offset:11264
    ds_read_b128 v[40:43], v11 offset:14336
    v_exp_f32 v100, v100
    v_exp_f32 v101, v101
    v_exp_f32 v102, v102
    v_exp_f32 v103, v103
    v_mfma_f32_16x16x32_bf16 v[60:63], v[56:59], v[48:51], v[60:63]
    v_cvt_pk_bf16_f32 v52, v96, v97
    v_cvt_pk_bf16_f32 v53, v98, v99
    v_cvt_pk_bf16_f32 v54, v100, v101
    v_cvt_pk_bf16_f32 v55, v102, v103
    s_waitcnt lgkmcnt(2)
    v_mfma_f32_32x32x16_bf16 v[88:103], v[32:35], v[16:19], v[72:87]
    v_exp_f32 v104, v104
    v_exp_f32 v105, v105
    v_exp_f32 v106, v106
    v_exp_f32 v107, v107
    s_waitcnt lgkmcnt(0)
    v_mfma_f32_32x32x16_bf16 v[120:135], v[44:47], v[52:55], v[120:135]
    v_exp_f32 v108, v108
    v_exp_f32 v109, v109
    v_exp_f32 v110, v110
    v_exp_f32 v111, v111
    v_mfma_f32_16x16x32_bf16 v[60:63], v[56:59], v[52:55], v[60:63]
    v_cvt_pk_bf16_f32 v48, v104, v105
    v_cvt_pk_bf16_f32 v49, v106, v107
    v_cvt_pk_bf16_f32 v50, v108, v109
    v_cvt_pk_bf16_f32 v51, v110, v111
    v_mfma_f32_32x32x16_bf16 v[88:103], v[36:39], v[20:23], v[88:103]
    ds_read_b128 v[32:35], v11 offset:20480
    ds_read_b128 v[36:39], v11 offset:21504
    v_exp_f32 v112, v112
    v_exp_f32 v113, v113
    v_exp_f32 v114, v114
    v_exp_f32 v115, v115
    v_mfma_f32_32x32x16_bf16 v[120:135], v[40:43], v[48:51], v[120:135]
    ds_read_b128 v[44:47], v11 offset:15360
    ds_read_b128 v[40:43], v11 offset:18432
    v_exp_f32 v116, v116
    v_exp_f32 v117, v117
    v_exp_f32 v118, v118
    v_exp_f32 v119, v119
    v_mfma_f32_16x16x32_bf16 v[60:63], v[56:59], v[48:51], v[60:63]
    v_cvt_pk_bf16_f32 v52, v112, v113
    v_cvt_pk_bf16_f32 v53, v114, v115
    v_cvt_pk_bf16_f32 v54, v116, v117
    v_cvt_pk_bf16_f32 v55, v118, v119
    s_waitcnt lgkmcnt(2)
    v_mfma_f32_32x32x16_bf16 v[104:119], v[32:35], v[16:19], v[72:87]
    v_exp_f32 v88, v88
    v_exp_f32 v89, v89
    v_exp_f32 v90, v90
    v_exp_f32 v91, v91
    s_waitcnt lgkmcnt(0)
    v_mfma_f32_32x32x16_bf16 v[120:135], v[44:47], v[52:55], v[120:135]
    v_exp_f32 v92, v92
    v_exp_f32 v93, v93
    v_exp_f32 v94, v94
    v_exp_f32 v95, v95
    v_mfma_f32_16x16x32_bf16 v[60:63], v[56:59], v[52:55], v[60:63]
    v_cvt_pk_bf16_f32 v48, v88, v89
    v_cvt_pk_bf16_f32 v49, v90, v91
    v_cvt_pk_bf16_f32 v50, v92, v93
    v_cvt_pk_bf16_f32 v51, v94, v95
    v_mfma_f32_32x32x16_bf16 v[104:119], v[36:39], v[20:23], v[104:119]
    ds_read_b128 v[32:35], v11 offset:24576
    ds_read_b128 v[36:39], v11 offset:25600
    v_exp_f32 v96, v96
    v_exp_f32 v97, v97
    v_exp_f32 v98, v98
    v_exp_f32 v99, v99
    v_mfma_f32_32x32x16_bf16 v[120:135], v[40:43], v[48:51], v[120:135]
    ds_read_b128 v[44:47], v11 offset:19456
    ds_read_b128 v[40:43], v11 offset:22528
    v_exp_f32 v100, v100
    v_exp_f32 v101, v101
    v_exp_f32 v102, v102
    v_exp_f32 v103, v103
    v_mfma_f32_16x16x32_bf16 v[60:63], v[56:59], v[48:51], v[60:63]
    v_cvt_pk_bf16_f32 v52, v96, v97
    v_cvt_pk_bf16_f32 v53, v98, v99
    v_cvt_pk_bf16_f32 v54, v100, v101
    v_cvt_pk_bf16_f32 v55, v102, v103
    s_waitcnt lgkmcnt(2)
    v_mfma_f32_32x32x16_bf16 v[88:103], v[32:35], v[16:19], v[72:87]
    v_exp_f32 v104, v104
    v_exp_f32 v105, v105
    v_exp_f32 v106, v106
    v_exp_f32 v107, v107
    s_waitcnt lgkmcnt(0)
    v_mfma_f32_32x32x16_bf16 v[120:135], v[44:47], v[52:55], v[120:135]
    v_exp_f32 v108, v108
    v_exp_f32 v109, v109
    v_exp_f32 v110, v110
    v_exp_f32 v111, v111
    v_mfma_f32_16x16x32_bf16 v[60:63], v[56:59], v[52:55], v[60:63]
    v_cvt_pk_bf16_f32 v48, v104, v105
    v_cvt_pk_bf16_f32 v49, v106, v107
    v_cvt_pk_bf16_f32 v50, v108, v109
    v_cvt_pk_bf16_f32 v51, v110, v111
    v_mfma_f32_32x32x16_bf16 v[88:103], v[36:39], v[20:23], v[88:103]
    ds_read_b128 v[32:35], v11 offset:28672
    ds_read_b128 v[36:39], v11 offset:29696
    v_exp_f32 v112, v112
    v_exp_f32 v113, v113
    v_exp_f32 v114, v114
    v_exp_f32 v115, v115
    v_mfma_f32_32x32x16_bf16 v[120:135], v[40:43], v[48:51], v[120:135]
    ds_read_b128 v[44:47], v11 offset:23552
    ds_read_b128 v[40:43], v11 offset:26624
    v_exp_f32 v116, v116
    v_exp_f32 v117, v117
    v_exp_f32 v118, v118
    v_exp_f32 v119, v119
    v_mfma_f32_16x16x32_bf16 v[60:63], v[56:59], v[48:51], v[60:63]
    v_cvt_pk_bf16_f32 v52, v112, v113
    v_cvt_pk_bf16_f32 v53, v114, v115
    v_cvt_pk_bf16_f32 v54, v116, v117
    v_cvt_pk_bf16_f32 v55, v118, v119
    s_waitcnt vmcnt(0)
    s_barrier
    s_waitcnt lgkmcnt(2)
    v_mfma_f32_32x32x16_bf16 v[104:119], v[32:35], v[16:19], v[72:87]
    v_exp_f32 v88, v88
    v_exp_f32 v89, v89
    v_exp_f32 v90, v90
    v_exp_f32 v91, v91
    s_waitcnt lgkmcnt(0)
    s_add_u32 m0, s18, 32768
    s_mov_b32 s19, 131072
    buffer_load_dwordx4 v12, s[12:15], s19 offen lds
    v_mfma_f32_16x16x32_bf16 v[164:167], v[192:195], v[152:155], 0
    v_mfma_f32_32x32x16_bf16 v[120:135], v[44:47], v[52:55], v[120:135]
    v_exp_f32 v92, v92
    v_exp_f32 v93, v93
    v_exp_f32 v94, v94
    v_exp_f32 v95, v95
    s_add_u32 m0, s18, 40960
    s_mov_b32 s19, 131072
    buffer_load_dwordx4 v13, s[12:15], s19 offen lds
    v_mfma_f32_16x16x32_bf16 v[168:171], v[192:195], v[156:159], 0
    v_mfma_f32_16x16x32_bf16 v[60:63], v[56:59], v[52:55], v[60:63]
    v_cvt_pk_bf16_f32 v48, v88, v89
    v_cvt_pk_bf16_f32 v49, v90, v91
    v_cvt_pk_bf16_f32 v50, v92, v93
    v_cvt_pk_bf16_f32 v51, v94, v95
    v_mfma_f32_32x32x16_bf16 v[104:119], v[36:39], v[20:23], v[104:119]
    s_add_u32 m0, s18, 49152
    s_mov_b32 s19, 131072
    buffer_load_dwordx4 v14, s[12:15], s19 offen lds
    ds_read_b128 v[32:35], v10 offset:0
    ds_read_b128 v[36:39], v10 offset:1024
    v_exp_f32 v96, v96
    v_exp_f32 v97, v97
    v_exp_f32 v98, v98
    v_exp_f32 v99, v99
    v_mfma_f32_32x32x16_bf16 v[120:135], v[40:43], v[48:51], v[120:135]
    ds_read_b128 v[44:47], v11 offset:27648
    ds_read_b128 v[40:43], v11 offset:30720
    v_exp_f32 v100, v100
    v_exp_f32 v101, v101
    v_exp_f32 v102, v102
    v_exp_f32 v103, v103
    s_add_u32 m0, s18, 57344
    s_mov_b32 s19, 131072
    buffer_load_dwordx4 v15, s[12:15], s19 offen lds
    v_mfma_f32_16x16x32_bf16 v[60:63], v[56:59], v[48:51], v[60:63]
    ds_read_b128 v[232:235], v28
    ds_read_b128 v[236:239], v28 offset:4096
    ds_read_b128 v[240:243], v30
    ds_read_b128 v[244:247], v29
    ds_read_b128 v[248:251], v29 offset:4096
    ds_read_b128 v[252:255], v31
    v_cvt_pk_bf16_f32 v52, v96, v97
    v_cvt_pk_bf16_f32 v53, v98, v99
    v_cvt_pk_bf16_f32 v54, v100, v101
    v_cvt_pk_bf16_f32 v55, v102, v103
    s_waitcnt lgkmcnt(8)
    v_mfma_f32_32x32x16_bf16 v[88:103], v[32:35], v[16:19], v[72:87]
    v_exp_f32 v104, v104
    v_exp_f32 v105, v105
    v_exp_f32 v106, v106
    v_exp_f32 v107, v107
    s_waitcnt lgkmcnt(0)
    v_max3_f32 v70, |v164|, |v165|, v70
    v_max3_f32 v70, |v166|, |v167|, v70
    buffer_load_dwordx4 v[152:155], v69, s[76:79], 0 offen offset:3072
    v_mfma_f32_32x32x16_bf16 v[120:135], v[44:47], v[52:55], v[120:135]
    ds_read_b128 v[44:47], v11 offset:31744
    v_exp_f32 v108, v108
    v_exp_f32 v109, v109
    v_mfma_f32_32x32x16_bf16 v[200:215], v[232:235], v[240:243], v[200:215]
    v_exp_f32 v110, v110
    v_exp_f32 v111, v111
    v_max3_f32 v70, |v168|, |v169|, v70
    v_max3_f32 v70, |v170|, |v171|, v70
    buffer_load_dwordx4 v[156:159], v69, s[76:79], 0 offen offset:3584
    v_mfma_f32_16x16x32_bf16 v[60:63], v[56:59], v[52:55], v[60:63]
    v_cvt_pk_bf16_f32 v48, v104, v105
    v_cvt_pk_bf16_f32 v49, v106, v107
    v_cvt_pk_bf16_f32 v50, v108, v109
    v_cvt_pk_bf16_f32 v51, v110, v111
    v_mfma_f32_32x32x16_bf16 v[88:103], v[36:39], v[20:23], v[88:103]
    ds_read_b128 v[32:35], v10 offset:4096
    ds_read_b128 v[36:39], v10 offset:5120
    v_exp_f32 v112, v112
    v_exp_f32 v113, v113
    v_mfma_f32_32x32x16_bf16 v[216:231], v[236:239], v[240:243], v[216:231]
    v_exp_f32 v114, v114
    v_exp_f32 v115, v115
    v_mfma_f32_32x32x16_bf16 v[120:135], v[40:43], v[48:51], v[120:135]
    ds_read_b128 v[40:43], v10 offset:2048
    v_exp_f32 v116, v116
    v_exp_f32 v117, v117
    v_mfma_f32_32x32x16_bf16 v[200:215], v[244:247], v[252:255], v[200:215]
    v_exp_f32 v118, v118
    v_exp_f32 v119, v119
    v_mfma_f32_16x16x32_bf16 v[60:63], v[56:59], v[48:51], v[60:63]
    v_cvt_pk_bf16_f32 v52, v112, v113
    v_cvt_pk_bf16_f32 v53, v114, v115
    v_cvt_pk_bf16_f32 v54, v116, v117
    v_cvt_pk_bf16_f32 v55, v118, v119
    v_mfma_f32_32x32x16_bf16 v[216:231], v[248:251], v[252:255], v[216:231]
    s_waitcnt lgkmcnt(3)
    s_nop 0
    v_mfma_f32_32x32x16_bf16 v[120:135], v[44:47], v[52:55], v[120:135]
    v_mfma_f32_16x16x32_bf16 v[60:63], v[56:59], v[52:55], v[60:63]
    s_nop 7
    v_cmp_nlt_f32 vcc, v60, s28
    s_nop 1
    s_cbranch_vccnz L_at2_slow
L_at2_ret:
    s_waitcnt lgkmcnt(2)
    v_mfma_f32_32x32x16_bf16 v[104:119], v[32:35], v[16:19], v[72:87]
    v_exp_f32 v88, v88
    v_exp_f32 v89, v89
    v_exp_f32 v90, v90
    v_exp_f32 v91, v91
    s_waitcnt lgkmcnt(0)
    s_add_u32 m0, s18, 98304
    s_nop 0
    buffer_load_dwordx4 v68, s[4:7], s40 offen lds
    s_add_u32 s40, s40, 256
    v_exp_f32 v92, v92
    v_exp_f32 v93, v93
    v_exp_f32 v94, v94
    v_exp_f32 v95, v95
    s_add_u32 m0, s18, 106496
    s_nop 0
    buffer_load_dwordx4 v68, s[8:11], s41 offen lds
    s_add_u32 s41, s41, 256
    v_cvt_pk_bf16_f32 v48, v88, v89
    v_cvt_pk_bf16_f32 v49, v90, v91
    v_cvt_pk_bf16_f32 v50, v92, v93
    v_cvt_pk_bf16_f32 v51, v94, v95
    v_mfma_f32_32x32x16_bf16 v[104:119], v[36:39], v[20:23], v[104:119]
    s_add_u32 m0, s18, 114688
    s_nop 0
    buffer_load_dwordx4 v68, s[4:7], s42 offen lds
    s_add_u32 s42, s42, 256
    ds_read_b128 v[32:35], v10 offset:8192
    ds_read_b128 v[36:39], v10 offset:9216
    v_exp_f32 v96, v96
    v_exp_f32 v97, v97
    v_exp_f32 v98, v98
    v_exp_f32 v99, v99
    v_mfma_f32_32x32x16_bf16 v[136:151], v[40:43], v[48:51], v[120:135]
    ds_read_b128 v[44:47], v10 offset:3072
    ds_read_b128 v[40:43], v10 offset:6144
    v_exp_f32 v100, v100
    v_exp_f32 v101, v101
    v_exp_f32 v102, v102
    v_exp_f32 v103, v103
    s_add_u32 m0, s18, 122880
    s_nop 0
    buffer_load_dwordx4 v68, s[8:11], s43 offen lds
    s_add_u32 s43, s43, 256
    v_mfma_f32_16x16x32_bf16 v[64:67], v[56:59], v[48:51], v[60:63]
    v_cvt_pk_bf16_f32 v52, v96, v97
    v_cvt_pk_bf16_f32 v53, v98, v99
    v_cvt_pk_bf16_f32 v54, v100, v101
    v_cvt_pk_bf16_f32 v55, v102, v103
    s_waitcnt lgkmcnt(2)
    v_mfma_f32_32x32x16_bf16 v[88:103], v[32:35], v[16:19], v[72:87]
    v_exp_f32 v104, v104
    v_exp_f32 v105, v105
    v_exp_f32 v106, v106
    v_exp_f32 v107, v107
    s_waitcnt lgkmcnt(0)
    v_mfma_f32_32x32x16_bf16 v[136:151], v[44:47], v[52:55], v[136:151]
    v_exp_f32 v108, v108
    v_exp_f32 v109, v109
    v_exp_f32 v110, v110
    v_exp_f32 v111, v111
    v_mfma_f32_16x16x32_bf16 v[64:67], v[56:59], v[52:55], v[64:67]
    v_cvt_pk_bf16_f32 v48, v104, v105
    v_cvt_pk_bf16_f32 v49, v106, v107
    v_cvt_pk_bf16_f32 v50, v108, v109
    v_cvt_pk_bf16_f32 v51, v110, v111
    v_mfma_f32_32x32x16_bf16 v[88:103], v[36:39], v[20:23], v[88:103]
    ds_read_b128 v[32:35], v10 offset:12288
    ds_read_b128 v[36:39], v10 offset:13312
    v_exp_f32 v112, v112
    v_exp_f32 v113, v113
    v_exp_f32 v114, v114
    v_exp_f32 v115, v115
    v_mfma_f32_32x32x16_bf16 v[136:151], v[40:43], v[48:51], v[136:151]
    ds_read_b128 v[44:47], v10 offset:7168
    ds_read_b128 v[40:43], v10 offset:10240
    v_exp_f32 v116, v116
    v_exp_f32 v117, v117
    v_exp_f32 v118, v118
    v_exp_f32 v119, v119
    v_mfma_f32_16x16x32_bf16 v[64:67], v[56:59], v[48:51], v[64:67]
    v_cvt_pk_bf16_f32 v52, v112, v113
    v_cvt_pk_bf16_f32 v53, v114, v115
    v_cvt_pk_bf16_f32 v54, v116, v117
    v_cvt_pk_bf16_f32 v55, v118, v119
    s_waitcnt lgkmcnt(2)
    v_mfma_f32_32x32x16_bf16 v[104:119], v[32:35], v[16:19], v[72:87]
    v_exp_f32 v88, v88
    v_exp_f32 v89, v89
    v_exp_f32 v90, v90
    v_exp_f32 v91, v91
    s_waitcnt lgkmcnt(0)
    v_mfma_f32_32x32x16_bf16 v[136:151], v[44:47], v[52:55], v[136:151]
    v_exp_f32 v92, v92
    v_exp_f32 v93, v93
    v_exp_f32 v94, v94
    v_exp_f32 v95, v95
    v_mfma_f32_16x16x32_bf16 v[64:67], v[56:59], v[52:55], v[64:67]
    v_cvt_pk_bf16_f32 v48, v88, v89
    v_cvt_pk_bf16_f32 v49, v90, v91
    v_cvt_pk_bf16_f32 v50, v92, v93
    v_cvt_pk_bf16_f32 v51, v94, v95
    v_mfma_f32_32x32x16_bf16 v[104:119], v[36:39], v[20:23], v[104:119]
    ds_read_b128 v[32:35], v10 offset:16384
    ds_read_b128 v[36:39], v10 offset:17408
    v_exp_f32 v96, v96
    v_exp_f32 v97, v97
    v_exp_f32 v98, v98
    v_exp_f32 v99, v99
    v_mfma_f32_32x32x16_bf16 v[136:151], v[40:43], v[48:51], v[136:151]
    ds_read_b128 v[44:47], v10 offset:11264
    ds_read_b128 v[40:43], v10 offset:14336
    v_exp_f32 v100, v100
    v_exp_f32 v101, v101
    v_exp_f32 v102, v102
    v_exp_f32 v103, v103
    v_mfma_f32_16x16x32_bf16 v[64:67], v[56:59], v[48:51], v[64:67]
    v_cvt_pk_bf16_f32 v52, v96, v97
    v_cvt_pk_bf16_f32 v53, v98, v99
    v_cvt_pk_bf16_f32 v54, v100, v101
    v_cvt_pk_bf16_f32 v55, v102, v103
    s_waitcnt lgkmcnt(2)
    v_mfma_f32_32x32x16_bf16 v[88:103], v[32:35], v[16:19], v[72:87]
    v_exp_f32 v104, v104
    v_exp_f32 v105, v105
    v_exp_f32 v106, v106
    v_exp_f32 v107, v107
    s_waitcnt lgkmcnt(0)
    v_mfma_f32_32x32x16_bf16 v[136:151], v[44:47], v[52:55], v[136:151]
    v_exp_f32 v108, v108
    v_exp_f32 v109, v109
    v_exp_f32 v110, v110
    v_exp_f32 v111, v111
    v_mfma_f32_16x16x32_bf16 v[64:67], v[56:59], v[52:55], v[64:67]
    v_cvt_pk_bf16_f32 v48, v104, v105
    v_cvt_pk_bf16_f32 v49, v106, v107
    v_cvt_pk_bf16_f32 v50, v108, v109
    v_cvt_pk_bf16_f32 v51, v110, v111
    v_mfma_f32_32x32x16_bf16 v[88:103], v[36:39], v[20:23], v[88:103]
    ds_read_b128 v[32:35], v10 offset:20480
    ds_read_b128 v[36:39], v10 offset:21504
    v_exp_f32 v112, v112
    v_exp_f32 v113, v113
    v_exp_f32 v114, v114
    v_exp_f32 v115, v115
    v_mfma_f32_32x32x16_bf16 v[136:151], v[40:43], v[48:51], v[136:151]
    ds_read_b128 v[44:47], v10 offset:15360
    ds_read_b128 v[40:43], v10 offset:18432
    v_exp_f32 v116, v116
    v_exp_f32 v117, v117
    v_exp_f32 v118, v118
    v_exp_f32 v119, v119
    v_mfma_f32_16x16x32_bf16 v[64:67], v[56:59], v[48:51], v[64:67]
    v_cvt_pk_bf16_f32 v52, v112, v113
    v_cvt_pk_bf16_f32 v53, v114, v115
    v_cvt_pk_bf16_f32 v54, v116, v117
    v_cvt_pk_bf16_f32 v55, v118, v119
    s_waitcnt lgkmcnt(2)
    v_mfma_f32_32x32x16_bf16 v[104:119], v[32:35], v[16:19], v[72:87]
    v_exp_f32 v88, v88
    v_exp_f32 v89, v89
    v_exp_f32 v90, v90
    v_exp_f32 v91, v91
    s_waitcnt lgkmcnt(0)
    v_mfma_f32_32x32x16_bf16 v[136:151], v[44:47], v[52:55], v[136:151]
    v_exp_f32 v92, v92
    v_exp_f32 v93, v93
    v_exp_f32 v94, v94
    v_exp_f32 v95, v95
    v_mfma_f32_16x16x32_bf16 v[64:67], v[56:59], v[52:55], v[64:67]
    v_cvt_pk_bf16_f32 v48, v88, v89
    v_cvt_pk_bf16_f32 v49, v90, v91
    v_cvt_pk_bf16_f32 v50, v92, v93
    v_cvt_pk_bf16_f32 v51, v94, v95
    v_mfma_f32_32x32x16_bf16 v[104:119], v[36:39], v[20:23], v[104:119]
    ds_read_b128 v[32:35], v10 offset:24576
    ds_read_b128 v[36:39], v10 offset:25600
    v_exp_f32 v96, v96
    v_exp_f32 v97, v97
    v_exp_f32 v98, v98
    v_exp_f32 v99, v99
    v_mfma_f32_32x32x16_bf16 v[136:151], v[40:43], v[48:51], v[136:151]
    ds_read_b128 v[44:47], v10 offset:19456
    ds_read_b128 v[40:43], v10 offset:22528
    v_exp_f32 v100, v100
    v_exp_f32 v101, v101
    v_exp_f32 v102, v102
    v_exp_f32 v103, v103
    v_mfma_f32_16x16x32_bf16 v[64:67], v[56:59], v[48:51], v[64:67]
    v_cvt_pk_bf16_f32 v52, v96, v97
    v_cvt_pk_bf16_f32 v53, v98, v99
    v_cvt_pk_bf16_f32 v54, v100, v101
    v_cvt_pk_bf16_f32 v55, v102, v103
    s_waitcnt lgkmcnt(2)
    v_mfma_f32_32x32x16_bf16 v[88:103], v[32:35], v[16:19], v[72:87]
    v_exp_f32 v104, v104
    v_exp_f32 v105, v105
    v_exp_f32 v106, v106
    v_exp_f32 v107, v107
    s_waitcnt lgkmcnt(0)
    v_mfma_f32_32x32x16_bf16 v[136:151], v[44:47], v[52:55], v[136:151]
    v_exp_f32 v108, v108
    v_exp_f32 v109, v109
    v_exp_f32 v110, v110
    v_exp_f32 v111, v111
    v_mfma_f32_16x16x32_bf16 v[64:67], v[56:59], v[52:55], v[64:67]
    v_cvt_pk_bf16_f32 v48, v104, v105
    v_cvt_pk_bf16_f32 v49, v106, v107
    v_cvt_pk_bf16_f32 v50, v108, v109
    v_cvt_pk_bf16_f32 v51, v110, v111
    v_mfma_f32_32x32x16_bf16 v[88:103], v[36:39], v[20:23], v[88:103]
    ds_read_b128 v[32:35], v10 offset:28672
    ds_read_b128 v[36:39], v10 offset:29696
    v_exp_f32 v112, v112
    v_exp_f32 v113, v113
    v_exp_f32 v114, v114
    v_exp_f32 v115, v115
    v_mfma_f32_32x32x16_bf16 v[136:151], v[40:43], v[48:51], v[136:151]
    ds_read_b128 v[44:47], v10 offset:23552
    ds_read_b128 v[40:43], v10 offset:26624
    v_exp_f32 v116, v116
    v_exp_f32 v117, v117
    v_exp_f32 v118, v118
    v_exp_f32 v119, v119
    v_mfma_f32_16x16x32_bf16 v[64:67], v[56:59], v[48:51], v[64:67]
    v_cvt_pk_bf16_f32 v52, v112, v113
    v_cvt_pk_bf16_f32 v53, v114, v115
    v_cvt_pk_bf16_f32 v54, v116, v117
    v_cvt_pk_bf16_f32 v55, v118, v119
    s_waitcnt vmcnt(0)
    s_barrier
    s_waitcnt lgkmcnt(2)
    v_mfma_f32_32x32x16_bf16 v[104:119], v[32:35], v[16:19], v[72:87]
    v_exp_f32 v88, v88
    v_exp_f32 v89, v89
    v_exp_f32 v90, v90
    v_exp_f32 v91, v91
    s_waitcnt lgkmcnt(0)
    s_add_u32 m0, s18, 65536
    s_mov_b32 s19, 163840
    buffer_load_dwordx4 v12, s[12:15], s19 offen lds
    v_mfma_f32_16x16x32_bf16 v[164:167], v[192:195], v[152:155], 0
    v_mfma_f32_32x32x16_bf16 v[136:151], v[44:47], v[52:55], v[136:151]
    v_exp_f32 v92, v92
    v_exp_f32 v93, v93
    v_exp_f32 v94, v94
    v_exp_f32 v95, v95
    s_add_u32 m0, s18, 73728
    s_mov_b32 s19, 163840
    buffer_load_dwordx4 v13, s[12:15], s19 offen lds
    v_mfma_f32_16x16x32_bf16 v[168:171], v[192:195], v[156:159], 0
    v_mfma_f32_16x16x32_bf16 v[64:67], v[56:59], v[52:55], v[64:67]
    v_cvt_pk_bf16_f32 v48, v88, v89
    v_cvt_pk_bf16_f32 v49, v90, v91
    v_cvt_pk_bf16_f32 v50, v92, v93
    v_cvt_pk_bf16_f32 v51, v94, v95
    v_mfma_f32_32x32x16_bf16 v[104:119], v[36:39], v[20:23], v[104:119]
    s_add_u32 m0, s18, 81920
    s_mov_b32 s19, 163840
    buffer_load_dwordx4 v14, s[12:15], s19 offen lds
    ds_read_b128 v[32:35], v10 offset:32768
    ds_read_b128 v[36:39], v10 offset:33792
    v_exp_f32 v96, v96
    v_exp_f32 v97, v97
    v_exp_f32 v98, v98
    v_exp_f32 v99, v99
    v_mfma_f32_32x32x16_bf16 v[136:151], v[40:43], v[48:51], v[136:151]
    ds_read_b128 v[44:47], v10 offset:27648
    ds_read_b128 v[40:43], v10 offset:30720
    v_exp_f32 v100, v100
    v_exp_f32 v101, v101
    v_exp_f32 v102, v102
    v_exp_f32 v103, v103
    s_add_u32 m0, s18, 90112
    s_mov_b32 s19, 163840
    buffer_load_dwordx4 v15, s[12:15], s19 offen lds
    v_mfma_f32_16x16x32_bf16 v[64:67], v[56:59], v[48:51], v[64:67]
    ds_read_b128 v[232:235], v24
    ds_read_b128 v[236:239], v24 offset:4096
    ds_read_b128 v[240:243], v26
    ds_read_b128 v[244:247], v25
    ds_read_b128 v[248:251], v25 offset:4096
    ds_read_b128 v[252:255], v27
    v_cvt_pk_bf16_f32 v52, v96, v97
    v_cvt_pk_bf16_f32 v53, v98, v99
    v_cvt_pk_bf16_f32 v54, v100, v101
    v_cvt_pk_bf16_f32 v55, v102, v103
    s_bitcmp1_b32 s58, 0
    s_cselect_b32 s84, s52, s50
    s_cselect_b32 s85, s53, s51
    s_mov_b32 s86, 2097152
    s_lshr_b32 s59, s58, 2
    s_add_u32 s59, s59, 1
    s_sub_u32 s63, 1024, s59
    s_lshl_b32 s59, s59, 11
    s_lshl_b32 s63, s63, 11
    v_mov_b32 v3, s63
    v_mov_b32 v4, s59
    v_cmp_gt_u32 vcc, 32, v2
    v_and_b32 v5, 15, v2
    v_lshlrev_b32 v5, 5, v5
    v_bfe_u32 v6, v2, 4, 1
    v_lshl_add_u32 v5, v6, 4, v5
    v_cndmask_b32 v3, v3, v4, vcc
    v_add_u32 v69, v3, v5
    s_and_b32 s63, s58, 2
    s_lshl_b32 s63, s63, 9
    s_mov_b32 s80, s88
    s_mov_b32 s81, s89
    s_mov_b32 s82, 2097152
    s_mov_b32 s83, 0x00020000
    v_lshl_add_u32 v3, v0, 8, s2
    v_lshlrev_b32 v3, 7, v3
    buffer_load_dword v176, v3, s[80:83], 0 offen
    s_mov_b32 s87, 0x00020000
    s_lshr_b32 s59, s58, 1
    s_and_b32 s59, s59, 7
    s_lshl_b32 s59, s59, 9
    s_add_u32 s59, s59, 4194304
    v_add_u32 v7, s59, v5
    s_waitcnt lgkmcnt(8)
    v_mfma_f32_32x32x16_bf16 v[88:103], v[32:35], v[16:19], v[72:87]
    v_exp_f32 v104, v104
    v_exp_f32 v105, v105
    v_exp_f32 v106, v106
    v_exp_f32 v107, v107
    s_waitcnt lgkmcnt(0)
    v_max3_f32 v70, |v164|, |v165|, v70
    v_max3_f32 v70, |v166|, |v167|, v70
    buffer_load_dwordx4 v[152:155], v69, s[84:87], s63 offen offset:0
    v_mfma_f32_32x32x16_bf16 v[136:151], v[44:47], v[52:55], v[136:151]
    ds_read_b128 v[44:47], v10 offset:31744
    v_exp_f32 v108, v108
    v_exp_f32 v109, v109
    v_mfma_f32_32x32x16_bf16 v[200:215], v[232:235], v[240:243], v[200:215]
    v_exp_f32 v110, v110
    v_exp_f32 v111, v111
    v_max3_f32 v70, |v168|, |v169|, v70
    v_max3_f32 v70, |v170|, |v171|, v70
    buffer_load_dwordx4 v[156:159], v69, s[84:87], s63 offen offset:512
    v_mfma_f32_16x16x32_bf16 v[64:67], v[56:59], v[52:55], v[64:67]
    v_cvt_pk_bf16_f32 v48, v104, v105
    v_cvt_pk_bf16_f32 v49, v106, v107
    v_cvt_pk_bf16_f32 v50, v108, v109
    v_cvt_pk_bf16_f32 v51, v110, v111
    v_mfma_f32_32x32x16_bf16 v[88:103], v[36:39], v[20:23], v[88:103]
    buffer_load_dwordx4 v[160:163], v7, s[76:79], 0 offen
    ds_read_b128 v[32:35], v10 offset:36864
    ds_read_b128 v[36:39], v10 offset:37888
    v_exp_f32 v112, v112
    v_exp_f32 v113, v113
    v_mfma_f32_32x32x16_bf16 v[216:231], v[236:239], v[240:243], v[216:231]
    v_exp_f32 v114, v114
    v_exp_f32 v115, v115
    v_mfma_f32_32x32x16_bf16 v[136:151], v[40:43], v[48:51], v[136:151]
    ds_read_b128 v[40:43], v10 offset:34816
    v_exp_f32 v116, v116
    v_exp_f32 v117, v117
    v_mfma_f32_32x32x16_bf16 v[200:215], v[244:247], v[252:255], v[200:215]
    v_exp_f32 v118, v118
    v_exp_f32 v119, v119
    v_mfma_f32_16x16x32_bf16 v[64:67], v[56:59], v[48:51], v[64:67]
    v_cvt_pk_bf16_f32 v52, v112, v113
    v_cvt_pk_bf16_f32 v53, v114, v115
    v_cvt_pk_bf16_f32 v54, v116, v117
    v_cvt_pk_bf16_f32 v55, v118, v119
    v_mfma_f32_32x32x16_bf16 v[216:231], v[248:251], v[252:255], v[216:231]
    s_waitcnt lgkmcnt(3)
    s_nop 0
    v_mfma_f32_32x32x16_bf16 v[136:151], v[44:47], v[52:55], v[136:151]
    v_mfma_f32_16x16x32_bf16 v[64:67], v[56:59], v[52:55], v[64:67]
    s_nop 7
    v_cmp_nlt_f32 vcc, v64, s28
    s_nop 1
    s_cbranch_vccnz L_at3_slow
L_at3_ret:
    s_waitcnt lgkmcnt(2)
    v_mfma_f32_32x32x16_bf16 v[104:119], v[32:35], v[16:19], v[72:87]
    v_exp_f32 v88, v88
    v_exp_f32 v89, v89
    v_exp_f32 v90, v90
    v_exp_f32 v91, v91
    s_waitcnt lgkmcnt(0)
    s_add_u32 m0, s18, 131072
    s_nop 0
    buffer_load_dwordx4 v68, s[4:7], s40 offen lds
    s_add_u32 s40, s40, 256
    v_exp_f32 v92, v92
    v_exp_f32 v93, v93
    v_exp_f32 v94, v94
    v_exp_f32 v95, v95
    s_add_u32 m0, s18, 139264
    s_nop 0
    buffer_load_dwordx4 v68, s[8:11], s41 offen lds
    s_add_u32 s41, s41, 256
    v_cvt_pk_bf16_f32 v48, v88, v89
    v_cvt_pk_bf16_f32 v49, v90, v91
    v_cvt_pk_bf16_f32 v50, v92, v93
    v_cvt_pk_bf16_f32 v51, v94, v95
    v_mfma_f32_32x32x16_bf16 v[104:119], v[36:39], v[20:23], v[104:119]
    s_add_u32 m0, s18, 147456
    s_nop 0
    buffer_load_dwordx4 v68, s[4:7], s42 offen lds
    s_add_u32 s42, s42, 256
    ds_read_b128 v[32:35], v10 offset:40960
    ds_read_b128 v[36:39], v10 offset:41984
    v_exp_f32 v96, v96
    v_exp_f32 v97, v97
    v_exp_f32 v98, v98
    v_exp_f32 v99, v99
    v_mfma_f32_32x32x16_bf16 v[120:135], v[40:43], v[48:51], v[136:151]
    ds_read_b128 v[44:47], v10 offset:35840
    ds_read_b128 v[40:43], v10 offset:38912
    v_exp_f32 v100, v100
    v_exp_f32 v101, v101
    v_exp_f32 v102, v102
    v_exp_f32 v103, v103
    s_add_u32 m0, s18, 155648
    s_nop 0
    buffer_load_dwordx4 v68, s[8:11], s43 offen lds
    s_add_u32 s43, s43, 256
    v_mfma_f32_16x16x32_bf16 v[60:63], v[56:59], v[48:51], v[64:67]
    v_cvt_pk_bf16_f32 v52, v96, v97
    v_cvt_pk_bf16_f32 v53, v98, v99
    v_cvt_pk_bf16_f32 v54, v100, v101
    v_cvt_pk_bf16_f32 v55, v102, v103
    s_waitcnt lgkmcnt(2)
    v_mfma_f32_32x32x16_bf16 v[88:103], v[32:35], v[16:19], v[72:87]
    v_exp_f32 v104, v104
    v_exp_f32 v105, v105
    v_exp_f32 v106, v106
    v_exp_f32 v107, v107
    s_waitcnt lgkmcnt(0)
    v_mfma_f32_32x32x16_bf16 v[120:135], v[44:47], v[52:55], v[120:135]
    v_exp_f32 v108, v108
    v_exp_f32 v109, v109
    v_exp_f32 v110, v110
    v_exp_f32 v111, v111
    v_mfma_f32_16x16x32_bf16 v[60:63], v[56:59], v[52:55], v[60:63]
    v_cvt_pk_bf16_f32 v48, v104, v105
    v_cvt_pk_bf16_f32 v49, v106, v107
    v_cvt_pk_bf16_f32 v50, v108, v109
    v_cvt_pk_bf16_f32 v51, v110, v111
    v_mfma_f32_32x32x16_bf16 v[88:103], v[36:39], v[20:23], v[88:103]
    ds_read_b128 v[32:35], v10 offset:45056
    ds_read_b128 v[36:39], v10 offset:46080
    v_exp_f32 v112, v112
    v_exp_f32 v113, v113
    v_exp_f32 v114, v114
    v_exp_f32 v115, v115
    v_mfma_f32_32x32x16_bf16 v[120:135], v[40:43], v[48:51], v[120:135]
    ds_read_b128 v[44:47], v10 offset:39936
    ds_read_b128 v[40:43], v10 offset:43008
    v_exp_f32 v116, v116
    v_exp_f32 v117, v117
    v_exp_f32 v118, v118
    v_exp_f32 v119, v119
    v_mfma_f32_16x16x32_bf16 v[60:63], v[56:59], v[48:51], v[60:63]
    v_cvt_pk_bf16_f32 v52, v112, v113
    v_cvt_pk_bf16_f32 v53, v114, v115
    v_cvt_pk_bf16_f32 v54, v116, v117
    v_cvt_pk_bf16_f32 v55, v118, v119
    s_waitcnt lgkmcnt(2)
    v_mfma_f32_32x32x16_bf16 v[104:119], v[32:35], v[16:19], v[72:87]
    v_exp_f32 v88, v88
    v_exp_f32 v89, v89
    v_exp_f32 v90, v90
    v_exp_f32 v91, v91
    s_waitcnt lgkmcnt(0)
    v_mfma_f32_32x32x16_bf16 v[120:135], v[44:47], v[52:55], v[120:135]
    v_exp_f32 v92, v92
    v_exp_f32 v93, v93
    v_exp_f32 v94, v94
    v_exp_f32 v95, v95
    v_mfma_f32_16x16x32_bf16 v[60:63], v[56:59], v[52:55], v[60:63]
    v_cvt_pk_bf16_f32 v48, v88, v89
    v_cvt_pk_bf16_f32 v49, v90, v91
    v_cvt_pk_bf16_f32 v50, v92, v93
    v_cvt_pk_bf16_f32 v51, v94, v95
    v_mfma_f32_32x32x16_bf16 v[104:119], v[36:39], v[20:23], v[104:119]
    ds_read_b128 v[32:35], v10 offset:49152
    ds_read_b128 v[36:39], v10 offset:50176
    v_exp_f32 v96, v96
    v_exp_f32 v97, v97
    v_exp_f32 v98, v98
    v_exp_f32 v99, v99
    v_mfma_f32_32x32x16_bf16 v[120:135], v[40:43], v[48:51], v[120:135]
    ds_read_b128 v[44:47], v10 offset:44032
    ds_read_b128 v[40:43], v10 offset:47104
    v_exp_f32 v100, v100
    v_exp_f32 v101, v101
    v_exp_f32 v102, v102
    v_exp_f32 v103, v103
    v_mfma_f32_16x16x32_bf16 v[60:63], v[56:59], v[48:51], v[60:63]
    v_cvt_pk_bf16_f32 v52, v96, v97
    v_cvt_pk_bf16_f32 v53, v98, v99
    v_cvt_pk_bf16_f32 v54, v100, v101
    v_cvt_pk_bf16_f32 v55, v102, v103
    s_waitcnt lgkmcnt(2)
    v_mfma_f32_32x32x16_bf16 v[88:103], v[32:35], v[16:19], v[72:87]
    v_exp_f32 v104, v104
    v_exp_f32 v105, v105
    v_exp_f32 v106, v106
    v_exp_f32 v107, v107
    s_waitcnt lgkmcnt(0)
    v_mfma_f32_32x32x16_bf16 v[120:135], v[44:47], v[52:55], v[120:135]
    v_exp_f32 v108, v108
    v_exp_f32 v109, v109
    v_exp_f32 v110, v110
    v_exp_f32 v111, v111
    v_mfma_f32_16x16x32_bf16 v[60:63], v[56:59], v[52:55], v[60:63]
    v_cvt_pk_bf16_f32 v48, v104, v105
    v_cvt_pk_bf16_f32 v49, v106, v107
    v_cvt_pk_bf16_f32 v50, v108, v109
    v_cvt_pk_bf16_f32 v51, v110, v111
    v_mfma_f32_32x32x16_bf16 v[88:103], v[36:39], v[20:23], v[88:103]
    ds_read_b128 v[32:35], v10 offset:53248
    ds_read_b128 v[36:39], v10 offset:54272
    v_exp_f32 v112, v112
    v_exp_f32 v113, v113
    v_exp_f32 v114, v114
    v_exp_f32 v115, v115
    v_mfma_f32_32x32x16_bf16 v[120:135], v[40:43], v[48:51], v[120:135]
    ds_read_b128 v[44:47], v10 offset:48128
    ds_read_b128 v[40:43], v10 offset:51200
    v_exp_f32 v116, v116
    v_exp_f32 v117, v117
    v_exp_f32 v118, v118
    v_exp_f32 v119, v119
    v_mfma_f32_16x16x32_bf16 v[60:63], v[56:59], v[48:51], v[60:63]
    v_cvt_pk_bf16_f32 v52, v112, v113
    v_cvt_pk_bf16_f32 v53, v114, v115
    v_cvt_pk_bf16_f32 v54, v116, v117
    v_cvt_pk_bf16_f32 v55, v118, v119
    s_waitcnt lgkmcnt(2)
    v_mfma_f32_32x32x16_bf16 v[104:119], v[32:35], v[16:19], v[72:87]
    v_exp_f32 v88, v88
    v_exp_f32 v89, v89
    v_exp_f32 v90, v90
    v_exp_f32 v91, v91
    s_waitcnt lgkmcnt(0)
    v_mfma_f32_32x32x16_bf16 v[120:135], v[44:47], v[52:55], v[120:135]
    v_exp_f32 v92, v92
    v_exp_f32 v93, v93
    v_exp_f32 v94, v94
    v_exp_f32 v95, v95
    v_mfma_f32_16x16x32_bf16 v[60:63], v[56:59], v[52:55], v[60:63]
    v_cvt_pk_bf16_f32 v48, v88, v89
    v_cvt_pk_bf16_f32 v49, v90, v91
    v_cvt_pk_bf16_f32 v50, v92, v93
    v_cvt_pk_bf16_f32 v51, v94, v95
    v_mfma_f32_32x32x16_bf16 v[104:119], v[36:39], v[20:23], v[104:119]
    ds_read_b128 v[32:35], v10 offset:57344
    ds_read_b128 v[36:39], v10 offset:58368
    v_exp_f32 v96, v96
    v_exp_f32 v97, v97
    v_exp_f32 v98, v98
    v_exp_f32 v99, v99
    v_mfma_f32_32x32x16_bf16 v[120:135], v[40:43], v[48:51], v[120:135]
    ds_read_b128 v[44:47], v10 offset:52224
    ds_read_b128 v[40:43], v10 offset:55296
    v_exp_f32 v100, v100
    v_exp_f32 v101, v101
    v_exp_f32 v102, v102
    v_exp_f32 v103, v103
    v_mfma_f32_16x16x32_bf16 v[60:63], v[56:59], v[48:51], v[60:63]
    v_cvt_pk_bf16_f32 v52, v96, v97
    v_cvt_pk_bf16_f32 v53, v98, v99
    v_cvt_pk_bf16_f32 v54, v100, v101
    v_cvt_pk_bf16_f32 v55, v102, v103
    s_waitcnt lgkmcnt(2)
    v_mfma_f32_32x32x16_bf16 v[88:103], v[32:35], v[16:19], v[72:87]
    v_exp_f32 v104, v104
    v_exp_f32 v105, v105
    v_exp_f32 v106, v106
    v_exp_f32 v107, v107
    s_waitcnt lgkmcnt(0)
    v_mfma_f32_32x32x16_bf16 v[120:135], v[44:47], v[52:55], v[120:135]
    v_exp_f32 v108, v108
    v_exp_f32 v109, v109
    v_exp_f32 v110, v110
    v_exp_f32 v111, v111
    v_mfma_f32_16x16x32_bf16 v[60:63], v[56:59], v[52:55], v[60:63]
    v_cvt_pk_bf16_f32 v48, v104, v105
    v_cvt_pk_bf16_f32 v49, v106, v107
    v_cvt_pk_bf16_f32 v50, v108, v109
    v_cvt_pk_bf16_f32 v51, v110, v111
    v_mfma_f32_32x32x16_bf16 v[88:103], v[36:39], v[20:23], v[88:103]
    ds_read_b128 v[32:35], v10 offset:61440
    ds_read_b128 v[36:39], v10 offset:62464
    v_exp_f32 v112, v112
    v_exp_f32 v113, v113
    v_exp_f32 v114, v114
    v_exp_f32 v115, v115
    v_mfma_f32_32x32x16_bf16 v[120:135], v[40:43], v[48:51], v[120:135]
    ds_read_b128 v[44:47], v10 offset:56320
    ds_read_b128 v[40:43], v10 offset:59392
    v_exp_f32 v116, v116
    v_exp_f32 v117, v117
    v_exp_f32 v118, v118
    v_exp_f32 v119, v119
    v_mfma_f32_16x16x32_bf16 v[60:63], v[56:59], v[48:51], v[60:63]
    v_cvt_pk_bf16_f32 v52, v112, v113
    v_cvt_pk_bf16_f32 v53, v114, v115
    v_cvt_pk_bf16_f32 v54, v116, v117
    v_cvt_pk_bf16_f32 v55, v118, v119
    s_waitcnt vmcnt(0)
    s_barrier
    s_waitcnt lgkmcnt(2)
    v_mfma_f32_32x32x16_bf16 v[104:119], v[32:35], v[16:19], v[72:87]
    v_exp_f32 v88, v88
    v_exp_f32 v89, v89
    v_exp_f32 v90, v90
    v_exp_f32 v91, v91
    s_waitcnt lgkmcnt(0)
    s_add_u32 m0, s18, 0
    s_mov_b32 s19, 196608
    buffer_load_dwordx4 v12, s[12:15], s19 offen lds
    v_mfma_f32_16x16x32_bf16 v[164:167], v[192:195], v[152:155], 0
    v_mfma_f32_32x32x16_bf16 v[120:135], v[44:47], v[52:55], v[120:135]
    v_exp_f32 v92, v92
    v_exp_f32 v93, v93
    v_exp_f32 v94, v94
    v_exp_f32 v95, v95
    s_add_u32 m0, s18, 8192
    s_mov_b32 s19, 196608
    buffer_load_dwordx4 v13, s[12:15], s19 offen lds
    v_mfma_f32_16x16x32_bf16 v[168:171], v[192:195], v[156:159], 0
    v_mfma_f32_16x16x32_bf16 v[60:63], v[56:59], v[52:55], v[60:63]
    v_cvt_pk_bf16_f32 v48, v88, v89
    v_cvt_pk_bf16_f32 v49, v90, v91
    v_cvt_pk_bf16_f32 v50, v92, v93
    v_cvt_pk_bf16_f32 v51, v94, v95
    v_mfma_f32_32x32x16_bf16 v[104:119], v[36:39], v[20:23], v[104:119]
    s_add_u32 m0, s18, 16384
    s_mov_b32 s19, 196608
    buffer_load_dwordx4 v14, s[12:15], s19 offen lds
    v_mfma_f32_16x16x32_bf16 v[172:175], v[192:195], v[160:163], 0
    ds_read_b128 v[32:35], v11 offset:0
    ds_read_b128 v[36:39], v11 offset:1024
    v_exp_f32 v96, v96
    v_exp_f32 v97, v97
    v_exp_f32 v98, v98
    v_exp_f32 v99, v99
    v_mfma_f32_32x32x16_bf16 v[120:135], v[40:43], v[48:51], v[120:135]
    ds_read_b128 v[44:47], v10 offset:60416
    ds_read_b128 v[40:43], v10 offset:63488
    v_exp_f32 v100, v100
    v_exp_f32 v101, v101
    v_exp_f32 v102, v102
    v_exp_f32 v103, v103
    s_add_u32 m0, s18, 24576
    s_mov_b32 s19, 196608
    buffer_load_dwordx4 v15, s[12:15], s19 offen lds
    v_mfma_f32_16x16x32_bf16 v[60:63], v[56:59], v[48:51], v[60:63]
    ds_read_b128 v[232:235], v28
    ds_read_b128 v[236:239], v28 offset:4096
    ds_read_b128 v[240:243], v30
    ds_read_b128 v[244:247], v29
    ds_read_b128 v[248:251], v29 offset:4096
    ds_read_b128 v[252:255], v31
    v_cvt_pk_bf16_f32 v52, v96, v97
    v_cvt_pk_bf16_f32 v53, v98, v99
    v_cvt_pk_bf16_f32 v54, v100, v101
    v_cvt_pk_bf16_f32 v55, v102, v103
    v_mov_b32 v3, 512
    v_mov_b32 v4, -512
    v_cmp_gt_u32 vcc, 32, v2
    s_lshr_b32 s59, s58, 1
    s_sub_u32 s63, 4194304, s61
    s_and_b32 s23, s58, 0xfffffff9
    v_cndmask_b32 v69, v4, v3, vcc
    s_cmp_eq_u32 s23, 0
    s_cselect_b32 s59, s59, 0
    s_cselect_b32 s63, s63, 0
    v_mul_lo_u32 v7, v69, s59
    v_add3_u32 v7, v7, v71, s63
    s_waitcnt lgkmcnt(8)
    v_mfma_f32_32x32x16_bf16 v[88:103], v[32:35], v[16:19], v[72:87]
    v_exp_f32 v104, v104
    v_exp_f32 v105, v105
    v_exp_f32 v106, v106
    v_exp_f32 v107, v107
    s_waitcnt lgkmcnt(0)
    v_max3_f32 v70, |v164|, |v165|, v70
    v_max3_f32 v70, |v166|, |v167|, v70
    buffer_load_dwordx4 v[152:155], v71, s[76:79], 0 offen
    v_add_u32 v71, v71, v69
    v_mfma_f32_32x32x16_bf16 v[120:135], v[44:47], v[52:55], v[120:135]
    ds_read_b128 v[44:47], v10 offset:64512
    v_exp_f32 v108, v108
    v_exp_f32 v109, v109
    v_mfma_f32_32x32x16_bf16 v[200:215], v[232:235], v[240:243], v[200:215]
    v_exp_f32 v110, v110
    v_exp_f32 v111, v111
    v_max3_f32 v70, |v168|, |v169|, v70
    v_max3_f32 v70, |v170|, |v171|, v70
    buffer_load_dwordx4 v[156:159], v71, s[76:79], 0 offen
    v_add_u32 v71, v71, v69
    v_mfma_f32_16x16x32_bf16 v[60:63], v[56:59], v[52:55], v[60:63]
    v_cvt_pk_bf16_f32 v48, v104, v105
    v_cvt_pk_bf16_f32 v49, v106, v107
    v_cvt_pk_bf16_f32 v50, v108, v109
    v_cvt_pk_bf16_f32 v51, v110, v111
    v_mfma_f32_32x32x16_bf16 v[88:103], v[36:39], v[20:23], v[88:103]
    v_max3_f32 v70, |v172|, |v173|, v70
    v_max3_f32 v70, |v174|, |v175|, v70
    buffer_load_dwordx4 v[160:163], v7, s[76:79], 0 offen
    ds_read_b128 v[32:35], v11 offset:4096
    ds_read_b128 v[36:39], v11 offset:5120
    v_exp_f32 v112, v112
    v_exp_f32 v113, v113
    v_mfma_f32_32x32x16_bf16 v[216:231], v[236:239], v[240:243], v[216:231]
    v_exp_f32 v114, v114
    v_exp_f32 v115, v115
    v_mfma_f32_32x32x16_bf16 v[120:135], v[40:43], v[48:51], v[120:135]
    ds_read_b128 v[40:43], v11 offset:2048
    v_exp_f32 v116, v116
    v_exp_f32 v117, v117
    v_mfma_f32_32x32x16_bf16 v[200:215], v[244:247], v[252:255], v[200:215]
    v_exp_f32 v118, v118
    v_exp_f32 v119, v119
    v_mfma_f32_16x16x32_bf16 v[60:63], v[56:59], v[48:51], v[60:63]
    v_cvt_pk_bf16_f32 v52, v112, v113
    v_cvt_pk_bf16_f32 v53, v114, v115
    v_cvt_pk_bf16_f32 v54, v116, v117
    v_cvt_pk_bf16_f32 v55, v118, v119
    v_mfma_f32_32x32x16_bf16 v[216:231], v[248:251], v[252:255], v[216:231]
    s_waitcnt lgkmcnt(3)
    s_nop 0
    v_mfma_f32_32x32x16_bf16 v[120:135], v[44:47], v[52:55], v[120:135]
    v_mfma_f32_16x16x32_bf16 v[60:63], v[56:59], v[52:55], v[60:63]
    s_nop 7
    v_cmp_nlt_f32 vcc, v60, s28
    s_nop 1
    s_cbranch_vccnz L_at4_slow
L_at4_ret:
    s_waitcnt lgkmcnt(2)
    v_mfma_f32_32x32x16_bf16 v[104:119], v[32:35], v[16:19], v[72:87]
    v_exp_f32 v88, v88
    v_exp_f32 v89, v89
    v_exp_f32 v90, v90
    v_exp_f32 v91, v91
    s_waitcnt lgkmcnt(0)
    s_add_u32 m0, s18, 98304
    s_nop 0
    buffer_load_dwordx4 v68, s[4:7], s40 offen lds
    s_add_u32 s40, s40, 256
    v_exp_f32 v92, v92
    v_exp_f32 v93, v93
    v_exp_f32 v94, v94
    v_exp_f32 v95, v95
    s_add_u32 m0, s18, 106496
    s_nop 0
    buffer_load_dwordx4 v68, s[8:11], s41 offen lds
    s_add_u32 s41, s41, 256
    v_cvt_pk_bf16_f32 v48, v88, v89
    v_cvt_pk_bf16_f32 v49, v90, v91
    v_cvt_pk_bf16_f32 v50, v92, v93
    v_cvt_pk_bf16_f32 v51, v94, v95
    v_mfma_f32_32x32x16_bf16 v[104:119], v[36:39], v[20:23], v[104:119]
    s_add_u32 m0, s18, 114688
    s_nop 0
    buffer_load_dwordx4 v68, s[4:7], s42 offen lds
    s_add_u32 s42, s42, 256
    ds_read_b128 v[32:35], v11 offset:8192
    ds_read_b128 v[36:39], v11 offset:9216
    v_exp_f32 v96, v96
    v_exp_f32 v97, v97
    v_exp_f32 v98, v98
    v_exp_f32 v99, v99
    v_mfma_f32_32x32x16_bf16 v[136:151], v[40:43], v[48:51], v[120:135]
    ds_read_b128 v[44:47], v11 offset:3072
    ds_read_b128 v[40:43], v11 offset:6144
    v_exp_f32 v100, v100
    v_exp_f32 v101, v101
    v_exp_f32 v102, v102
    v_exp_f32 v103, v103
    s_add_u32 m0, s18, 122880
    s_nop 0
    buffer_load_dwordx4 v68, s[8:11], s43 offen lds
    s_add_u32 s43, s43, 256
    v_mfma_f32_16x16x32_bf16 v[64:67], v[56:59], v[48:51], v[60:63]
    v_cvt_pk_bf16_f32 v52, v96, v97
    v_cvt_pk_bf16_f32 v53, v98, v99
    v_cvt_pk_bf16_f32 v54, v100, v101
    v_cvt_pk_bf16_f32 v55, v102, v103
    s_waitcnt lgkmcnt(2)
    v_mfma_f32_32x32x16_bf16 v[88:103], v[32:35], v[16:19], v[72:87]
    v_exp_f32 v104, v104
    v_exp_f32 v105, v105
    v_exp_f32 v106, v106
    v_exp_f32 v107, v107
    s_waitcnt lgkmcnt(0)
    v_mfma_f32_32x32x16_bf16 v[136:151], v[44:47], v[52:55], v[136:151]
    v_exp_f32 v108, v108
    v_exp_f32 v109, v109
    v_exp_f32 v110, v110
    v_exp_f32 v111, v111
    v_mfma_f32_16x16x32_bf16 v[64:67], v[56:59], v[52:55], v[64:67]
    v_cvt_pk_bf16_f32 v48, v104, v105
    v_cvt_pk_bf16_f32 v49, v106, v107
    v_cvt_pk_bf16_f32 v50, v108, v109
    v_cvt_pk_bf16_f32 v51, v110, v111
    v_mfma_f32_32x32x16_bf16 v[88:103], v[36:39], v[20:23], v[88:103]
    ds_read_b128 v[32:35], v11 offset:12288
    ds_read_b128 v[36:39], v11 offset:13312
    v_exp_f32 v112, v112
    v_exp_f32 v113, v113
    v_exp_f32 v114, v114
    v_exp_f32 v115, v115
    v_mfma_f32_32x32x16_bf16 v[136:151], v[40:43], v[48:51], v[136:151]
    ds_read_b128 v[44:47], v11 offset:7168
    ds_read_b128 v[40:43], v11 offset:10240
    v_exp_f32 v116, v116
    v_exp_f32 v117, v117
    v_exp_f32 v118, v118
    v_exp_f32 v119, v119
    v_mfma_f32_16x16x32_bf16 v[64:67], v[56:59], v[48:51], v[64:67]
    v_cvt_pk_bf16_f32 v52, v112, v113
    v_cvt_pk_bf16_f32 v53, v114, v115
    v_cvt_pk_bf16_f32 v54, v116, v117
    v_cvt_pk_bf16_f32 v55, v118, v119
    s_waitcnt lgkmcnt(2)
    v_mfma_f32_32x32x16_bf16 v[104:119], v[32:35], v[16:19], v[72:87]
    v_exp_f32 v88, v88
    v_exp_f32 v89, v89
    v_exp_f32 v90, v90
    v_exp_f32 v91, v91
    s_waitcnt lgkmcnt(0)
    v_mfma_f32_32x32x16_bf16 v[136:151], v[44:47], v[52:55], v[136:151]
    v_exp_f32 v92, v92
    v_exp_f32 v93, v93
    v_exp_f32 v94, v94
    v_exp_f32 v95, v95
    v_mfma_f32_16x16x32_bf16 v[64:67], v[56:59], v[52:55], v[64:67]
    v_cvt_pk_bf16_f32 v48, v88, v89
    v_cvt_pk_bf16_f32 v49, v90, v91
    v_cvt_pk_bf16_f32 v50, v92, v93
    v_cvt_pk_bf16_f32 v51, v94, v95
    v_mfma_f32_32x32x16_bf16 v[104:119], v[36:39], v[20:23], v[104:119]
    ds_read_b128 v[32:35], v11 offset:16384
    ds_read_b128 v[36:39], v11 offset:17408
    v_exp_f32 v96, v96
    v_exp_f32 v97, v97
    v_exp_f32 v98, v98
    v_exp_f32 v99, v99
    v_mfma_f32_32x32x16_bf16 v[136:151], v[40:43], v[48:51], v[136:151]
    ds_read_b128 v[44:47], v11 offset:11264
    ds_read_b128 v[40:43], v11 offset:14336
    v_exp_f32 v100, v100
    v_exp_f32 v101, v101
    v_exp_f32 v102, v102
    v_exp_f32 v103, v103
    v_mfma_f32_16x16x32_bf16 v[64:67], v[56:59], v[48:51], v[64:67]
    v_cvt_pk_bf16_f32 v52, v96, v97
    v_cvt_pk_bf16_f32 v53, v98, v99
    v_cvt_pk_bf16_f32 v54, v100, v101
    v_cvt_pk_bf16_f32 v55, v102, v103
    s_waitcnt lgkmcnt(2)
    v_mfma_f32_32x32x16_bf16 v[88:103], v[32:35], v[16:19], v[72:87]
    v_exp_f32 v104, v104
    v_exp_f32 v105, v105
    v_exp_f32 v106, v106
    v_exp_f32 v107, v107
    s_waitcnt lgkmcnt(0)
    v_mfma_f32_32x32x16_bf16 v[136:151], v[44:47], v[52:55], v[136:151]
    v_exp_f32 v108, v108
    v_exp_f32 v109, v109
    v_exp_f32 v110, v110
    v_exp_f32 v111, v111
    v_mfma_f32_16x16x32_bf16 v[64:67], v[56:59], v[52:55], v[64:67]
    v_cvt_pk_bf16_f32 v48, v104, v105
    v_cvt_pk_bf16_f32 v49, v106, v107
    v_cvt_pk_bf16_f32 v50, v108, v109
    v_cvt_pk_bf16_f32 v51, v110, v111
    v_mfma_f32_32x32x16_bf16 v[88:103], v[36:39], v[20:23], v[88:103]
    ds_read_b128 v[32:35], v11 offset:20480
    ds_read_b128 v[36:39], v11 offset:21504
    v_exp_f32 v112, v112
    v_exp_f32 v113, v113
    v_exp_f32 v114, v114
    v_exp_f32 v115, v115
    v_mfma_f32_32x32x16_bf16 v[136:151], v[40:43], v[48:51], v[136:151]
    ds_read_b128 v[44:47], v11 offset:15360
    ds_read_b128 v[40:43], v11 offset:18432
    v_exp_f32 v116, v116
    v_exp_f32 v117, v117
    v_exp_f32 v118, v118
    v_exp_f32 v119, v119
    v_mfma_f32_16x16x32_bf16 v[64:67], v[56:59], v[48:51], v[64:67]
    v_cvt_pk_bf16_f32 v52, v112, v113
    v_cvt_pk_bf16_f32 v53, v114, v115
    v_cvt_pk_bf16_f32 v54, v116, v117
    v_cvt_pk_bf16_f32 v55, v118, v119
    s_waitcnt lgkmcnt(2)
    v_mfma_f32_32x32x16_bf16 v[104:119], v[32:35], v[16:19], v[72:87]
    v_exp_f32 v88, v88
    v_exp_f32 v89, v89
    v_exp_f32 v90, v90
    v_exp_f32 v91, v91
    s_waitcnt lgkmcnt(0)
    v_mfma_f32_32x32x16_bf16 v[136:151], v[44:47], v[52:55], v[136:151]
    v_exp_f32 v92, v92
    v_exp_f32 v93, v93
    v_exp_f32 v94, v94
    v_exp_f32 v95, v95
    v_mfma_f32_16x16x32_bf16 v[64:67], v[56:59], v[52:55], v[64:67]
    v_cvt_pk_bf16_f32 v48, v88, v89
    v_cvt_pk_bf16_f32 v49, v90, v91
    v_cvt_pk_bf16_f32 v50, v92, v93
    v_cvt_pk_bf16_f32 v51, v94, v95
    v_mfma_f32_32x32x16_bf16 v[104:119], v[36:39], v[20:23], v[104:119]
    ds_read_b128 v[32:35], v11 offset:24576
    ds_read_b128 v[36:39], v11 offset:25600
    v_exp_f32 v96, v96
    v_exp_f32 v97, v97
    v_exp_f32 v98, v98
    v_exp_f32 v99, v99
    v_mfma_f32_32x32x16_bf16 v[136:151], v[40:43], v[48:51], v[136:151]
    ds_read_b128 v[44:47], v11 offset:19456
    ds_read_b128 v[40:43], v11 offset:22528
    v_exp_f32 v100, v100
    v_exp_f32 v101, v101
    v_exp_f32 v102, v102
    v_exp_f32 v103, v103
    v_mfma_f32_16x16x32_bf16 v[64:67], v[56:59], v[48:51], v[64:67]
    v_cvt_pk_bf16_f32 v52, v96, v97
    v_cvt_pk_bf16_f32 v53, v98, v99
    v_cvt_pk_bf16_f32 v54, v100, v101
    v_cvt_pk_bf16_f32 v55, v102, v103
    s_waitcnt lgkmcnt(2)
    v_mfma_f32_32x32x16_bf16 v[88:103], v[32:35], v[16:19], v[72:87]
    v_exp_f32 v104, v104
    v_exp_f32 v105, v105
    v_exp_f32 v106, v106
    v_exp_f32 v107, v107
    s_waitcnt lgkmcnt(0)
    v_mfma_f32_32x32x16_bf16 v[136:151], v[44:47], v[52:55], v[136:151]
    v_exp_f32 v108, v108
    v_exp_f32 v109, v109
    v_exp_f32 v110, v110
    v_exp_f32 v111, v111
    v_mfma_f32_16x16x32_bf16 v[64:67], v[56:59], v[52:55], v[64:67]
    v_cvt_pk_bf16_f32 v48, v104, v105
    v_cvt_pk_bf16_f32 v49, v106, v107
    v_cvt_pk_bf16_f32 v50, v108, v109
    v_cvt_pk_bf16_f32 v51, v110, v111
    v_mfma_f32_32x32x16_bf16 v[88:103], v[36:39], v[20:23], v[88:103]
    ds_read_b128 v[32:35], v11 offset:28672
    ds_read_b128 v[36:39], v11 offset:29696
    v_exp_f32 v112, v112
    v_exp_f32 v113, v113
    v_exp_f32 v114, v114
    v_exp_f32 v115, v115
    v_mfma_f32_32x32x16_bf16 v[136:151], v[40:43], v[48:51], v[136:151]
    ds_read_b128 v[44:47], v11 offset:23552
    ds_read_b128 v[40:43], v11 offset:26624
    v_exp_f32 v116, v116
    v_exp_f32 v117, v117
    v_exp_f32 v118, v118
    v_exp_f32 v119, v119
    v_mfma_f32_16x16x32_bf16 v[64:67], v[56:59], v[48:51], v[64:67]
    v_cvt_pk_bf16_f32 v52, v112, v113
    v_cvt_pk_bf16_f32 v53, v114, v115
    v_cvt_pk_bf16_f32 v54, v116, v117
    v_cvt_pk_bf16_f32 v55, v118, v119
    s_waitcnt vmcnt(0)
    s_barrier
    s_waitcnt lgkmcnt(2)
    v_mfma_f32_32x32x16_bf16 v[104:119], v[32:35], v[16:19], v[72:87]
    v_exp_f32 v88, v88
    v_exp_f32 v89, v89
    v_exp_f32 v90, v90
    v_exp_f32 v91, v91
    s_waitcnt lgkmcnt(0)
    s_add_u32 m0, s18, 32768
    s_mov_b32 s19, 229376
    buffer_load_dwordx4 v12, s[12:15], s19 offen lds
    v_mfma_f32_16x16x32_bf16 v[164:167], v[196:199], v[152:155], 0
    v_mfma_f32_32x32x16_bf16 v[136:151], v[44:47], v[52:55], v[136:151]
    v_exp_f32 v92, v92
    v_exp_f32 v93, v93
    v_exp_f32 v94, v94
    v_exp_f32 v95, v95
    s_add_u32 m0, s18, 40960
    s_mov_b32 s19, 229376
    buffer_load_dwordx4 v13, s[12:15], s19 offen lds
    v_mfma_f32_16x16x32_bf16 v[168:171], v[196:199], v[156:159], 0
    v_mfma_f32_16x16x32_bf16 v[64:67], v[56:59], v[52:55], v[64:67]
    v_cvt_pk_bf16_f32 v48, v88, v89
    v_cvt_pk_bf16_f32 v49, v90, v91
    v_cvt_pk_bf16_f32 v50, v92, v93
    v_cvt_pk_bf16_f32 v51, v94, v95
    v_mfma_f32_32x32x16_bf16 v[104:119], v[36:39], v[20:23], v[104:119]
    s_add_u32 m0, s18, 49152
    s_mov_b32 s19, 229376
    buffer_load_dwordx4 v14, s[12:15], s19 offen lds
    v_mfma_f32_16x16x32_bf16 v[172:175], v[196:199], v[160:163], 0
    ds_read_b128 v[32:35], v10 offset:0
    ds_read_b128 v[36:39], v10 offset:1024
    v_exp_f32 v96, v96
    v_exp_f32 v97, v97
    v_exp_f32 v98, v98
    v_exp_f32 v99, v99
    v_mfma_f32_32x32x16_bf16 v[136:151], v[40:43], v[48:51], v[136:151]
    ds_read_b128 v[44:47], v11 offset:27648
    ds_read_b128 v[40:43], v11 offset:30720
    v_exp_f32 v100, v100
    v_exp_f32 v101, v101
    v_exp_f32 v102, v102
    v_exp_f32 v103, v103
    s_add_u32 m0, s18, 57344
    s_mov_b32 s19, 229376
    buffer_load_dwordx4 v15, s[12:15], s19 offen lds
    v_mfma_f32_16x16x32_bf16 v[64:67], v[56:59], v[48:51], v[64:67]
    ds_read_b128 v[232:235], v24
    ds_read_b128 v[236:239], v24 offset:4096
    ds_read_b128 v[240:243], v26
    ds_read_b128 v[244:247], v25
    ds_read_b128 v[248:251], v25 offset:4096
    ds_read_b128 v[252:255], v27
    v_cvt_pk_bf16_f32 v52, v96, v97
    v_cvt_pk_bf16_f32 v53, v98, v99
    v_cvt_pk_bf16_f32 v54, v100, v101
    v_cvt_pk_bf16_f32 v55, v102, v103
    s_waitcnt lgkmcnt(8)
    v_mfma_f32_32x32x16_bf16 v[88:103], v[32:35], v[16:19], v[72:87]
    v_exp_f32 v104, v104
    v_exp_f32 v105, v105
    v_exp_f32 v106, v106
    v_exp_f32 v107, v107
    s_waitcnt lgkmcnt(0)
    v_max3_f32 v70, |v164|, |v165|, v70
    v_max3_f32 v70, |v166|, |v167|, v70
    buffer_load_dwordx4 v[152:155], v71, s[76:79], 0 offen
    v_add_u32 v71, v71, v69
    v_mfma_f32_32x32x16_bf16 v[136:151], v[44:47], v[52:55], v[136:151]
    ds_read_b128 v[44:47], v11 offset:31744
    v_exp_f32 v108, v108
    v_exp_f32 v109, v109
    v_mfma_f32_32x32x16_bf16 v[200:215], v[232:235], v[240:243], v[200:215]
    v_exp_f32 v110, v110
    v_exp_f32 v111, v111
    v_max3_f32 v70, |v168|, |v169|, v70
    v_max3_f32 v70, |v170|, |v171|, v70
    buffer_load_dwordx4 v[156:159], v71, s[76:79], 0 offen
    v_add_u32 v71, v71, v69
    v_mfma_f32_16x16x32_bf16 v[64:67], v[56:59], v[52:55], v[64:67]
    v_cvt_pk_bf16_f32 v48, v104, v105
    v_cvt_pk_bf16_f32 v49, v106, v107
    v_cvt_pk_bf16_f32 v50, v108, v109
    v_cvt_pk_bf16_f32 v51, v110, v111
    v_mfma_f32_32x32x16_bf16 v[88:103], v[36:39], v[20:23], v[88:103]
    v_max3_f32 v70, |v172|, |v173|, v70
    v_max3_f32 v70, |v174|, |v175|, v70
    ds_read_b128 v[32:35], v10 offset:4096
    ds_read_b128 v[36:39], v10 offset:5120
    v_exp_f32 v112, v112
    v_exp_f32 v113, v113
    v_mfma_f32_32x32x16_bf16 v[216:231], v[236:239], v[240:243], v[216:231]
    v_exp_f32 v114, v114
    v_exp_f32 v115, v115
    v_mfma_f32_32x32x16_bf16 v[136:151], v[40:43], v[48:51], v[136:151]
    ds_read_b128 v[40:43], v10 offset:2048
    v_exp_f32 v116, v116
    v_exp_f32 v117, v117
    v_mfma_f32_32x32x16_bf16 v[200:215], v[244:247], v[252:255], v[200:215]
    v_exp_f32 v118, v118
    v_exp_f32 v119, v119
    v_mfma_f32_16x16x32_bf16 v[64:67], v[56:59], v[48:51], v[64:67]
    v_cvt_pk_bf16_f32 v52, v112, v113
    v_cvt_pk_bf16_f32 v53, v114, v115
    v_cvt_pk_bf16_f32 v54, v116, v117
    v_cvt_pk_bf16_f32 v55, v118, v119
    v_mfma_f32_32x32x16_bf16 v[216:231], v[248:251], v[252:255], v[216:231]
    s_waitcnt lgkmcnt(3)
    s_nop 0
    v_mfma_f32_32x32x16_bf16 v[136:151], v[44:47], v[52:55], v[136:151]
    v_mfma_f32_16x16x32_bf16 v[64:67], v[56:59], v[52:55], v[64:67]
    s_nop 7
    v_cmp_nlt_f32 vcc, v64, s28
    s_nop 1
    s_cbranch_vccnz L_at5_slow
L_at5_ret:
    s_waitcnt lgkmcnt(2)
    v_mfma_f32_32x32x16_bf16 v[104:119], v[32:35], v[16:19], v[72:87]
    v_exp_f32 v88, v88
    v_exp_f32 v89, v89
    v_exp_f32 v90, v90
    v_exp_f32 v91, v91
    s_waitcnt lgkmcnt(0)
    s_add_u32 m0, s18, 131072
    s_nop 0
    buffer_load_dwordx4 v68, s[4:7], s40 offen lds
    s_add_u32 s40, s40, 256
    v_exp_f32 v92, v92
    v_exp_f32 v93, v93
    v_exp_f32 v94, v94
    v_exp_f32 v95, v95
    s_add_u32 m0, s18, 139264
    s_nop 0
    buffer_load_dwordx4 v68, s[8:11], s41 offen lds
    s_add_u32 s41, s41, 256
    v_cvt_pk_bf16_f32 v48, v88, v89
    v_cvt_pk_bf16_f32 v49, v90, v91
    v_cvt_pk_bf16_f32 v50, v92, v93
    v_cvt_pk_bf16_f32 v51, v94, v95
    v_mfma_f32_32x32x16_bf16 v[104:119], v[36:39], v[20:23], v[104:119]
    s_add_u32 m0, s18, 147456
    s_nop 0
    buffer_load_dwordx4 v68, s[4:7], s42 offen lds
    s_add_u32 s42, s42, 256
    ds_read_b128 v[32:35], v10 offset:8192
    ds_read_b128 v[36:39], v10 offset:9216
    v_exp_f32 v96, v96
    v_exp_f32 v97, v97
    v_exp_f32 v98, v98
    v_exp_f32 v99, v99
    v_mfma_f32_32x32x16_bf16 v[120:135], v[40:43], v[48:51], v[136:151]
    ds_read_b128 v[44:47], v10 offset:3072
    ds_read_b128 v[40:43], v10 offset:6144
    v_exp_f32 v100, v100
    v_exp_f32 v101, v101
    v_exp_f32 v102, v102
    v_exp_f32 v103, v103
    s_add_u32 m0, s18, 155648
    s_nop 0
    buffer_load_dwordx4 v68, s[8:11], s43 offen lds
    s_add_u32 s43, s43, 256
    v_mfma_f32_16x16x32_bf16 v[60:63], v[56:59], v[48:51], v[64:67]
    v_cvt_pk_bf16_f32 v52, v96, v97
    v_cvt_pk_bf16_f32 v53, v98, v99
    v_cvt_pk_bf16_f32 v54, v100, v101
    v_cvt_pk_bf16_f32 v55, v102, v103
    s_waitcnt lgkmcnt(2)
    v_mfma_f32_32x32x16_bf16 v[88:103], v[32:35], v[16:19], v[72:87]
    v_exp_f32 v104, v104
    v_exp_f32 v105, v105
    v_exp_f32 v106, v106
    v_exp_f32 v107, v107
    s_waitcnt lgkmcnt(0)
    v_mfma_f32_32x32x16_bf16 v[120:135], v[44:47], v[52:55], v[120:135]
    v_exp_f32 v108, v108
    v_exp_f32 v109, v109
    v_exp_f32 v110, v110
    v_exp_f32 v111, v111
    v_mfma_f32_16x16x32_bf16 v[60:63], v[56:59], v[52:55], v[60:63]
    v_cvt_pk_bf16_f32 v48, v104, v105
    v_cvt_pk_bf16_f32 v49, v106, v107
    v_cvt_pk_bf16_f32 v50, v108, v109
    v_cvt_pk_bf16_f32 v51, v110, v111
    v_mfma_f32_32x32x16_bf16 v[88:103], v[36:39], v[20:23], v[88:103]
    ds_read_b128 v[32:35], v10 offset:12288
    ds_read_b128 v[36:39], v10 offset:13312
    v_exp_f32 v112, v112
    v_exp_f32 v113, v113
    v_exp_f32 v114, v114
    v_exp_f32 v115, v115
    v_mfma_f32_32x32x16_bf16 v[120:135], v[40:43], v[48:51], v[120:135]
    ds_read_b128 v[44:47], v10 offset:7168
    ds_read_b128 v[40:43], v10 offset:10240
    v_exp_f32 v116, v116
    v_exp_f32 v117, v117
    v_exp_f32 v118, v118
    v_exp_f32 v119, v119
    v_mfma_f32_16x16x32_bf16 v[60:63], v[56:59], v[48:51], v[60:63]
    v_cvt_pk_bf16_f32 v52, v112, v113
    v_cvt_pk_bf16_f32 v53, v114, v115
    v_cvt_pk_bf16_f32 v54, v116, v117
    v_cvt_pk_bf16_f32 v55, v118, v119
    s_waitcnt lgkmcnt(2)
    v_mfma_f32_32x32x16_bf16 v[104:119], v[32:35], v[16:19], v[72:87]
    v_exp_f32 v88, v88
    v_exp_f32 v89, v89
    v_exp_f32 v90, v90
    v_exp_f32 v91, v91
    s_waitcnt lgkmcnt(0)
    v_mfma_f32_32x32x16_bf16 v[120:135], v[44:47], v[52:55], v[120:135]
    v_exp_f32 v92, v92
    v_exp_f32 v93, v93
    v_exp_f32 v94, v94
    v_exp_f32 v95, v95
    v_mfma_f32_16x16x32_bf16 v[60:63], v[56:59], v[52:55], v[60:63]
    v_cvt_pk_bf16_f32 v48, v88, v89
    v_cvt_pk_bf16_f32 v49, v90, v91
    v_cvt_pk_bf16_f32 v50, v92, v93
    v_cvt_pk_bf16_f32 v51, v94, v95
    v_mfma_f32_32x32x16_bf16 v[104:119], v[36:39], v[20:23], v[104:119]
    ds_read_b128 v[32:35], v10 offset:16384
    ds_read_b128 v[36:39], v10 offset:17408
    v_exp_f32 v96, v96
    v_exp_f32 v97, v97
    v_exp_f32 v98, v98
    v_exp_f32 v99, v99
    v_mfma_f32_32x32x16_bf16 v[120:135], v[40:43], v[48:51], v[120:135]
    ds_read_b128 v[44:47], v10 offset:11264
    ds_read_b128 v[40:43], v10 offset:14336
    v_exp_f32 v100, v100
    v_exp_f32 v101, v101
    v_exp_f32 v102, v102
    v_exp_f32 v103, v103
    v_mfma_f32_16x16x32_bf16 v[60:63], v[56:59], v[48:51], v[60:63]
    v_cvt_pk_bf16_f32 v52, v96, v97
    v_cvt_pk_bf16_f32 v53, v98, v99
    v_cvt_pk_bf16_f32 v54, v100, v101
    v_cvt_pk_bf16_f32 v55, v102, v103
    s_waitcnt lgkmcnt(2)
    v_mfma_f32_32x32x16_bf16 v[88:103], v[32:35], v[16:19], v[72:87]
    v_exp_f32 v104, v104
    v_exp_f32 v105, v105
    v_exp_f32 v106, v106
    v_exp_f32 v107, v107
    s_waitcnt lgkmcnt(0)
    v_mfma_f32_32x32x16_bf16 v[120:135], v[44:47], v[52:55], v[120:135]
    v_exp_f32 v108, v108
    v_exp_f32 v109, v109
    v_exp_f32 v110, v110
    v_exp_f32 v111, v111
    v_mfma_f32_16x16x32_bf16 v[60:63], v[56:59], v[52:55], v[60:63]
    v_cvt_pk_bf16_f32 v48, v104, v105
    v_cvt_pk_bf16_f32 v49, v106, v107
    v_cvt_pk_bf16_f32 v50, v108, v109
    v_cvt_pk_bf16_f32 v51, v110, v111
    v_mfma_f32_32x32x16_bf16 v[88:103], v[36:39], v[20:23], v[88:103]
    ds_read_b128 v[32:35], v10 offset:20480
    ds_read_b128 v[36:39], v10 offset:21504
    v_exp_f32 v112, v112
    v_exp_f32 v113, v113
    v_exp_f32 v114, v114
    v_exp_f32 v115, v115
    v_mfma_f32_32x32x16_bf16 v[120:135], v[40:43], v[48:51], v[120:135]
    ds_read_b128 v[44:47], v10 offset:15360
    ds_read_b128 v[40:43], v10 offset:18432
    v_exp_f32 v116, v116
    v_exp_f32 v117, v117
    v_exp_f32 v118, v118
    v_exp_f32 v119, v119
    v_mfma_f32_16x16x32_bf16 v[60:63], v[56:59], v[48:51], v[60:63]
    v_cvt_pk_bf16_f32 v52, v112, v113
    v_cvt_pk_bf16_f32 v53, v114, v115
    v_cvt_pk_bf16_f32 v54, v116, v117
    v_cvt_pk_bf16_f32 v55, v118, v119
    s_waitcnt lgkmcnt(2)
    v_mfma_f32_32x32x16_bf16 v[104:119], v[32:35], v[16:19], v[72:87]
    v_exp_f32 v88, v88
    v_exp_f32 v89, v89
    v_exp_f32 v90, v90
    v_exp_f32 v91, v91
    s_waitcnt lgkmcnt(0)
    v_mfma_f32_32x32x16_bf16 v[120:135], v[44:47], v[52:55], v[120:135]
    v_exp_f32 v92, v92
    v_exp_f32 v93, v93
    v_exp_f32 v94, v94
    v_exp_f32 v95, v95
    v_mfma_f32_16x16x32_bf16 v[60:63], v[56:59], v[52:55], v[60:63]
    v_cvt_pk_bf16_f32 v48, v88, v89
    v_cvt_pk_bf16_f32 v49, v90, v91
    v_cvt_pk_bf16_f32 v50, v92, v93
    v_cvt_pk_bf16_f32 v51, v94, v95
    v_mfma_f32_32x32x16_bf16 v[104:119], v[36:39], v[20:23], v[104:119]
    ds_read_b128 v[32:35], v10 offset:24576
    ds_read_b128 v[36:39], v10 offset:25600
    v_exp_f32 v96, v96
    v_exp_f32 v97, v97
    v_exp_f32 v98, v98
    v_exp_f32 v99, v99
    v_mfma_f32_32x32x16_bf16 v[120:135], v[40:43], v[48:51], v[120:135]
    ds_read_b128 v[44:47], v10 offset:19456
    ds_read_b128 v[40:43], v10 offset:22528
    v_exp_f32 v100, v100
    v_exp_f32 v101, v101
    v_exp_f32 v102, v102
    v_exp_f32 v103, v103
    v_mfma_f32_16x16x32_bf16 v[60:63], v[56:59], v[48:51], v[60:63]
    v_cvt_pk_bf16_f32 v52, v96, v97
    v_cvt_pk_bf16_f32 v53, v98, v99
    v_cvt_pk_bf16_f32 v54, v100, v101
    v_cvt_pk_bf16_f32 v55, v102, v103
    s_waitcnt lgkmcnt(2)
    v_mfma_f32_32x32x16_bf16 v[88:103], v[32:35], v[16:19], v[72:87]
    v_exp_f32 v104, v104
    v_exp_f32 v105, v105
    v_exp_f32 v106, v106
    v_exp_f32 v107, v107
    s_waitcnt lgkmcnt(0)
    v_mfma_f32_32x32x16_bf16 v[120:135], v[44:47], v[52:55], v[120:135]
    v_exp_f32 v108, v108
    v_exp_f32 v109, v109
    v_exp_f32 v110, v110
    v_exp_f32 v111, v111
    v_mfma_f32_16x16x32_bf16 v[60:63], v[56:59], v[52:55], v[60:63]
    v_cvt_pk_bf16_f32 v48, v104, v105
    v_cvt_pk_bf16_f32 v49, v106, v107
    v_cvt_pk_bf16_f32 v50, v108, v109
    v_cvt_pk_bf16_f32 v51, v110, v111
    v_mfma_f32_32x32x16_bf16 v[88:103], v[36:39], v[20:23], v[88:103]
    ds_read_b128 v[32:35], v10 offset:28672
    ds_read_b128 v[36:39], v10 offset:29696
    v_exp_f32 v112, v112
    v_exp_f32 v113, v113
    v_exp_f32 v114, v114
    v_exp_f32 v115, v115
    v_mfma_f32_32x32x16_bf16 v[120:135], v[40:43], v[48:51], v[120:135]
    ds_read_b128 v[44:47], v10 offset:23552
    ds_read_b128 v[40:43], v10 offset:26624
    v_exp_f32 v116, v116
    v_exp_f32 v117, v117
    v_exp_f32 v118, v118
    v_exp_f32 v119, v119
    v_mfma_f32_16x16x32_bf16 v[60:63], v[56:59], v[48:51], v[60:63]
    v_cvt_pk_bf16_f32 v52, v112, v113
    v_cvt_pk_bf16_f32 v53, v114, v115
    v_cvt_pk_bf16_f32 v54, v116, v117
    v_cvt_pk_bf16_f32 v55, v118, v119
    s_waitcnt vmcnt(0)
    s_barrier
    s_waitcnt lgkmcnt(2)
    v_mfma_f32_32x32x16_bf16 v[104:119], v[32:35], v[16:19], v[72:87]
    v_exp_f32 v88, v88
    v_exp_f32 v89, v89
    v_exp_f32 v90, v90
    v_exp_f32 v91, v91
    s_waitcnt lgkmcnt(0)
    v_mfma_f32_16x16x32_bf16 v[164:167], v[196:199], v[152:155], 0
    v_mfma_f32_32x32x16_bf16 v[120:135], v[44:47], v[52:55], v[120:135]
    v_exp_f32 v92, v92
    v_exp_f32 v93, v93
    v_exp_f32 v94, v94
    v_exp_f32 v95, v95
    v_mfma_f32_16x16x32_bf16 v[168:171], v[196:199], v[156:159], 0
    v_mfma_f32_16x16x32_bf16 v[60:63], v[56:59], v[52:55], v[60:63]
    v_cvt_pk_bf16_f32 v48, v88, v89
    v_cvt_pk_bf16_f32 v49, v90, v91
    v_cvt_pk_bf16_f32 v50, v92, v93
    v_cvt_pk_bf16_f32 v51, v94, v95
    v_mfma_f32_32x32x16_bf16 v[104:119], v[36:39], v[20:23], v[104:119]
    ds_read_b128 v[32:35], v10 offset:32768
    ds_read_b128 v[36:39], v10 offset:33792
    v_exp_f32 v96, v96
    v_exp_f32 v97, v97
    v_exp_f32 v98, v98
    v_exp_f32 v99, v99
    v_mfma_f32_32x32x16_bf16 v[120:135], v[40:43], v[48:51], v[120:135]
    ds_read_b128 v[44:47], v10 offset:27648
    ds_read_b128 v[40:43], v10 offset:30720
    v_exp_f32 v100, v100
    v_exp_f32 v101, v101
    v_exp_f32 v102, v102
    v_exp_f32 v103, v103
    v_mfma_f32_16x16x32_bf16 v[60:63], v[56:59], v[48:51], v[60:63]
    ds_read_b128 v[232:235], v28
    ds_read_b128 v[236:239], v28 offset:4096
    ds_read_b128 v[240:243], v30
    ds_read_b128 v[244:247], v29
    ds_read_b128 v[248:251], v29 offset:4096
    ds_read_b128 v[252:255], v31
    v_cvt_pk_bf16_f32 v52, v96, v97
    v_cvt_pk_bf16_f32 v53, v98, v99
    v_cvt_pk_bf16_f32 v54, v100, v101
    v_cvt_pk_bf16_f32 v55, v102, v103
    s_waitcnt lgkmcnt(8)
    v_mfma_f32_32x32x16_bf16 v[88:103], v[32:35], v[16:19], v[72:87]
    v_exp_f32 v104, v104
    v_exp_f32 v105, v105
    v_exp_f32 v106, v106
    v_exp_f32 v107, v107
    s_waitcnt lgkmcnt(0)
    v_max3_f32 v70, |v164|, |v165|, v70
    v_max3_f32 v70, |v166|, |v167|, v70
    v_mfma_f32_32x32x16_bf16 v[120:135], v[44:47], v[52:55], v[120:135]
    ds_read_b128 v[44:47], v10 offset:31744
    v_exp_f32 v108, v108
    v_exp_f32 v109, v109
    v_mfma_f32_32x32x16_bf16 v[200:215], v[232:235], v[240:243], v[200:215]
    v_exp_f32 v110, v110
    v_exp_f32 v111, v111
    v_max3_f32 v70, |v168|, |v169|, v70
    v_max3_f32 v70, |v170|, |v171|, v70
    v_mfma_f32_16x16x32_bf16 v[60:63], v[56:59], v[52:55], v[60:63]
    v_cvt_pk_bf16_f32 v48, v104, v105
    v_cvt_pk_bf16_f32 v49, v106, v107
    v_cvt_pk_bf16_f32 v50, v108, v109
    v_cvt_pk_bf16_f32 v51, v110, v111
    v_mfma_f32_32x32x16_bf16 v[88:103], v[36:39], v[20:23], v[88:103]
    ds_read_b128 v[32:35], v10 offset:36864
    ds_read_b128 v[36:39], v10 offset:37888
    v_exp_f32 v112, v112
    v_exp_f32 v113, v113
    v_mfma_f32_32x32x16_bf16 v[216:231], v[236:239], v[240:243], v[216:231]
    v_exp_f32 v114, v114
    v_exp_f32 v115, v115
    v_mfma_f32_32x32x16_bf16 v[120:135], v[40:43], v[48:51], v[120:135]
    ds_read_b128 v[40:43], v10 offset:34816
    v_exp_f32 v116, v116
    v_exp_f32 v117, v117
    v_mfma_f32_32x32x16_bf16 v[200:215], v[244:247], v[252:255], v[200:215]
    v_exp_f32 v118, v118
    v_exp_f32 v119, v119
    v_mfma_f32_16x16x32_bf16 v[60:63], v[56:59], v[48:51], v[60:63]
    v_cvt_pk_bf16_f32 v52, v112, v113
    v_cvt_pk_bf16_f32 v53, v114, v115
    v_cvt_pk_bf16_f32 v54, v116, v117
    v_cvt_pk_bf16_f32 v55, v118, v119
    v_mfma_f32_32x32x16_bf16 v[216:231], v[248:251], v[252:255], v[216:231]
    s_waitcnt lgkmcnt(3)
    s_nop 0
    v_mfma_f32_32x32x16_bf16 v[120:135], v[44:47], v[52:55], v[120:135]
    v_mfma_f32_16x16x32_bf16 v[60:63], v[56:59], v[52:55], v[60:63]
    s_nop 7
    v_cmp_nlt_f32 vcc, v60, s28
    s_nop 1
    s_cbranch_vccnz L_at6_slow
L_at6_ret:
    s_and_b32 s27, s22, 1
    s_lshr_b32 s25, s22, 1
    s_and_b32 s23, s22, 3
    s_lshl_b32 s23, s23, 13
    s_cmp_ge_u32 s22, 4
    s_cselect_b32 s30, 0, 32768
    s_add_u32 s30, s30, 65536
    s_add_u32 s23, s23, s30
    v_add_u32 v24, s23, v9
    s_lshl_b32 s23, s25, 11
    s_lshl_b32 s30, s27, 13
    s_add_u32 s23, s23, s30
    v_add_u32 v26, s23, v9
    v_add_u32 v25, 98304, v26
    v_add_u32 v26, 65536, v26
    s_mov_b32 s23, 998328238
    v_cmp_nle_f32 vcc, v70, s23
    s_add_u32 s30, s58, 37748736
    v_mov_b32 v4, 0
    s_cmp_lg_u64 vcc, 0
    s_cselect_b32 s23, 1, 0
    v_mov_b32 v3, s23
    s_mov_b64 exec, 1
    buffer_store_byte v3, v4, s[12:15], s30 offen
    s_mov_b64 exec, -1
    s_waitcnt lgkmcnt(2)
    v_mfma_f32_32x32x16_bf16 v[104:119], v[32:35], v[16:19], v[72:87]
    v_exp_f32 v88, v88
    v_exp_f32 v89, v89
    v_exp_f32 v90, v90
    v_exp_f32 v91, v91
    s_waitcnt lgkmcnt(0)
    v_exp_f32 v92, v92
    v_exp_f32 v93, v93
    v_exp_f32 v94, v94
    v_exp_f32 v95, v95
    v_cvt_pk_bf16_f32 v48, v88, v89
    v_cvt_pk_bf16_f32 v49, v90, v91
    v_cvt_pk_bf16_f32 v50, v92, v93
    v_cvt_pk_bf16_f32 v51, v94, v95
    v_mfma_f32_32x32x16_bf16 v[104:119], v[36:39], v[20:23], v[104:119]
    ds_read_b128 v[32:35], v10 offset:40960
    ds_read_b128 v[36:39], v10 offset:41984
    v_exp_f32 v96, v96
    v_exp_f32 v97, v97
    v_exp_f32 v98, v98
    v_exp_f32 v99, v99
    v_mfma_f32_32x32x16_bf16 v[136:151], v[40:43], v[48:51], v[120:135]
    ds_read_b128 v[44:47], v10 offset:35840
    ds_read_b128 v[40:43], v10 offset:38912
    v_exp_f32 v100, v100
    v_exp_f32 v101, v101
    v_exp_f32 v102, v102
    v_exp_f32 v103, v103
    v_mfma_f32_16x16x32_bf16 v[64:67], v[56:59], v[48:51], v[60:63]
    v_cvt_pk_bf16_f32 v52, v96, v97
    v_cvt_pk_bf16_f32 v53, v98, v99
    v_cvt_pk_bf16_f32 v54, v100, v101
    v_cvt_pk_bf16_f32 v55, v102, v103
    s_waitcnt lgkmcnt(2)
    v_mfma_f32_32x32x16_bf16 v[88:103], v[32:35], v[16:19], v[72:87]
    v_exp_f32 v104, v104
    v_exp_f32 v105, v105
    v_exp_f32 v106, v106
    v_exp_f32 v107, v107
    s_waitcnt lgkmcnt(0)
    ds_write_b128 v24, v[200:203] offset:0
    v_mfma_f32_32x32x16_bf16 v[136:151], v[44:47], v[52:55], v[136:151]
    v_exp_f32 v108, v108
    v_exp_f32 v109, v109
    v_exp_f32 v110, v110
    v_exp_f32 v111, v111
    ds_write_b128 v24, v[204:207] offset:1024
    v_mfma_f32_16x16x32_bf16 v[64:67], v[56:59], v[52:55], v[64:67]
    v_cvt_pk_bf16_f32 v48, v104, v105
    v_cvt_pk_bf16_f32 v49, v106, v107
    v_cvt_pk_bf16_f32 v50, v108, v109
    v_cvt_pk_bf16_f32 v51, v110, v111
    v_mfma_f32_32x32x16_bf16 v[88:103], v[36:39], v[20:23], v[88:103]
    ds_write_b128 v24, v[208:211] offset:2048
    ds_read_b128 v[32:35], v10 offset:45056
    ds_read_b128 v[36:39], v10 offset:46080
    v_exp_f32 v112, v112
    v_exp_f32 v113, v113
    v_exp_f32 v114, v114
    v_exp_f32 v115, v115
    v_mfma_f32_32x32x16_bf16 v[136:151], v[40:43], v[48:51], v[136:151]
    ds_read_b128 v[44:47], v10 offset:39936
    ds_read_b128 v[40:43], v10 offset:43008
    v_exp_f32 v116, v116
    v_exp_f32 v117, v117
    v_exp_f32 v118, v118
    v_exp_f32 v119, v119
    v_mfma_f32_16x16x32_bf16 v[64:67], v[56:59], v[48:51], v[64:67]
    v_cvt_pk_bf16_f32 v52, v112, v113
    v_cvt_pk_bf16_f32 v53, v114, v115
    v_cvt_pk_bf16_f32 v54, v116, v117
    v_cvt_pk_bf16_f32 v55, v118, v119
    s_waitcnt lgkmcnt(2)
    v_mfma_f32_32x32x16_bf16 v[104:119], v[32:35], v[16:19], v[72:87]
    v_exp_f32 v88, v88
    v_exp_f32 v89, v89
    v_exp_f32 v90, v90
    v_exp_f32 v91, v91
    s_waitcnt lgkmcnt(0)
    ds_write_b128 v24, v[212:215] offset:3072
    v_mfma_f32_32x32x16_bf16 v[136:151], v[44:47], v[52:55], v[136:151]
    v_exp_f32 v92, v92
    v_exp_f32 v93, v93
    v_exp_f32 v94, v94
    v_exp_f32 v95, v95
    ds_write_b128 v24, v[216:219] offset:4096
    v_mfma_f32_16x16x32_bf16 v[64:67], v[56:59], v[52:55], v[64:67]
    v_cvt_pk_bf16_f32 v48, v88, v89
    v_cvt_pk_bf16_f32 v49, v90, v91
    v_cvt_pk_bf16_f32 v50, v92, v93
    v_cvt_pk_bf16_f32 v51, v94, v95
    v_mfma_f32_32x32x16_bf16 v[104:119], v[36:39], v[20:23], v[104:119]
    ds_write_b128 v24, v[220:223] offset:5120
    ds_read_b128 v[32:35], v10 offset:49152
    ds_read_b128 v[36:39], v10 offset:50176
    v_exp_f32 v96, v96
    v_exp_f32 v97, v97
    v_exp_f32 v98, v98
    v_exp_f32 v99, v99
    v_mfma_f32_32x32x16_bf16 v[136:151], v[40:43], v[48:51], v[136:151]
    ds_read_b128 v[44:47], v10 offset:44032
    ds_read_b128 v[40:43], v10 offset:47104
    v_exp_f32 v100, v100
    v_exp_f32 v101, v101
    v_exp_f32 v102, v102
    v_exp_f32 v103, v103
    v_mfma_f32_16x16x32_bf16 v[64:67], v[56:59], v[48:51], v[64:67]
    v_cvt_pk_bf16_f32 v52, v96, v97
    v_cvt_pk_bf16_f32 v53, v98, v99
    v_cvt_pk_bf16_f32 v54, v100, v101
    v_cvt_pk_bf16_f32 v55, v102, v103
    s_waitcnt lgkmcnt(2)
    v_mfma_f32_32x32x16_bf16 v[88:103], v[32:35], v[16:19], v[72:87]
    v_exp_f32 v104, v104
    v_exp_f32 v105, v105
    v_exp_f32 v106, v106
    v_exp_f32 v107, v107
    s_waitcnt lgkmcnt(0)
    ds_write_b128 v24, v[224:227] offset:6144
    v_mfma_f32_32x32x16_bf16 v[136:151], v[44:47], v[52:55], v[136:151]
    v_exp_f32 v108, v108
    v_exp_f32 v109, v109
    v_exp_f32 v110, v110
    v_exp_f32 v111, v111
    ds_write_b128 v24, v[228:231] offset:7168
    v_mfma_f32_16x16x32_bf16 v[64:67], v[56:59], v[52:55], v[64:67]
    v_cvt_pk_bf16_f32 v48, v104, v105
    v_cvt_pk_bf16_f32 v49, v106, v107
    v_cvt_pk_bf16_f32 v50, v108, v109
    v_cvt_pk_bf16_f32 v51, v110, v111
    v_mfma_f32_32x32x16_bf16 v[88:103], v[36:39], v[20:23], v[88:103]
    ds_read_b128 v[32:35], v10 offset:53248
    ds_read_b128 v[36:39], v10 offset:54272
    v_exp_f32 v112, v112
    v_exp_f32 v113, v113
    v_exp_f32 v114, v114
    v_exp_f32 v115, v115
    v_mfma_f32_32x32x16_bf16 v[136:151], v[40:43], v[48:51], v[136:151]
    ds_read_b128 v[44:47], v10 offset:48128
    ds_read_b128 v[40:43], v10 offset:51200
    v_exp_f32 v116, v116
    v_exp_f32 v117, v117
    v_exp_f32 v118, v118
    v_exp_f32 v119, v119
    v_mfma_f32_16x16x32_bf16 v[64:67], v[56:59], v[48:51], v[64:67]
    v_cvt_pk_bf16_f32 v52, v112, v113
    v_cvt_pk_bf16_f32 v53, v114, v115
    v_cvt_pk_bf16_f32 v54, v116, v117
    v_cvt_pk_bf16_f32 v55, v118, v119
    s_waitcnt lgkmcnt(2)
    v_mfma_f32_32x32x16_bf16 v[104:119], v[32:35], v[16:19], v[72:87]
    v_exp_f32 v88, v88
    v_exp_f32 v89, v89
    v_exp_f32 v90, v90
    v_exp_f32 v91, v91
    s_waitcnt lgkmcnt(0)
    v_mfma_f32_32x32x16_bf16 v[136:151], v[44:47], v[52:55], v[136:151]
    v_exp_f32 v92, v92
    v_exp_f32 v93, v93
    v_exp_f32 v94, v94
    v_exp_f32 v95, v95
    v_mfma_f32_16x16x32_bf16 v[64:67], v[56:59], v[52:55], v[64:67]
    v_cvt_pk_bf16_f32 v48, v88, v89
    v_cvt_pk_bf16_f32 v49, v90, v91
    v_cvt_pk_bf16_f32 v50, v92, v93
    v_cvt_pk_bf16_f32 v51, v94, v95
    v_mfma_f32_32x32x16_bf16 v[104:119], v[36:39], v[20:23], v[104:119]
    ds_read_b128 v[32:35], v10 offset:57344
    ds_read_b128 v[36:39], v10 offset:58368
    v_exp_f32 v96, v96
    v_exp_f32 v97, v97
    v_exp_f32 v98, v98
    v_exp_f32 v99, v99
    v_mfma_f32_32x32x16_bf16 v[136:151], v[40:43], v[48:51], v[136:151]
    ds_read_b128 v[44:47], v10 offset:52224
    ds_read_b128 v[40:43], v10 offset:55296
    v_exp_f32 v100, v100
    v_exp_f32 v101, v101
    v_exp_f32 v102, v102
    v_exp_f32 v103, v103
    v_mfma_f32_16x16x32_bf16 v[64:67], v[56:59], v[48:51], v[64:67]
    v_cvt_pk_bf16_f32 v52, v96, v97
    v_cvt_pk_bf16_f32 v53, v98, v99
    v_cvt_pk_bf16_f32 v54, v100, v101
    v_cvt_pk_bf16_f32 v55, v102, v103
    s_waitcnt lgkmcnt(2)
    v_mfma_f32_32x32x16_bf16 v[88:103], v[32:35], v[16:19], v[72:87]
    v_exp_f32 v104, v104
    v_exp_f32 v105, v105
    v_exp_f32 v106, v106
    v_exp_f32 v107, v107
    s_waitcnt lgkmcnt(0)
    v_mfma_f32_32x32x16_bf16 v[136:151], v[44:47], v[52:55], v[136:151]
    v_exp_f32 v108, v108
    v_exp_f32 v109, v109
    v_exp_f32 v110, v110
    v_exp_f32 v111, v111
    v_mfma_f32_16x16x32_bf16 v[64:67], v[56:59], v[52:55], v[64:67]
    v_cvt_pk_bf16_f32 v48, v104, v105
    v_cvt_pk_bf16_f32 v49, v106, v107
    v_cvt_pk_bf16_f32 v50, v108, v109
    v_cvt_pk_bf16_f32 v51, v110, v111
    v_mfma_f32_32x32x16_bf16 v[88:103], v[36:39], v[20:23], v[88:103]
    ds_read_b128 v[32:35], v10 offset:61440
    ds_read_b128 v[36:39], v10 offset:62464
    v_exp_f32 v112, v112
    v_exp_f32 v113, v113
    v_exp_f32 v114, v114
    v_exp_f32 v115, v115
    v_mfma_f32_32x32x16_bf16 v[136:151], v[40:43], v[48:51], v[136:151]
    ds_read_b128 v[44:47], v10 offset:56320
    ds_read_b128 v[40:43], v10 offset:59392
    v_exp_f32 v116, v116
    v_exp_f32 v117, v117
    v_exp_f32 v118, v118
    v_exp_f32 v119, v119
    v_mfma_f32_16x16x32_bf16 v[64:67], v[56:59], v[48:51], v[64:67]
    v_cvt_pk_bf16_f32 v52, v112, v113
    v_cvt_pk_bf16_f32 v53, v114, v115
    v_cvt_pk_bf16_f32 v54, v116, v117
    v_cvt_pk_bf16_f32 v55, v118, v119
    s_waitcnt vmcnt(0) lgkmcnt(0)
    s_barrier
    s_waitcnt lgkmcnt(2)
    v_mfma_f32_32x32x16_bf16 v[104:119], v[32:35], v[16:19], v[72:87]
    v_exp_f32 v88, v88
    v_exp_f32 v89, v89
    v_exp_f32 v90, v90
    v_exp_f32 v91, v91
    s_waitcnt lgkmcnt(0)
    v_mfma_f32_32x32x16_bf16 v[136:151], v[44:47], v[52:55], v[136:151]
    v_exp_f32 v92, v92
    v_exp_f32 v93, v93
    v_exp_f32 v94, v94
    v_exp_f32 v95, v95
    v_mfma_f32_16x16x32_bf16 v[64:67], v[56:59], v[52:55], v[64:67]
    v_cvt_pk_bf16_f32 v48, v88, v89
    v_cvt_pk_bf16_f32 v49, v90, v91
    v_cvt_pk_bf16_f32 v50, v92, v93
    v_cvt_pk_bf16_f32 v51, v94, v95
    v_mfma_f32_32x32x16_bf16 v[104:119], v[36:39], v[20:23], v[104:119]
    ds_read_b128 v[32:35], v10 offset:61440
    ds_read_b128 v[36:39], v10 offset:62464
    v_exp_f32 v96, v96
    v_exp_f32 v97, v97
    v_exp_f32 v98, v98
    v_exp_f32 v99, v99
    v_mfma_f32_32x32x16_bf16 v[136:151], v[40:43], v[48:51], v[136:151]
    ds_read_b128 v[44:47], v10 offset:60416
    ds_read_b128 v[40:43], v10 offset:63488
    v_exp_f32 v100, v100
    v_exp_f32 v101, v101
    v_exp_f32 v102, v102
    v_exp_f32 v103, v103
    v_mfma_f32_16x16x32_bf16 v[64:67], v[56:59], v[48:51], v[64:67]
    ds_read_b128 v[200:203], v25 offset:0
    ds_read_b128 v[204:207], v25 offset:1024
    ds_read_b128 v[208:211], v25 offset:16384
    ds_read_b128 v[212:215], v25 offset:17408
    ds_read_b128 v[216:219], v26 offset:0
    ds_read_b128 v[220:223], v26 offset:1024
    ds_read_b128 v[224:227], v26 offset:16384
    ds_read_b128 v[228:231], v26 offset:17408
    v_cvt_pk_bf16_f32 v52, v96, v97
    v_cvt_pk_bf16_f32 v53, v98, v99
    v_cvt_pk_bf16_f32 v54, v100, v101
    v_cvt_pk_bf16_f32 v55, v102, v103
    s_waitcnt lgkmcnt(10)
    v_mfma_f32_32x32x16_bf16 v[88:103], v[32:35], v[16:19], v[72:87]
    v_exp_f32 v104, v104
    v_exp_f32 v105, v105
    v_exp_f32 v106, v106
    v_exp_f32 v107, v107
    s_waitcnt lgkmcnt(0)
    v_mfma_f32_32x32x16_bf16 v[136:151], v[44:47], v[52:55], v[136:151]
    ds_read_b128 v[44:47], v10 offset:64512
    v_exp_f32 v108, v108
    v_exp_f32 v109, v109
    v_exp_f32 v110, v110
    v_exp_f32 v111, v111
    v_mfma_f32_16x16x32_bf16 v[64:67], v[56:59], v[52:55], v[64:67]
    v_cvt_pk_bf16_f32 v48, v104, v105
    v_cvt_pk_bf16_f32 v49, v106, v107
    v_cvt_pk_bf16_f32 v50, v108, v109
    v_cvt_pk_bf16_f32 v51, v110, v111
    v_mfma_f32_32x32x16_bf16 v[88:103], v[36:39], v[20:23], v[88:103]
    ds_read_b128 v[32:35], v10 offset:61440
    ds_read_b128 v[36:39], v10 offset:62464
    v_exp_f32 v112, v112
    v_exp_f32 v113, v113
    v_exp_f32 v114, v114
    v_exp_f32 v115, v115
    v_mfma_f32_32x32x16_bf16 v[136:151], v[40:43], v[48:51], v[136:151]
    ds_read_b128 v[40:43], v10 offset:63488
    v_exp_f32 v116, v116
    v_exp_f32 v117, v117
    v_exp_f32 v118, v118
    v_exp_f32 v119, v119
    v_mfma_f32_16x16x32_bf16 v[64:67], v[56:59], v[48:51], v[64:67]
    v_cvt_pk_bf16_f32 v52, v112, v113
    v_cvt_pk_bf16_f32 v53, v114, v115
    v_cvt_pk_bf16_f32 v54, v116, v117
    v_cvt_pk_bf16_f32 v55, v118, v119
    s_waitcnt lgkmcnt(3)
    s_nop 0
    v_mfma_f32_32x32x16_bf16 v[136:151], v[44:47], v[52:55], v[136:151]
    v_mfma_f32_16x16x32_bf16 v[64:67], v[56:59], v[52:55], v[64:67]
    s_nop 7
    v_cmp_nlt_f32 vcc, v64, s28
    s_nop 1
    s_cbranch_vccnz L_at7_slow
L_at7_ret:
    s_nop 3
    v_rcp_f32 v7, v64
    s_add_u32 s31, s26, 16777216
    v_mul_f32 v136, v7, v136
    v_mul_f32 v137, v7, v137
    v_mul_f32 v138, v7, v138
    v_mul_f32 v139, v7, v139
    v_mul_f32 v140, v7, v140
    v_mul_f32 v141, v7, v141
    v_mul_f32 v142, v7, v142
    v_mul_f32 v143, v7, v143
    v_mul_f32 v144, v7, v144
    v_mul_f32 v145, v7, v145
    v_mul_f32 v146, v7, v146
    v_mul_f32 v147, v7, v147
    v_mul_f32 v148, v7, v148
    v_mul_f32 v149, v7, v149
    v_mul_f32 v150, v7, v150
    v_mul_f32 v151, v7, v151
    v_cvt_pk_bf16_f32 v48, v136, v137
    v_cvt_pk_bf16_f32 v49, v138, v139
    v_cvt_pk_bf16_f32 v50, v140, v141
    v_cvt_pk_bf16_f32 v51, v142, v143
    v_cvt_pk_bf16_f32 v52, v144, v145
    v_cvt_pk_bf16_f32 v53, v146, v147
    v_cvt_pk_bf16_f32 v54, v148, v149
    v_cvt_pk_bf16_f32 v55, v150, v151
    s_nop 1
    v_permlane32_swap_b32 v48, v50
    v_permlane32_swap_b32 v49, v51
    v_permlane32_swap_b32 v52, v54
    v_permlane32_swap_b32 v53, v55
    buffer_store_dwordx4 v[48:51], v8, s[12:15], s31 offen offset:0
    buffer_store_dwordx4 v[52:55], v8, s[12:15], s31 offen offset:32
    v_add_f32 v200, v200, v208
    v_add_f32 v216, v216, v224
    v_add_f32 v201, v201, v209
    v_add_f32 v217, v217, v225
    v_add_f32 v202, v202, v210
    v_add_f32 v218, v218, v226
    v_add_f32 v203, v203, v211
    v_add_f32 v219, v219, v227
    v_add_f32 v204, v204, v212
    v_add_f32 v220, v220, v228
    v_add_f32 v205, v205, v213
    v_add_f32 v221, v221, v229
    v_add_f32 v206, v206, v214
    v_add_f32 v222, v222, v230
    v_add_f32 v207, v207, v215
    v_add_f32 v223, v223, v231
    v_add_f32 v200, v200, v216
    v_add_f32 v201, v201, v217
    v_add_f32 v202, v202, v218
    v_add_f32 v203, v203, v219
    v_add_f32 v204, v204, v220
    v_add_f32 v205, v205, v221
    v_add_f32 v206, v206, v222
    v_add_f32 v207, v207, v223
    v_cvt_pk_bf16_f32 v16, v200, v201
    v_cvt_pk_bf16_f32 v17, v202, v203
    v_cvt_pk_bf16_f32 v18, v204, v205
    v_cvt_pk_bf16_f32 v19, v206, v207
    s_nop 1
    v_permlane32_swap_b32 v16, v18
    v_permlane32_swap_b32 v17, v19
    v_and_b32 v3, 31, v2
    s_lshl_b32 s23, s27, 5
    v_add_u32 v3, s23, v3
    s_mov_b32 s23, 2176
    v_mul_lo_u32 v3, v3, s23
    v_lshrrev_b32 v4, 5, v2
    v_lshl_add_u32 v3, v4, 4, v3
    s_lshl_b32 s23, s25, 5
    s_add_u32 s23, s23, s21
    buffer_store_dwordx4 v[16:19], v3, s[12:15], s23 offen
    s_branch L_k2_end
L_at0_slow:
    s_nop 15
    v_cmp_nlt_f32 vcc, v60, s29
    s_nop 4
    s_cbranch_vccnz L_at0_heavy
    v_frexp_exp_i32_f32 v3, v60
    v_add_u32 v3, 100, v3
    v_cvt_f32_i32 v4, v3
    v_sub_u32 v3, 0, v3
    v_ldexp_f32 v120, v120, v3
    v_ldexp_f32 v121, v121, v3
    v_ldexp_f32 v122, v122, v3
    v_ldexp_f32 v123, v123, v3
    v_ldexp_f32 v124, v124, v3
    v_ldexp_f32 v125, v125, v3
    v_ldexp_f32 v126, v126, v3
    v_ldexp_f32 v127, v127, v3
    v_ldexp_f32 v128, v128, v3
    v_ldexp_f32 v129, v129, v3
    v_ldexp_f32 v130, v130, v3
    v_ldexp_f32 v131, v131, v3
    v_ldexp_f32 v132, v132, v3
    v_ldexp_f32 v133, v133, v3
    v_ldexp_f32 v134, v134, v3
    v_ldexp_f32 v135, v135, v3
    v_ldexp_f32 v60, v60, v3
    v_ldexp_f32 v61, v61, v3
    v_ldexp_f32 v62, v62, v3
    v_ldexp_f32 v63, v63, v3
    v_sub_f32 v72, v72, v4
    v_sub_f32 v73, v73, v4
    v_sub_f32 v74, v74, v4
    v_sub_f32 v75, v75, v4
    v_sub_f32 v76, v76, v4
    v_sub_f32 v77, v77, v4
    v_sub_f32 v78, v78, v4
    v_sub_f32 v79, v79, v4
    v_sub_f32 v80, v80, v4
    v_sub_f32 v81, v81, v4
    v_sub_f32 v82, v82, v4
    v_sub_f32 v83, v83, v4
    v_sub_f32 v84, v84, v4
    v_sub_f32 v85, v85, v4
    v_sub_f32 v86, v86, v4
    v_sub_f32 v87, v87, v4
    v_sub_f32 v88, v88, v4
    v_sub_f32 v89, v89, v4
    v_sub_f32 v90, v90, v4
    v_sub_f32 v91, v91, v4
    v_sub_f32 v92, v92, v4
    v_sub_f32 v93, v93, v4
    v_sub_f32 v94, v94, v4
    v_sub_f32 v95, v95, v4
    v_sub_f32 v96, v96, v4
    v_sub_f32 v97, v97, v4
    v_sub_f32 v98, v98, v4
    v_sub_f32 v99, v99, v4
    v_sub_f32 v100, v100, v4
    v_sub_f32 v101, v101, v4
    v_sub_f32 v102, v102, v4
    v_sub_f32 v103, v103, v4
    s_nop 1
    s_branch L_at0_ret
L_at0_heavy:
    s_waitcnt vmcnt(0)
    v_mfma_f32_16x16x32_bf16 v[164:167], v[192:195], v[152:155], 0
    v_mfma_f32_16x16x32_bf16 v[168:171], v[192:195], v[156:159], 0
    v_mfma_f32_16x16x32_bf16 v[172:175], v[192:195], v[160:163], 0
    s_nop 15
    v_max3_f32 v70, |v164|, |v165|, v70
    v_max3_f32 v70, |v166|, |v167|, v70
    v_max3_f32 v70, |v168|, |v169|, v70
    v_max3_f32 v70, |v170|, |v171|, v70
    v_max3_f32 v70, |v172|, |v173|, v70
    v_max3_f32 v70, |v174|, |v175|, v70
    s_waitcnt lgkmcnt(0)
    v_log_f32 v5, v64
    v_add_u32 v6, 0, v10
    s_mov_b32 s30, 0
L_at0_h1:
    ds_read_b128 v[168:171], v6
    ds_read_b128 v[172:175], v6 offset:1024
    s_waitcnt lgkmcnt(0)
    v_mfma_f32_32x32x16_bf16 v[152:167], v[168:171], v[16:19], v[72:87]
    v_mfma_f32_32x32x16_bf16 v[152:167], v[172:175], v[20:23], v[152:167]
    s_nop 15
    v_max3_f32 v5, v152, v153, v5
    v_max3_f32 v5, v154, v155, v5
    v_max3_f32 v5, v156, v157, v5
    v_max3_f32 v5, v158, v159, v5
    v_max3_f32 v5, v160, v161, v5
    v_max3_f32 v5, v162, v163, v5
    v_max3_f32 v5, v164, v165, v5
    v_max3_f32 v5, v166, v167, v5
    v_add_u32 v6, 4096, v6
    s_add_u32 s30, s30, 1
    s_cmp_lt_u32 s30, 8
    s_cbranch_scc1 L_at0_h1
    v_mov_b32 v6, v5
    s_nop 1
    v_permlane32_swap_b32 v5, v6
    s_nop 1
    v_max_f32 v5, v5, v6
    v_ceil_f32 v4, v5
    v_add_f32 v4, 1120403456, v4
    v_cvt_i32_f32 v3, v4
    v_sub_u32 v3, 0, v3
    v_ldexp_f32 v120, v136, v3
    v_ldexp_f32 v121, v137, v3
    v_ldexp_f32 v122, v138, v3
    v_ldexp_f32 v123, v139, v3
    v_ldexp_f32 v124, v140, v3
    v_ldexp_f32 v125, v141, v3
    v_ldexp_f32 v126, v142, v3
    v_ldexp_f32 v127, v143, v3
    v_ldexp_f32 v128, v144, v3
    v_ldexp_f32 v129, v145, v3
    v_ldexp_f32 v130, v146, v3
    v_ldexp_f32 v131, v147, v3
    v_ldexp_f32 v132, v148, v3
    v_ldexp_f32 v133, v149, v3
    v_ldexp_f32 v134, v150, v3
    v_ldexp_f32 v135, v151, v3
    v_ldexp_f32 v60, v64, v3
    v_ldexp_f32 v61, v65, v3
    v_ldexp_f32 v62, v66, v3
    v_ldexp_f32 v63, v67, v3
    v_sub_f32 v72, v72, v4
    v_sub_f32 v73, v73, v4
    v_sub_f32 v74, v74, v4
    v_sub_f32 v75, v75, v4
    v_sub_f32 v76, v76, v4
    v_sub_f32 v77, v77, v4
    v_sub_f32 v78, v78, v4
    v_sub_f32 v79, v79, v4
    v_sub_f32 v80, v80, v4
    v_sub_f32 v81, v81, v4
    v_sub_f32 v82, v82, v4
    v_sub_f32 v83, v83, v4
    v_sub_f32 v84, v84, v4
    v_sub_f32 v85, v85, v4
    v_sub_f32 v86, v86, v4
    v_sub_f32 v87, v87, v4
    v_sub_f32 v88, v88, v4
    v_sub_f32 v89, v89, v4
    v_sub_f32 v90, v90, v4
    v_sub_f32 v91, v91, v4
    v_sub_f32 v92, v92, v4
    v_sub_f32 v93, v93, v4
    v_sub_f32 v94, v94, v4
    v_sub_f32 v95, v95, v4
    v_sub_f32 v96, v96, v4
    v_sub_f32 v97, v97, v4
    v_sub_f32 v98, v98, v4
    v_sub_f32 v99, v99, v4
    v_sub_f32 v100, v100, v4
    v_sub_f32 v101, v101, v4
    v_sub_f32 v102, v102, v4
    v_sub_f32 v103, v103, v4
    v_add_u32 v6, 0, v10
    s_mov_b32 s30, 0
L_at0_h2:
    ds_read_b128 v[168:171], v6
    ds_read_b128 v[172:175], v6 offset:1024
    ds_read_b128 v[176:179], v6 offset:2048
    ds_read_b128 v[180:183], v6 offset:3072
    s_waitcnt lgkmcnt(0)
    v_mfma_f32_32x32x16_bf16 v[152:167], v[168:171], v[16:19], v[72:87]
    v_mfma_f32_32x32x16_bf16 v[152:167], v[172:175], v[20:23], v[152:167]
    s_nop 15
    v_exp_f32 v152, v152
    v_exp_f32 v153, v153
    v_exp_f32 v154, v154
    v_exp_f32 v155, v155
    v_exp_f32 v156, v156
    v_exp_f32 v157, v157
    v_exp_f32 v158, v158
    v_exp_f32 v159, v159
    v_exp_f32 v160, v160
    v_exp_f32 v161, v161
    v_exp_f32 v162, v162
    v_exp_f32 v163, v163
    v_exp_f32 v164, v164
    v_exp_f32 v165, v165
    v_exp_f32 v166, v166
    v_exp_f32 v167, v167
    s_nop 0
    v_cvt_pk_bf16_f32 v184, v152, v153
    v_cvt_pk_bf16_f32 v185, v154, v155
    v_cvt_pk_bf16_f32 v186, v156, v157
    v_cvt_pk_bf16_f32 v187, v158, v159
    v_cvt_pk_bf16_f32 v188, v160, v161
    v_cvt_pk_bf16_f32 v189, v162, v163
    v_cvt_pk_bf16_f32 v190, v164, v165
    v_cvt_pk_bf16_f32 v191, v166, v167
    s_nop 1
    v_mfma_f32_32x32x16_bf16 v[120:135], v[176:179], v[184:187], v[120:135]
    v_mfma_f32_32x32x16_bf16 v[120:135], v[180:183], v[188:191], v[120:135]
    v_mfma_f32_16x16x32_bf16 v[60:63], v[56:59], v[184:187], v[60:63]
    v_mfma_f32_16x16x32_bf16 v[60:63], v[56:59], v[188:191], v[60:63]
    v_add_u32 v6, 4096, v6
    s_add_u32 s30, s30, 1
    s_cmp_lt_u32 s30, 8
    s_cbranch_scc1 L_at0_h2
    s_nop 7
    v_mov_b32 v152, 0
    v_mov_b32 v153, 0
    v_mov_b32 v154, 0
    v_mov_b32 v155, 0
    v_mov_b32 v156, 0
    v_mov_b32 v157, 0
    v_mov_b32 v158, 0
    v_mov_b32 v159, 0
    v_mov_b32 v160, 0
    v_mov_b32 v161, 0
    v_mov_b32 v162, 0
    v_mov_b32 v163, 0
    s_branch L_at0_ret
L_at1_slow:
    s_nop 15
    v_cmp_nlt_f32 vcc, v64, s29
    s_nop 4
    s_cbranch_vccnz L_at1_heavy
    v_frexp_exp_i32_f32 v3, v64
    v_add_u32 v3, 100, v3
    v_cvt_f32_i32 v4, v3
    v_sub_u32 v3, 0, v3
    v_ldexp_f32 v136, v136, v3
    v_ldexp_f32 v137, v137, v3
    v_ldexp_f32 v138, v138, v3
    v_ldexp_f32 v139, v139, v3
    v_ldexp_f32 v140, v140, v3
    v_ldexp_f32 v141, v141, v3
    v_ldexp_f32 v142, v142, v3
    v_ldexp_f32 v143, v143, v3
    v_ldexp_f32 v144, v144, v3
    v_ldexp_f32 v145, v145, v3
    v_ldexp_f32 v146, v146, v3
    v_ldexp_f32 v147, v147, v3
    v_ldexp_f32 v148, v148, v3
    v_ldexp_f32 v149, v149, v3
    v_ldexp_f32 v150, v150, v3
    v_ldexp_f32 v151, v151, v3
    v_ldexp_f32 v64, v64, v3
    v_ldexp_f32 v65, v65, v3
    v_ldexp_f32 v66, v66, v3
    v_ldexp_f32 v67, v67, v3
    v_sub_f32 v72, v72, v4
    v_sub_f32 v73, v73, v4
    v_sub_f32 v74, v74, v4
    v_sub_f32 v75, v75, v4
    v_sub_f32 v76, v76, v4
    v_sub_f32 v77, v77, v4
    v_sub_f32 v78, v78, v4
    v_sub_f32 v79, v79, v4
    v_sub_f32 v80, v80, v4
    v_sub_f32 v81, v81, v4
    v_sub_f32 v82, v82, v4
    v_sub_f32 v83, v83, v4
    v_sub_f32 v84, v84, v4
    v_sub_f32 v85, v85, v4
    v_sub_f32 v86, v86, v4
    v_sub_f32 v87, v87, v4
    v_sub_f32 v88, v88, v4
    v_sub_f32 v89, v89, v4
    v_sub_f32 v90, v90, v4
    v_sub_f32 v91, v91, v4
    v_sub_f32 v92, v92, v4
    v_sub_f32 v93, v93, v4
    v_sub_f32 v94, v94, v4
    v_sub_f32 v95, v95, v4
    v_sub_f32 v96, v96, v4
    v_sub_f32 v97, v97, v4
    v_sub_f32 v98, v98, v4
    v_sub_f32 v99, v99, v4
    v_sub_f32 v100, v100, v4
    v_sub_f32 v101, v101, v4
    v_sub_f32 v102, v102, v4
    v_sub_f32 v103, v103, v4
    s_nop 1
    s_branch L_at1_ret
L_at1_heavy:
    s_waitcnt vmcnt(0)
    v_mfma_f32_16x16x32_bf16 v[164:167], v[192:195], v[152:155], 0
    v_mfma_f32_16x16x32_bf16 v[168:171], v[192:195], v[156:159], 0
    s_nop 15
    v_max3_f32 v70, |v164|, |v165|, v70
    v_max3_f32 v70, |v166|, |v167|, v70
    v_max3_f32 v70, |v168|, |v169|, v70
    v_max3_f32 v70, |v170|, |v171|, v70
    s_waitcnt lgkmcnt(0)
    v_log_f32 v5, v60
    v_add_u32 v6, 32768, v10
    s_mov_b32 s30, 0
L_at1_h1:
    ds_read_b128 v[168:171], v6
    ds_read_b128 v[172:175], v6 offset:1024
    s_waitcnt lgkmcnt(0)
    v_mfma_f32_32x32x16_bf16 v[152:167], v[168:171], v[16:19], v[72:87]
    v_mfma_f32_32x32x16_bf16 v[152:167], v[172:175], v[20:23], v[152:167]
    s_nop 15
    v_max3_f32 v5, v152, v153, v5
    v_max3_f32 v5, v154, v155, v5
    v_max3_f32 v5, v156, v157, v5
    v_max3_f32 v5, v158, v159, v5
    v_max3_f32 v5, v160, v161, v5
    v_max3_f32 v5, v162, v163, v5
    v_max3_f32 v5, v164, v165, v5
    v_max3_f32 v5, v166, v167, v5
    v_add_u32 v6, 4096, v6
    s_add_u32 s30, s30, 1
    s_cmp_lt_u32 s30, 8
    s_cbranch_scc1 L_at1_h1
    v_mov_b32 v6, v5
    s_nop 1
    v_permlane32_swap_b32 v5, v6
    s_nop 1
    v_max_f32 v5, v5, v6
    v_ceil_f32 v4, v5
    v_add_f32 v4, 1120403456, v4
    v_cvt_i32_f32 v3, v4
    v_sub_u32 v3, 0, v3
    v_ldexp_f32 v136, v120, v3
    v_ldexp_f32 v137, v121, v3
    v_ldexp_f32 v138, v122, v3
    v_ldexp_f32 v139, v123, v3
    v_ldexp_f32 v140, v124, v3
    v_ldexp_f32 v141, v125, v3
    v_ldexp_f32 v142, v126, v3
    v_ldexp_f32 v143, v127, v3
    v_ldexp_f32 v144, v128, v3
    v_ldexp_f32 v145, v129, v3
    v_ldexp_f32 v146, v130, v3
    v_ldexp_f32 v147, v131, v3
    v_ldexp_f32 v148, v132, v3
    v_ldexp_f32 v149, v133, v3
    v_ldexp_f32 v150, v134, v3
    v_ldexp_f32 v151, v135, v3
    v_ldexp_f32 v64, v60, v3
    v_ldexp_f32 v65, v61, v3
    v_ldexp_f32 v66, v62, v3
    v_ldexp_f32 v67, v63, v3
    v_sub_f32 v72, v72, v4
    v_sub_f32 v73, v73, v4
    v_sub_f32 v74, v74, v4
    v_sub_f32 v75, v75, v4
    v_sub_f32 v76, v76, v4
    v_sub_f32 v77, v77, v4
    v_sub_f32 v78, v78, v4
    v_sub_f32 v79, v79, v4
    v_sub_f32 v80, v80, v4
    v_sub_f32 v81, v81, v4
    v_sub_f32 v82, v82, v4
    v_sub_f32 v83, v83, v4
    v_sub_f32 v84, v84, v4
    v_sub_f32 v85, v85, v4
    v_sub_f32 v86, v86, v4
    v_sub_f32 v87, v87, v4
    v_sub_f32 v88, v88, v4
    v_sub_f32 v89, v89, v4
    v_sub_f32 v90, v90, v4
    v_sub_f32 v91, v91, v4
    v_sub_f32 v92, v92, v4
    v_sub_f32 v93, v93, v4
    v_sub_f32 v94, v94, v4
    v_sub_f32 v95, v95, v4
    v_sub_f32 v96, v96, v4
    v_sub_f32 v97, v97, v4
    v_sub_f32 v98, v98, v4
    v_sub_f32 v99, v99, v4
    v_sub_f32 v100, v100, v4
    v_sub_f32 v101, v101, v4
    v_sub_f32 v102, v102, v4
    v_sub_f32 v103, v103, v4
    v_add_u32 v6, 32768, v10
    s_mov_b32 s30, 0
L_at1_h2:
    ds_read_b128 v[168:171], v6
    ds_read_b128 v[172:175], v6 offset:1024
    ds_read_b128 v[176:179], v6 offset:2048
    ds_read_b128 v[180:183], v6 offset:3072
    s_waitcnt lgkmcnt(0)
    v_mfma_f32_32x32x16_bf16 v[152:167], v[168:171], v[16:19], v[72:87]
    v_mfma_f32_32x32x16_bf16 v[152:167], v[172:175], v[20:23], v[152:167]
    s_nop 15
    v_exp_f32 v152, v152
    v_exp_f32 v153, v153
    v_exp_f32 v154, v154
    v_exp_f32 v155, v155
    v_exp_f32 v156, v156
    v_exp_f32 v157, v157
    v_exp_f32 v158, v158
    v_exp_f32 v159, v159
    v_exp_f32 v160, v160
    v_exp_f32 v161, v161
    v_exp_f32 v162, v162
    v_exp_f32 v163, v163
    v_exp_f32 v164, v164
    v_exp_f32 v165, v165
    v_exp_f32 v166, v166
    v_exp_f32 v167, v167
    s_nop 0
    v_cvt_pk_bf16_f32 v184, v152, v153
    v_cvt_pk_bf16_f32 v185, v154, v155
    v_cvt_pk_bf16_f32 v186, v156, v157
    v_cvt_pk_bf16_f32 v187, v158, v159
    v_cvt_pk_bf16_f32 v188, v160, v161
    v_cvt_pk_bf16_f32 v189, v162, v163
    v_cvt_pk_bf16_f32 v190, v164, v165
    v_cvt_pk_bf16_f32 v191, v166, v167
    s_nop 1
    v_mfma_f32_32x32x16_bf16 v[136:151], v[176:179], v[184:187], v[136:151]
    v_mfma_f32_32x32x16_bf16 v[136:151], v[180:183], v[188:191], v[136:151]
    v_mfma_f32_16x16x32_bf16 v[64:67], v[56:59], v[184:187], v[64:67]
    v_mfma_f32_16x16x32_bf16 v[64:67], v[56:59], v[188:191], v[64:67]
    v_add_u32 v6, 4096, v6
    s_add_u32 s30, s30, 1
    s_cmp_lt_u32 s30, 8
    s_cbranch_scc1 L_at1_h2
    s_nop 7
    v_mov_b32 v152, 0
    v_mov_b32 v153, 0
    v_mov_b32 v154, 0
    v_mov_b32 v155, 0
    v_mov_b32 v156, 0
    v_mov_b32 v157, 0
    v_mov_b32 v158, 0
    v_mov_b32 v159, 0
    s_branch L_at1_ret
L_at2_slow:
    s_nop 15
    v_cmp_nlt_f32 vcc, v60, s29
    s_nop 4
    s_cbranch_vccnz L_at2_heavy
    v_frexp_exp_i32_f32 v3, v60
    v_add_u32 v3, 100, v3
    v_cvt_f32_i32 v4, v3
    v_sub_u32 v3, 0, v3
    v_ldexp_f32 v120, v120, v3
    v_ldexp_f32 v121, v121, v3
    v_ldexp_f32 v122, v122, v3
    v_ldexp_f32 v123, v123, v3
    v_ldexp_f32 v124, v124, v3
    v_ldexp_f32 v125, v125, v3
    v_ldexp_f32 v126, v126, v3
    v_ldexp_f32 v127, v127, v3
    v_ldexp_f32 v128, v128, v3
    v_ldexp_f32 v129, v129, v3
    v_ldexp_f32 v130, v130, v3
    v_ldexp_f32 v131, v131, v3
    v_ldexp_f32 v132, v132, v3
    v_ldexp_f32 v133, v133, v3
    v_ldexp_f32 v134, v134, v3
    v_ldexp_f32 v135, v135, v3
    v_ldexp_f32 v60, v60, v3
    v_ldexp_f32 v61, v61, v3
    v_ldexp_f32 v62, v62, v3
    v_ldexp_f32 v63, v63, v3
    v_sub_f32 v72, v72, v4
    v_sub_f32 v73, v73, v4
    v_sub_f32 v74, v74, v4
    v_sub_f32 v75, v75, v4
    v_sub_f32 v76, v76, v4
    v_sub_f32 v77, v77, v4
    v_sub_f32 v78, v78, v4
    v_sub_f32 v79, v79, v4
    v_sub_f32 v80, v80, v4
    v_sub_f32 v81, v81, v4
    v_sub_f32 v82, v82, v4
    v_sub_f32 v83, v83, v4
    v_sub_f32 v84, v84, v4
    v_sub_f32 v85, v85, v4
    v_sub_f32 v86, v86, v4
    v_sub_f32 v87, v87, v4
    v_sub_f32 v88, v88, v4
    v_sub_f32 v89, v89, v4
    v_sub_f32 v90, v90, v4
    v_sub_f32 v91, v91, v4
    v_sub_f32 v92, v92, v4
    v_sub_f32 v93, v93, v4
    v_sub_f32 v94, v94, v4
    v_sub_f32 v95, v95, v4
    v_sub_f32 v96, v96, v4
    v_sub_f32 v97, v97, v4
    v_sub_f32 v98, v98, v4
    v_sub_f32 v99, v99, v4
    v_sub_f32 v100, v100, v4
    v_sub_f32 v101, v101, v4
    v_sub_f32 v102, v102, v4
    v_sub_f32 v103, v103, v4
    s_nop 1
    s_branch L_at2_ret
L_at2_heavy:
    s_waitcnt vmcnt(0)
    v_mfma_f32_16x16x32_bf16 v[164:167], v[192:195], v[152:155], 0
    v_mfma_f32_16x16x32_bf16 v[168:171], v[192:195], v[156:159], 0
    s_nop 15
    v_max3_f32 v70, |v164|, |v165|, v70
    v_max3_f32 v70, |v166|, |v167|, v70
    v_max3_f32 v70, |v168|, |v169|, v70
    v_max3_f32 v70, |v170|, |v171|, v70
    s_waitcnt lgkmcnt(0)
    v_log_f32 v5, v64
    v_add_u32 v6, 65536, v10
    s_mov_b32 s30, 0
L_at2_h1:
    ds_read_b128 v[168:171], v6
    ds_read_b128 v[172:175], v6 offset:1024
    s_waitcnt lgkmcnt(0)
    v_mfma_f32_32x32x16_bf16 v[152:167], v[168:171], v[16:19], v[72:87]
    v_mfma_f32_32x32x16_bf16 v[152:167], v[172:175], v[20:23], v[152:167]
    s_nop 15
    v_max3_f32 v5, v152, v153, v5
    v_max3_f32 v5, v154, v155, v5
    v_max3_f32 v5, v156, v157, v5
    v_max3_f32 v5, v158, v159, v5
    v_max3_f32 v5, v160, v161, v5
    v_max3_f32 v5, v162, v163, v5
    v_max3_f32 v5, v164, v165, v5
    v_max3_f32 v5, v166, v167, v5
    v_add_u32 v6, 4096, v6
    s_add_u32 s30, s30, 1
    s_cmp_lt_u32 s30, 8
    s_cbranch_scc1 L_at2_h1
    v_mov_b32 v6, v5
    s_nop 1
    v_permlane32_swap_b32 v5, v6
    s_nop 1
    v_max_f32 v5, v5, v6
    v_ceil_f32 v4, v5
    v_add_f32 v4, 1120403456, v4
    v_cvt_i32_f32 v3, v4
    v_sub_u32 v3, 0, v3
    v_ldexp_f32 v120, v136, v3
    v_ldexp_f32 v121, v137, v3
    v_ldexp_f32 v122, v138, v3
    v_ldexp_f32 v123, v139, v3
    v_ldexp_f32 v124, v140, v3
    v_ldexp_f32 v125, v141, v3
    v_ldexp_f32 v126, v142, v3
    v_ldexp_f32 v127, v143, v3
    v_ldexp_f32 v128, v144, v3
    v_ldexp_f32 v129, v145, v3
    v_ldexp_f32 v130, v146, v3
    v_ldexp_f32 v131, v147, v3
    v_ldexp_f32 v132, v148, v3
    v_ldexp_f32 v133, v149, v3
    v_ldexp_f32 v134, v150, v3
    v_ldexp_f32 v135, v151, v3
    v_ldexp_f32 v60, v64, v3
    v_ldexp_f32 v61, v65, v3
    v_ldexp_f32 v62, v66, v3
    v_ldexp_f32 v63, v67, v3
    v_sub_f32 v72, v72, v4
    v_sub_f32 v73, v73, v4
    v_sub_f32 v74, v74, v4
    v_sub_f32 v75, v75, v4
    v_sub_f32 v76, v76, v4
    v_sub_f32 v77, v77, v4
    v_sub_f32 v78, v78, v4
    v_sub_f32 v79, v79, v4
    v_sub_f32 v80, v80, v4
    v_sub_f32 v81, v81, v4
    v_sub_f32 v82, v82, v4
    v_sub_f32 v83, v83, v4
    v_sub_f32 v84, v84, v4
    v_sub_f32 v85, v85, v4
    v_sub_f32 v86, v86, v4
    v_sub_f32 v87, v87, v4
    v_sub_f32 v88, v88, v4
    v_sub_f32 v89, v89, v4
    v_sub_f32 v90, v90, v4
    v_sub_f32 v91, v91, v4
    v_sub_f32 v92, v92, v4
    v_sub_f32 v93, v93, v4
    v_sub_f32 v94, v94, v4
    v_sub_f32 v95, v95, v4
    v_sub_f32 v96, v96, v4
    v_sub_f32 v97, v97, v4
    v_sub_f32 v98, v98, v4
    v_sub_f32 v99, v99, v4
    v_sub_f32 v100, v100, v4
    v_sub_f32 v101, v101, v4
    v_sub_f32 v102, v102, v4
    v_sub_f32 v103, v103, v4
    v_add_u32 v6, 65536, v10
    s_mov_b32 s30, 0
L_at2_h2:
    ds_read_b128 v[168:171], v6
    ds_read_b128 v[172:175], v6 offset:1024
    ds_read_b128 v[176:179], v6 offset:2048
    ds_read_b128 v[180:183], v6 offset:3072
    s_waitcnt lgkmcnt(0)
    v_mfma_f32_32x32x16_bf16 v[152:167], v[168:171], v[16:19], v[72:87]
    v_mfma_f32_32x32x16_bf16 v[152:167], v[172:175], v[20:23], v[152:167]
    s_nop 15
    v_exp_f32 v152, v152
    v_exp_f32 v153, v153
    v_exp_f32 v154, v154
    v_exp_f32 v155, v155
    v_exp_f32 v156, v156
    v_exp_f32 v157, v157
    v_exp_f32 v158, v158
    v_exp_f32 v159, v159
    v_exp_f32 v160, v160
    v_exp_f32 v161, v161
    v_exp_f32 v162, v162
    v_exp_f32 v163, v163
    v_exp_f32 v164, v164
    v_exp_f32 v165, v165
    v_exp_f32 v166, v166
    v_exp_f32 v167, v167
    s_nop 0
    v_cvt_pk_bf16_f32 v184, v152, v153
    v_cvt_pk_bf16_f32 v185, v154, v155
    v_cvt_pk_bf16_f32 v186, v156, v157
    v_cvt_pk_bf16_f32 v187, v158, v159
    v_cvt_pk_bf16_f32 v188, v160, v161
    v_cvt_pk_bf16_f32 v189, v162, v163
    v_cvt_pk_bf16_f32 v190, v164, v165
    v_cvt_pk_bf16_f32 v191, v166, v167
    s_nop 1
    v_mfma_f32_32x32x16_bf16 v[120:135], v[176:179], v[184:187], v[120:135]
    v_mfma_f32_32x32x16_bf16 v[120:135], v[180:183], v[188:191], v[120:135]
    v_mfma_f32_16x16x32_bf16 v[60:63], v[56:59], v[184:187], v[60:63]
    v_mfma_f32_16x16x32_bf16 v[60:63], v[56:59], v[188:191], v[60:63]
    v_add_u32 v6, 4096, v6
    s_add_u32 s30, s30, 1
    s_cmp_lt_u32 s30, 8
    s_cbranch_scc1 L_at2_h2
    s_nop 7
    v_mov_b32 v152, 0
    v_mov_b32 v153, 0
    v_mov_b32 v154, 0
    v_mov_b32 v155, 0
    v_mov_b32 v156, 0
    v_mov_b32 v157, 0
    v_mov_b32 v158, 0
    v_mov_b32 v159, 0
    s_branch L_at2_ret
L_at3_slow:
    s_nop 15
    v_cmp_nlt_f32 vcc, v64, s29
    s_nop 4
    s_cbranch_vccnz L_at3_heavy
    v_frexp_exp_i32_f32 v3, v64
    v_add_u32 v3, 100, v3
    v_cvt_f32_i32 v4, v3
    v_sub_u32 v3, 0, v3
    v_ldexp_f32 v136, v136, v3
    v_ldexp_f32 v137, v137, v3
    v_ldexp_f32 v138, v138, v3
    v_ldexp_f32 v139, v139, v3
    v_ldexp_f32 v140, v140, v3
    v_ldexp_f32 v141, v141, v3
    v_ldexp_f32 v142, v142, v3
    v_ldexp_f32 v143, v143, v3
    v_ldexp_f32 v144, v144, v3
    v_ldexp_f32 v145, v145, v3
    v_ldexp_f32 v146, v146, v3
    v_ldexp_f32 v147, v147, v3
    v_ldexp_f32 v148, v148, v3
    v_ldexp_f32 v149, v149, v3
    v_ldexp_f32 v150, v150, v3
    v_ldexp_f32 v151, v151, v3
    v_ldexp_f32 v64, v64, v3
    v_ldexp_f32 v65, v65, v3
    v_ldexp_f32 v66, v66, v3
    v_ldexp_f32 v67, v67, v3
    v_sub_f32 v72, v72, v4
    v_sub_f32 v73, v73, v4
    v_sub_f32 v74, v74, v4
    v_sub_f32 v75, v75, v4
    v_sub_f32 v76, v76, v4
    v_sub_f32 v77, v77, v4
    v_sub_f32 v78, v78, v4
    v_sub_f32 v79, v79, v4
    v_sub_f32 v80, v80, v4
    v_sub_f32 v81, v81, v4
    v_sub_f32 v82, v82, v4
    v_sub_f32 v83, v83, v4
    v_sub_f32 v84, v84, v4
    v_sub_f32 v85, v85, v4
    v_sub_f32 v86, v86, v4
    v_sub_f32 v87, v87, v4
    v_sub_f32 v88, v88, v4
    v_sub_f32 v89, v89, v4
    v_sub_f32 v90, v90, v4
    v_sub_f32 v91, v91, v4
    v_sub_f32 v92, v92, v4
    v_sub_f32 v93, v93, v4
    v_sub_f32 v94, v94, v4
    v_sub_f32 v95, v95, v4
    v_sub_f32 v96, v96, v4
    v_sub_f32 v97, v97, v4
    v_sub_f32 v98, v98, v4
    v_sub_f32 v99, v99, v4
    v_sub_f32 v100, v100, v4
    v_sub_f32 v101, v101, v4
    v_sub_f32 v102, v102, v4
    v_sub_f32 v103, v103, v4
    s_nop 1
    s_branch L_at3_ret
L_at3_heavy:
    s_waitcnt vmcnt(0)
    v_mfma_f32_16x16x32_bf16 v[164:167], v[192:195], v[152:155], 0
    v_mfma_f32_16x16x32_bf16 v[168:171], v[192:195], v[156:159], 0
    v_mfma_f32_16x16x32_bf16 v[172:175], v[192:195], v[160:163], 0
    s_nop 15
    v_max3_f32 v70, |v164|, |v165|, v70
    v_max3_f32 v70, |v166|, |v167|, v70
    v_max3_f32 v70, |v168|, |v169|, v70
    v_max3_f32 v70, |v170|, |v171|, v70
    v_max3_f32 v70, |v172|, |v173|, v70
    v_max3_f32 v70, |v174|, |v175|, v70
    s_waitcnt lgkmcnt(0)
    v_log_f32 v5, v60
    v_add_u32 v6, 0, v10
    s_mov_b32 s30, 0
L_at3_h1:
    ds_read_b128 v[168:171], v6
    ds_read_b128 v[172:175], v6 offset:1024
    s_waitcnt lgkmcnt(0)
    v_mfma_f32_32x32x16_bf16 v[152:167], v[168:171], v[16:19], v[72:87]
    v_mfma_f32_32x32x16_bf16 v[152:167], v[172:175], v[20:23], v[152:167]
    s_nop 15
    v_max3_f32 v5, v152, v153, v5
    v_max3_f32 v5, v154, v155, v5
    v_max3_f32 v5, v156, v157, v5
    v_max3_f32 v5, v158, v159, v5
    v_max3_f32 v5, v160, v161, v5
    v_max3_f32 v5, v162, v163, v5
    v_max3_f32 v5, v164, v165, v5
    v_max3_f32 v5, v166, v167, v5
    v_add_u32 v6, 4096, v6
    s_add_u32 s30, s30, 1
    s_cmp_lt_u32 s30, 8
    s_cbranch_scc1 L_at3_h1
    v_mov_b32 v6, v5
    s_nop 1
    v_permlane32_swap_b32 v5, v6
    s_nop 1
    v_max_f32 v5, v5, v6
    v_ceil_f32 v4, v5
    v_add_f32 v4, 1120403456, v4
    v_cvt_i32_f32 v3, v4
    v_sub_u32 v3, 0, v3
    v_ldexp_f32 v136, v120, v3
    v_ldexp_f32 v137, v121, v3
    v_ldexp_f32 v138, v122, v3
    v_ldexp_f32 v139, v123, v3
    v_ldexp_f32 v140, v124, v3
    v_ldexp_f32 v141, v125, v3
    v_ldexp_f32 v142, v126, v3
    v_ldexp_f32 v143, v127, v3
    v_ldexp_f32 v144, v128, v3
    v_ldexp_f32 v145, v129, v3
    v_ldexp_f32 v146, v130, v3
    v_ldexp_f32 v147, v131, v3
    v_ldexp_f32 v148, v132, v3
    v_ldexp_f32 v149, v133, v3
    v_ldexp_f32 v150, v134, v3
    v_ldexp_f32 v151, v135, v3
    v_ldexp_f32 v64, v60, v3
    v_ldexp_f32 v65, v61, v3
    v_ldexp_f32 v66, v62, v3
    v_ldexp_f32 v67, v63, v3
    v_sub_f32 v72, v72, v4
    v_sub_f32 v73, v73, v4
    v_sub_f32 v74, v74, v4
    v_sub_f32 v75, v75, v4
    v_sub_f32 v76, v76, v4
    v_sub_f32 v77, v77, v4
    v_sub_f32 v78, v78, v4
    v_sub_f32 v79, v79, v4
    v_sub_f32 v80, v80, v4
    v_sub_f32 v81, v81, v4
    v_sub_f32 v82, v82, v4
    v_sub_f32 v83, v83, v4
    v_sub_f32 v84, v84, v4
    v_sub_f32 v85, v85, v4
    v_sub_f32 v86, v86, v4
    v_sub_f32 v87, v87, v4
    v_sub_f32 v88, v88, v4
    v_sub_f32 v89, v89, v4
    v_sub_f32 v90, v90, v4
    v_sub_f32 v91, v91, v4
    v_sub_f32 v92, v92, v4
    v_sub_f32 v93, v93, v4
    v_sub_f32 v94, v94, v4
    v_sub_f32 v95, v95, v4
    v_sub_f32 v96, v96, v4
    v_sub_f32 v97, v97, v4
    v_sub_f32 v98, v98, v4
    v_sub_f32 v99, v99, v4
    v_sub_f32 v100, v100, v4
    v_sub_f32 v101, v101, v4
    v_sub_f32 v102, v102, v4
    v_sub_f32 v103, v103, v4
    v_add_u32 v6, 0, v10
    s_mov_b32 s30, 0
L_at3_h2:
    ds_read_b128 v[168:171], v6
    ds_read_b128 v[172:175], v6 offset:1024
    ds_read_b128 v[176:179], v6 offset:2048
    ds_read_b128 v[180:183], v6 offset:3072
    s_waitcnt lgkmcnt(0)
    v_mfma_f32_32x32x16_bf16 v[152:167], v[168:171], v[16:19], v[72:87]
    v_mfma_f32_32x32x16_bf16 v[152:167], v[172:175], v[20:23], v[152:167]
    s_nop 15
    v_exp_f32 v152, v152
    v_exp_f32 v153, v153
    v_exp_f32 v154, v154
    v_exp_f32 v155, v155
    v_exp_f32 v156, v156
    v_exp_f32 v157, v157
    v_exp_f32 v158, v158
    v_exp_f32 v159, v159
    v_exp_f32 v160, v160
    v_exp_f32 v161, v161
    v_exp_f32 v162, v162
    v_exp_f32 v163, v163
    v_exp_f32 v164, v164
    v_exp_f32 v165, v165
    v_exp_f32 v166, v166
    v_exp_f32 v167, v167
    s_nop 0
    v_cvt_pk_bf16_f32 v184, v152, v153
    v_cvt_pk_bf16_f32 v185, v154, v155
    v_cvt_pk_bf16_f32 v186, v156, v157
    v_cvt_pk_bf16_f32 v187, v158, v159
    v_cvt_pk_bf16_f32 v188, v160, v161
    v_cvt_pk_bf16_f32 v189, v162, v163
    v_cvt_pk_bf16_f32 v190, v164, v165
    v_cvt_pk_bf16_f32 v191, v166, v167
    s_nop 1
    v_mfma_f32_32x32x16_bf16 v[136:151], v[176:179], v[184:187], v[136:151]
    v_mfma_f32_32x32x16_bf16 v[136:151], v[180:183], v[188:191], v[136:151]
    v_mfma_f32_16x16x32_bf16 v[64:67], v[56:59], v[184:187], v[64:67]
    v_mfma_f32_16x16x32_bf16 v[64:67], v[56:59], v[188:191], v[64:67]
    v_add_u32 v6, 4096, v6
    s_add_u32 s30, s30, 1
    s_cmp_lt_u32 s30, 8
    s_cbranch_scc1 L_at3_h2
    s_nop 7
    v_mov_b32 v152, 0
    v_mov_b32 v153, 0
    v_mov_b32 v154, 0
    v_mov_b32 v155, 0
    v_mov_b32 v156, 0
    v_mov_b32 v157, 0
    v_mov_b32 v158, 0
    v_mov_b32 v159, 0
    v_mov_b32 v160, 0
    v_mov_b32 v161, 0
    v_mov_b32 v162, 0
    v_mov_b32 v163, 0
    s_branch L_at3_ret
L_at4_slow:
    s_nop 15
    v_cmp_nlt_f32 vcc, v60, s29
    s_nop 4
    s_cbranch_vccnz L_at4_heavy
    v_frexp_exp_i32_f32 v3, v60
    v_add_u32 v3, 100, v3
    v_cvt_f32_i32 v4, v3
    v_sub_u32 v3, 0, v3
    v_ldexp_f32 v120, v120, v3
    v_ldexp_f32 v121, v121, v3
    v_ldexp_f32 v122, v122, v3
    v_ldexp_f32 v123, v123, v3
    v_ldexp_f32 v124, v124, v3
    v_ldexp_f32 v125, v125, v3
    v_ldexp_f32 v126, v126, v3
    v_ldexp_f32 v127, v127, v3
    v_ldexp_f32 v128, v128, v3
    v_ldexp_f32 v129, v129, v3
    v_ldexp_f32 v130, v130, v3
    v_ldexp_f32 v131, v131, v3
    v_ldexp_f32 v132, v132, v3
    v_ldexp_f32 v133, v133, v3
    v_ldexp_f32 v134, v134, v3
    v_ldexp_f32 v135, v135, v3
    v_ldexp_f32 v60, v60, v3
    v_ldexp_f32 v61, v61, v3
    v_ldexp_f32 v62, v62, v3
    v_ldexp_f32 v63, v63, v3
    v_sub_f32 v72, v72, v4
    v_sub_f32 v73, v73, v4
    v_sub_f32 v74, v74, v4
    v_sub_f32 v75, v75, v4
    v_sub_f32 v76, v76, v4
    v_sub_f32 v77, v77, v4
    v_sub_f32 v78, v78, v4
    v_sub_f32 v79, v79, v4
    v_sub_f32 v80, v80, v4
    v_sub_f32 v81, v81, v4
    v_sub_f32 v82, v82, v4
    v_sub_f32 v83, v83, v4
    v_sub_f32 v84, v84, v4
    v_sub_f32 v85, v85, v4
    v_sub_f32 v86, v86, v4
    v_sub_f32 v87, v87, v4
    v_sub_f32 v88, v88, v4
    v_sub_f32 v89, v89, v4
    v_sub_f32 v90, v90, v4
    v_sub_f32 v91, v91, v4
    v_sub_f32 v92, v92, v4
    v_sub_f32 v93, v93, v4
    v_sub_f32 v94, v94, v4
    v_sub_f32 v95, v95, v4
    v_sub_f32 v96, v96, v4
    v_sub_f32 v97, v97, v4
    v_sub_f32 v98, v98, v4
    v_sub_f32 v99, v99, v4
    v_sub_f32 v100, v100, v4
    v_sub_f32 v101, v101, v4
    v_sub_f32 v102, v102, v4
    v_sub_f32 v103, v103, v4
    s_nop 1
    s_branch L_at4_ret
L_at4_heavy:
    s_waitcnt vmcnt(0)
    v_mfma_f32_16x16x32_bf16 v[164:167], v[196:199], v[152:155], 0
    v_mfma_f32_16x16x32_bf16 v[168:171], v[196:199], v[156:159], 0
    v_mfma_f32_16x16x32_bf16 v[172:175], v[196:199], v[160:163], 0
    s_nop 15
    v_max3_f32 v70, |v164|, |v165|, v70
    v_max3_f32 v70, |v166|, |v167|, v70
    v_max3_f32 v70, |v168|, |v169|, v70
    v_max3_f32 v70, |v170|, |v171|, v70
    v_max3_f32 v70, |v172|, |v173|, v70
    v_max3_f32 v70, |v174|, |v175|, v70
    s_waitcnt lgkmcnt(0)
    v_log_f32 v5, v64
    v_add_u32 v6, 32768, v10
    s_mov_b32 s30, 0
L_at4_h1:
    ds_read_b128 v[168:171], v6
    ds_read_b128 v[172:175], v6 offset:1024
    s_waitcnt lgkmcnt(0)
    v_mfma_f32_32x32x16_bf16 v[152:167], v[168:171], v[16:19], v[72:87]
    v_mfma_f32_32x32x16_bf16 v[152:167], v[172:175], v[20:23], v[152:167]
    s_nop 15
    v_max3_f32 v5, v152, v153, v5
    v_max3_f32 v5, v154, v155, v5
    v_max3_f32 v5, v156, v157, v5
    v_max3_f32 v5, v158, v159, v5
    v_max3_f32 v5, v160, v161, v5
    v_max3_f32 v5, v162, v163, v5
    v_max3_f32 v5, v164, v165, v5
    v_max3_f32 v5, v166, v167, v5
    v_add_u32 v6, 4096, v6
    s_add_u32 s30, s30, 1
    s_cmp_lt_u32 s30, 8
    s_cbranch_scc1 L_at4_h1
    v_mov_b32 v6, v5
    s_nop 1
    v_permlane32_swap_b32 v5, v6
    s_nop 1
    v_max_f32 v5, v5, v6
    v_ceil_f32 v4, v5
    v_add_f32 v4, 1120403456, v4
    v_cvt_i32_f32 v3, v4
    v_sub_u32 v3, 0, v3
    v_ldexp_f32 v120, v136, v3
    v_ldexp_f32 v121, v137, v3
    v_ldexp_f32 v122, v138, v3
    v_ldexp_f32 v123, v139, v3
    v_ldexp_f32 v124, v140, v3
    v_ldexp_f32 v125, v141, v3
    v_ldexp_f32 v126, v142, v3
    v_ldexp_f32 v127, v143, v3
    v_ldexp_f32 v128, v144, v3
    v_ldexp_f32 v129, v145, v3
    v_ldexp_f32 v130, v146, v3
    v_ldexp_f32 v131, v147, v3
    v_ldexp_f32 v132, v148, v3
    v_ldexp_f32 v133, v149, v3
    v_ldexp_f32 v134, v150, v3
    v_ldexp_f32 v135, v151, v3
    v_ldexp_f32 v60, v64, v3
    v_ldexp_f32 v61, v65, v3
    v_ldexp_f32 v62, v66, v3
    v_ldexp_f32 v63, v67, v3
    v_sub_f32 v72, v72, v4
    v_sub_f32 v73, v73, v4
    v_sub_f32 v74, v74, v4
    v_sub_f32 v75, v75, v4
    v_sub_f32 v76, v76, v4
    v_sub_f32 v77, v77, v4
    v_sub_f32 v78, v78, v4
    v_sub_f32 v79, v79, v4
    v_sub_f32 v80, v80, v4
    v_sub_f32 v81, v81, v4
    v_sub_f32 v82, v82, v4
    v_sub_f32 v83, v83, v4
    v_sub_f32 v84, v84, v4
    v_sub_f32 v85, v85, v4
    v_sub_f32 v86, v86, v4
    v_sub_f32 v87, v87, v4
    v_sub_f32 v88, v88, v4
    v_sub_f32 v89, v89, v4
    v_sub_f32 v90, v90, v4
    v_sub_f32 v91, v91, v4
    v_sub_f32 v92, v92, v4
    v_sub_f32 v93, v93, v4
    v_sub_f32 v94, v94, v4
    v_sub_f32 v95, v95, v4
    v_sub_f32 v96, v96, v4
    v_sub_f32 v97, v97, v4
    v_sub_f32 v98, v98, v4
    v_sub_f32 v99, v99, v4
    v_sub_f32 v100, v100, v4
    v_sub_f32 v101, v101, v4
    v_sub_f32 v102, v102, v4
    v_sub_f32 v103, v103, v4
    v_add_u32 v6, 32768, v10
    s_mov_b32 s30, 0
L_at4_h2:
    ds_read_b128 v[168:171], v6
    ds_read_b128 v[172:175], v6 offset:1024
    ds_read_b128 v[176:179], v6 offset:2048
    ds_read_b128 v[180:183], v6 offset:3072
    s_waitcnt lgkmcnt(0)
    v_mfma_f32_32x32x16_bf16 v[152:167], v[168:171], v[16:19], v[72:87]
    v_mfma_f32_32x32x16_bf16 v[152:167], v[172:175], v[20:23], v[152:167]
    s_nop 15
    v_exp_f32 v152, v152
    v_exp_f32 v153, v153
    v_exp_f32 v154, v154
    v_exp_f32 v155, v155
    v_exp_f32 v156, v156
    v_exp_f32 v157, v157
    v_exp_f32 v158, v158
    v_exp_f32 v159, v159
    v_exp_f32 v160, v160
    v_exp_f32 v161, v161
    v_exp_f32 v162, v162
    v_exp_f32 v163, v163
    v_exp_f32 v164, v164
    v_exp_f32 v165, v165
    v_exp_f32 v166, v166
    v_exp_f32 v167, v167
    s_nop 0
    v_cvt_pk_bf16_f32 v184, v152, v153
    v_cvt_pk_bf16_f32 v185, v154, v155
    v_cvt_pk_bf16_f32 v186, v156, v157
    v_cvt_pk_bf16_f32 v187, v158, v159
    v_cvt_pk_bf16_f32 v188, v160, v161
    v_cvt_pk_bf16_f32 v189, v162, v163
    v_cvt_pk_bf16_f32 v190, v164, v165
    v_cvt_pk_bf16_f32 v191, v166, v167
    s_nop 1
    v_mfma_f32_32x32x16_bf16 v[120:135], v[176:179], v[184:187], v[120:135]
    v_mfma_f32_32x32x16_bf16 v[120:135], v[180:183], v[188:191], v[120:135]
    v_mfma_f32_16x16x32_bf16 v[60:63], v[56:59], v[184:187], v[60:63]
    v_mfma_f32_16x16x32_bf16 v[60:63], v[56:59], v[188:191], v[60:63]
    v_add_u32 v6, 4096, v6
    s_add_u32 s30, s30, 1
    s_cmp_lt_u32 s30, 8
    s_cbranch_scc1 L_at4_h2
    s_nop 7
    v_mov_b32 v152, 0
    v_mov_b32 v153, 0
    v_mov_b32 v154, 0
    v_mov_b32 v155, 0
    v_mov_b32 v156, 0
    v_mov_b32 v157, 0
    v_mov_b32 v158, 0
    v_mov_b32 v159, 0
    v_mov_b32 v160, 0
    v_mov_b32 v161, 0
    v_mov_b32 v162, 0
    v_mov_b32 v163, 0
    s_branch L_at4_ret
L_at5_slow:
    s_nop 15
    v_cmp_nlt_f32 vcc, v64, s29
    s_nop 4
    s_cbranch_vccnz L_at5_heavy
    v_frexp_exp_i32_f32 v3, v64
    v_add_u32 v3, 100, v3
    v_cvt_f32_i32 v4, v3
    v_sub_u32 v3, 0, v3
    v_ldexp_f32 v136, v136, v3
    v_ldexp_f32 v137, v137, v3
    v_ldexp_f32 v138, v138, v3
    v_ldexp_f32 v139, v139, v3
    v_ldexp_f32 v140, v140, v3
    v_ldexp_f32 v141, v141, v3
    v_ldexp_f32 v142, v142, v3
    v_ldexp_f32 v143, v143, v3
    v_ldexp_f32 v144, v144, v3
    v_ldexp_f32 v145, v145, v3
    v_ldexp_f32 v146, v146, v3
    v_ldexp_f32 v147, v147, v3
    v_ldexp_f32 v148, v148, v3
    v_ldexp_f32 v149, v149, v3
    v_ldexp_f32 v150, v150, v3
    v_ldexp_f32 v151, v151, v3
    v_ldexp_f32 v64, v64, v3
    v_ldexp_f32 v65, v65, v3
    v_ldexp_f32 v66, v66, v3
    v_ldexp_f32 v67, v67, v3
    v_sub_f32 v72, v72, v4
    v_sub_f32 v73, v73, v4
    v_sub_f32 v74, v74, v4
    v_sub_f32 v75, v75, v4
    v_sub_f32 v76, v76, v4
    v_sub_f32 v77, v77, v4
    v_sub_f32 v78, v78, v4
    v_sub_f32 v79, v79, v4
    v_sub_f32 v80, v80, v4
    v_sub_f32 v81, v81, v4
    v_sub_f32 v82, v82, v4
    v_sub_f32 v83, v83, v4
    v_sub_f32 v84, v84, v4
    v_sub_f32 v85, v85, v4
    v_sub_f32 v86, v86, v4
    v_sub_f32 v87, v87, v4
    v_sub_f32 v88, v88, v4
    v_sub_f32 v89, v89, v4
    v_sub_f32 v90, v90, v4
    v_sub_f32 v91, v91, v4
    v_sub_f32 v92, v92, v4
    v_sub_f32 v93, v93, v4
    v_sub_f32 v94, v94, v4
    v_sub_f32 v95, v95, v4
    v_sub_f32 v96, v96, v4
    v_sub_f32 v97, v97, v4
    v_sub_f32 v98, v98, v4
    v_sub_f32 v99, v99, v4
    v_sub_f32 v100, v100, v4
    v_sub_f32 v101, v101, v4
    v_sub_f32 v102, v102, v4
    v_sub_f32 v103, v103, v4
    s_nop 1
    s_branch L_at5_ret
L_at5_heavy:
    s_waitcnt vmcnt(0)
    v_mfma_f32_16x16x32_bf16 v[164:167], v[196:199], v[152:155], 0
    v_mfma_f32_16x16x32_bf16 v[168:171], v[196:199], v[156:159], 0
    s_nop 15
    v_max3_f32 v70, |v164|, |v165|, v70
    v_max3_f32 v70, |v166|, |v167|, v70
    v_max3_f32 v70, |v168|, |v169|, v70
    v_max3_f32 v70, |v170|, |v171|, v70
    s_waitcnt lgkmcnt(0)
    v_log_f32 v5, v60
    v_add_u32 v6, 65536, v10
    s_mov_b32 s30, 0
L_at5_h1:
    ds_read_b128 v[168:171], v6
    ds_read_b128 v[172:175], v6 offset:1024
    s_waitcnt lgkmcnt(0)
    v_mfma_f32_32x32x16_bf16 v[152:167], v[168:171], v[16:19], v[72:87]
    v_mfma_f32_32x32x16_bf16 v[152:167], v[172:175], v[20:23], v[152:167]
    s_nop 15
    v_max3_f32 v5, v152, v153, v5
    v_max3_f32 v5, v154, v155, v5
    v_max3_f32 v5, v156, v157, v5
    v_max3_f32 v5, v158, v159, v5
    v_max3_f32 v5, v160, v161, v5
    v_max3_f32 v5, v162, v163, v5
    v_max3_f32 v5, v164, v165, v5
    v_max3_f32 v5, v166, v167, v5
    v_add_u32 v6, 4096, v6
    s_add_u32 s30, s30, 1
    s_cmp_lt_u32 s30, 8
    s_cbranch_scc1 L_at5_h1
    v_mov_b32 v6, v5
    s_nop 1
    v_permlane32_swap_b32 v5, v6
    s_nop 1
    v_max_f32 v5, v5, v6
    v_ceil_f32 v4, v5
    v_add_f32 v4, 1120403456, v4
    v_cvt_i32_f32 v3, v4
    v_sub_u32 v3, 0, v3
    v_ldexp_f32 v136, v120, v3
    v_ldexp_f32 v137, v121, v3
    v_ldexp_f32 v138, v122, v3
    v_ldexp_f32 v139, v123, v3
    v_ldexp_f32 v140, v124, v3
    v_ldexp_f32 v141, v125, v3
    v_ldexp_f32 v142, v126, v3
    v_ldexp_f32 v143, v127, v3
    v_ldexp_f32 v144, v128, v3
    v_ldexp_f32 v145, v129, v3
    v_ldexp_f32 v146, v130, v3
    v_ldexp_f32 v147, v131, v3
    v_ldexp_f32 v148, v132, v3
    v_ldexp_f32 v149, v133, v3
    v_ldexp_f32 v150, v134, v3
    v_ldexp_f32 v151, v135, v3
    v_ldexp_f32 v64, v60, v3
    v_ldexp_f32 v65, v61, v3
    v_ldexp_f32 v66, v62, v3
    v_ldexp_f32 v67, v63, v3
    v_sub_f32 v72, v72, v4
    v_sub_f32 v73, v73, v4
    v_sub_f32 v74, v74, v4
    v_sub_f32 v75, v75, v4
    v_sub_f32 v76, v76, v4
    v_sub_f32 v77, v77, v4
    v_sub_f32 v78, v78, v4
    v_sub_f32 v79, v79, v4
    v_sub_f32 v80, v80, v4
    v_sub_f32 v81, v81, v4
    v_sub_f32 v82, v82, v4
    v_sub_f32 v83, v83, v4
    v_sub_f32 v84, v84, v4
    v_sub_f32 v85, v85, v4
    v_sub_f32 v86, v86, v4
    v_sub_f32 v87, v87, v4
    v_sub_f32 v88, v88, v4
    v_sub_f32 v89, v89, v4
    v_sub_f32 v90, v90, v4
    v_sub_f32 v91, v91, v4
    v_sub_f32 v92, v92, v4
    v_sub_f32 v93, v93, v4
    v_sub_f32 v94, v94, v4
    v_sub_f32 v95, v95, v4
    v_sub_f32 v96, v96, v4
    v_sub_f32 v97, v97, v4
    v_sub_f32 v98, v98, v4
    v_sub_f32 v99, v99, v4
    v_sub_f32 v100, v100, v4
    v_sub_f32 v101, v101, v4
    v_sub_f32 v102, v102, v4
    v_sub_f32 v103, v103, v4
    v_add_u32 v6, 65536, v10
    s_mov_b32 s30, 0
L_at5_h2:
    ds_read_b128 v[168:171], v6
    ds_read_b128 v[172:175], v6 offset:1024
    ds_read_b128 v[176:179], v6 offset:2048
    ds_read_b128 v[180:183], v6 offset:3072
    s_waitcnt lgkmcnt(0)
    v_mfma_f32_32x32x16_bf16 v[152:167], v[168:171], v[16:19], v[72:87]
    v_mfma_f32_32x32x16_bf16 v[152:167], v[172:175], v[20:23], v[152:167]
    s_nop 15
    v_exp_f32 v152, v152
    v_exp_f32 v153, v153
    v_exp_f32 v154, v154
    v_exp_f32 v155, v155
    v_exp_f32 v156, v156
    v_exp_f32 v157, v157
    v_exp_f32 v158, v158
    v_exp_f32 v159, v159
    v_exp_f32 v160, v160
    v_exp_f32 v161, v161
    v_exp_f32 v162, v162
    v_exp_f32 v163, v163
    v_exp_f32 v164, v164
    v_exp_f32 v165, v165
    v_exp_f32 v166, v166
    v_exp_f32 v167, v167
    s_nop 0
    v_cvt_pk_bf16_f32 v184, v152, v153
    v_cvt_pk_bf16_f32 v185, v154, v155
    v_cvt_pk_bf16_f32 v186, v156, v157
    v_cvt_pk_bf16_f32 v187, v158, v159
    v_cvt_pk_bf16_f32 v188, v160, v161
    v_cvt_pk_bf16_f32 v189, v162, v163
    v_cvt_pk_bf16_f32 v190, v164, v165
    v_cvt_pk_bf16_f32 v191, v166, v167
    s_nop 1
    v_mfma_f32_32x32x16_bf16 v[136:151], v[176:179], v[184:187], v[136:151]
    v_mfma_f32_32x32x16_bf16 v[136:151], v[180:183], v[188:191], v[136:151]
    v_mfma_f32_16x16x32_bf16 v[64:67], v[56:59], v[184:187], v[64:67]
    v_mfma_f32_16x16x32_bf16 v[64:67], v[56:59], v[188:191], v[64:67]
    v_add_u32 v6, 4096, v6
    s_add_u32 s30, s30, 1
    s_cmp_lt_u32 s30, 8
    s_cbranch_scc1 L_at5_h2
    s_nop 7
    v_mov_b32 v152, 0
    v_mov_b32 v153, 0
    v_mov_b32 v154, 0
    v_mov_b32 v155, 0
    v_mov_b32 v156, 0
    v_mov_b32 v157, 0
    v_mov_b32 v158, 0
    v_mov_b32 v159, 0
    s_branch L_at5_ret
L_at6_slow:
    s_nop 15
    v_cmp_nlt_f32 vcc, v60, s29
    s_nop 4
    s_cbranch_vccnz L_at6_heavy
    v_frexp_exp_i32_f32 v3, v60
    v_add_u32 v3, 100, v3
    v_cvt_f32_i32 v4, v3
    v_sub_u32 v3, 0, v3
    v_ldexp_f32 v120, v120, v3
    v_ldexp_f32 v121, v121, v3
    v_ldexp_f32 v122, v122, v3
    v_ldexp_f32 v123, v123, v3
    v_ldexp_f32 v124, v124, v3
    v_ldexp_f32 v125, v125, v3
    v_ldexp_f32 v126, v126, v3
    v_ldexp_f32 v127, v127, v3
    v_ldexp_f32 v128, v128, v3
    v_ldexp_f32 v129, v129, v3
    v_ldexp_f32 v130, v130, v3
    v_ldexp_f32 v131, v131, v3
    v_ldexp_f32 v132, v132, v3
    v_ldexp_f32 v133, v133, v3
    v_ldexp_f32 v134, v134, v3
    v_ldexp_f32 v135, v135, v3
    v_ldexp_f32 v60, v60, v3
    v_ldexp_f32 v61, v61, v3
    v_ldexp_f32 v62, v62, v3
    v_ldexp_f32 v63, v63, v3
    v_sub_f32 v72, v72, v4
    v_sub_f32 v73, v73, v4
    v_sub_f32 v74, v74, v4
    v_sub_f32 v75, v75, v4
    v_sub_f32 v76, v76, v4
    v_sub_f32 v77, v77, v4
    v_sub_f32 v78, v78, v4
    v_sub_f32 v79, v79, v4
    v_sub_f32 v80, v80, v4
    v_sub_f32 v81, v81, v4
    v_sub_f32 v82, v82, v4
    v_sub_f32 v83, v83, v4
    v_sub_f32 v84, v84, v4
    v_sub_f32 v85, v85, v4
    v_sub_f32 v86, v86, v4
    v_sub_f32 v87, v87, v4
    v_sub_f32 v88, v88, v4
    v_sub_f32 v89, v89, v4
    v_sub_f32 v90, v90, v4
    v_sub_f32 v91, v91, v4
    v_sub_f32 v92, v92, v4
    v_sub_f32 v93, v93, v4
    v_sub_f32 v94, v94, v4
    v_sub_f32 v95, v95, v4
    v_sub_f32 v96, v96, v4
    v_sub_f32 v97, v97, v4
    v_sub_f32 v98, v98, v4
    v_sub_f32 v99, v99, v4
    v_sub_f32 v100, v100, v4
    v_sub_f32 v101, v101, v4
    v_sub_f32 v102, v102, v4
    v_sub_f32 v103, v103, v4
    s_nop 1
    s_branch L_at6_ret
L_at6_heavy:
    s_waitcnt vmcnt(0)
    s_nop 15
    s_waitcnt lgkmcnt(0)
    v_log_f32 v5, v64
    v_add_u32 v6, 0, v10
    s_mov_b32 s30, 0
L_at6_h1:
    ds_read_b128 v[168:171], v6
    ds_read_b128 v[172:175], v6 offset:1024
    s_waitcnt lgkmcnt(0)
    v_mfma_f32_32x32x16_bf16 v[152:167], v[168:171], v[16:19], v[72:87]
    v_mfma_f32_32x32x16_bf16 v[152:167], v[172:175], v[20:23], v[152:167]
    s_nop 15
    v_max3_f32 v5, v152, v153, v5
    v_max3_f32 v5, v154, v155, v5
    v_max3_f32 v5, v156, v157, v5
    v_max3_f32 v5, v158, v159, v5
    v_max3_f32 v5, v160, v161, v5
    v_max3_f32 v5, v162, v163, v5
    v_max3_f32 v5, v164, v165, v5
    v_max3_f32 v5, v166, v167, v5
    v_add_u32 v6, 4096, v6
    s_add_u32 s30, s30, 1
    s_cmp_lt_u32 s30, 8
    s_cbranch_scc1 L_at6_h1
    v_mov_b32 v6, v5
    s_nop 1
    v_permlane32_swap_b32 v5, v6
    s_nop 1
    v_max_f32 v5, v5, v6
    v_ceil_f32 v4, v5
    v_add_f32 v4, 1120403456, v4
    v_cvt_i32_f32 v3, v4
    v_sub_u32 v3, 0, v3
    v_ldexp_f32 v120, v136, v3
    v_ldexp_f32 v121, v137, v3
    v_ldexp_f32 v122, v138, v3
    v_ldexp_f32 v123, v139, v3
    v_ldexp_f32 v124, v140, v3
    v_ldexp_f32 v125, v141, v3
    v_ldexp_f32 v126, v142, v3
    v_ldexp_f32 v127, v143, v3
    v_ldexp_f32 v128, v144, v3
    v_ldexp_f32 v129, v145, v3
    v_ldexp_f32 v130, v146, v3
    v_ldexp_f32 v131, v147, v3
    v_ldexp_f32 v132, v148, v3
    v_ldexp_f32 v133, v149, v3
    v_ldexp_f32 v134, v150, v3
    v_ldexp_f32 v135, v151, v3
    v_ldexp_f32 v60, v64, v3
    v_ldexp_f32 v61, v65, v3
    v_ldexp_f32 v62, v66, v3
    v_ldexp_f32 v63, v67, v3
    v_sub_f32 v72, v72, v4
    v_sub_f32 v73, v73, v4
    v_sub_f32 v74, v74, v4
    v_sub_f32 v75, v75, v4
    v_sub_f32 v76, v76, v4
    v_sub_f32 v77, v77, v4
    v_sub_f32 v78, v78, v4
    v_sub_f32 v79, v79, v4
    v_sub_f32 v80, v80, v4
    v_sub_f32 v81, v81, v4
    v_sub_f32 v82, v82, v4
    v_sub_f32 v83, v83, v4
    v_sub_f32 v84, v84, v4
    v_sub_f32 v85, v85, v4
    v_sub_f32 v86, v86, v4
    v_sub_f32 v87, v87, v4
    v_sub_f32 v88, v88, v4
    v_sub_f32 v89, v89, v4
    v_sub_f32 v90, v90, v4
    v_sub_f32 v91, v91, v4
    v_sub_f32 v92, v92, v4
    v_sub_f32 v93, v93, v4
    v_sub_f32 v94, v94, v4
    v_sub_f32 v95, v95, v4
    v_sub_f32 v96, v96, v4
    v_sub_f32 v97, v97, v4
    v_sub_f32 v98, v98, v4
    v_sub_f32 v99, v99, v4
    v_sub_f32 v100, v100, v4
    v_sub_f32 v101, v101, v4
    v_sub_f32 v102, v102, v4
    v_sub_f32 v103, v103, v4
    v_add_u32 v6, 0, v10
    s_mov_b32 s30, 0
L_at6_h2:
    ds_read_b128 v[168:171], v6
    ds_read_b128 v[172:175], v6 offset:1024
    ds_read_b128 v[176:179], v6 offset:2048
    ds_read_b128 v[180:183], v6 offset:3072
    s_waitcnt lgkmcnt(0)
    v_mfma_f32_32x32x16_bf16 v[152:167], v[168:171], v[16:19], v[72:87]
    v_mfma_f32_32x32x16_bf16 v[152:167], v[172:175], v[20:23], v[152:167]
    s_nop 15
    v_exp_f32 v152, v152
    v_exp_f32 v153, v153
    v_exp_f32 v154, v154
    v_exp_f32 v155, v155
    v_exp_f32 v156, v156
    v_exp_f32 v157, v157
    v_exp_f32 v158, v158
    v_exp_f32 v159, v159
    v_exp_f32 v160, v160
    v_exp_f32 v161, v161
    v_exp_f32 v162, v162
    v_exp_f32 v163, v163
    v_exp_f32 v164, v164
    v_exp_f32 v165, v165
    v_exp_f32 v166, v166
    v_exp_f32 v167, v167
    s_nop 0
    v_cvt_pk_bf16_f32 v184, v152, v153
    v_cvt_pk_bf16_f32 v185, v154, v155
    v_cvt_pk_bf16_f32 v186, v156, v157
    v_cvt_pk_bf16_f32 v187, v158, v159
    v_cvt_pk_bf16_f32 v188, v160, v161
    v_cvt_pk_bf16_f32 v189, v162, v163
    v_cvt_pk_bf16_f32 v190, v164, v165
    v_cvt_pk_bf16_f32 v191, v166, v167
    s_nop 1
    v_mfma_f32_32x32x16_bf16 v[120:135], v[176:179], v[184:187], v[120:135]
    v_mfma_f32_32x32x16_bf16 v[120:135], v[180:183], v[188:191], v[120:135]
    v_mfma_f32_16x16x32_bf16 v[60:63], v[56:59], v[184:187], v[60:63]
    v_mfma_f32_16x16x32_bf16 v[60:63], v[56:59], v[188:191], v[60:63]
    v_add_u32 v6, 4096, v6
    s_add_u32 s30, s30, 1
    s_cmp_lt_u32 s30, 8
    s_cbranch_scc1 L_at6_h2
    s_nop 7
    s_branch L_at6_ret
L_at7_slow:
    s_nop 15
    v_cmp_nlt_f32 vcc, v64, s29
    s_nop 4
    s_cbranch_vccnz L_at7_heavy
    v_frexp_exp_i32_f32 v3, v64
    v_add_u32 v3, 100, v3
    v_cvt_f32_i32 v4, v3
    v_sub_u32 v3, 0, v3
    v_ldexp_f32 v136, v136, v3
    v_ldexp_f32 v137, v137, v3
    v_ldexp_f32 v138, v138, v3
    v_ldexp_f32 v139, v139, v3
    v_ldexp_f32 v140, v140, v3
    v_ldexp_f32 v141, v141, v3
    v_ldexp_f32 v142, v142, v3
    v_ldexp_f32 v143, v143, v3
    v_ldexp_f32 v144, v144, v3
    v_ldexp_f32 v145, v145, v3
    v_ldexp_f32 v146, v146, v3
    v_ldexp_f32 v147, v147, v3
    v_ldexp_f32 v148, v148, v3
    v_ldexp_f32 v149, v149, v3
    v_ldexp_f32 v150, v150, v3
    v_ldexp_f32 v151, v151, v3
    v_ldexp_f32 v64, v64, v3
    v_ldexp_f32 v65, v65, v3
    v_ldexp_f32 v66, v66, v3
    v_ldexp_f32 v67, v67, v3
    v_sub_f32 v72, v72, v4
    v_sub_f32 v73, v73, v4
    v_sub_f32 v74, v74, v4
    v_sub_f32 v75, v75, v4
    v_sub_f32 v76, v76, v4
    v_sub_f32 v77, v77, v4
    v_sub_f32 v78, v78, v4
    v_sub_f32 v79, v79, v4
    v_sub_f32 v80, v80, v4
    v_sub_f32 v81, v81, v4
    v_sub_f32 v82, v82, v4
    v_sub_f32 v83, v83, v4
    v_sub_f32 v84, v84, v4
    v_sub_f32 v85, v85, v4
    v_sub_f32 v86, v86, v4
    v_sub_f32 v87, v87, v4
    v_sub_f32 v88, v88, v4
    v_sub_f32 v89, v89, v4
    v_sub_f32 v90, v90, v4
    v_sub_f32 v91, v91, v4
    v_sub_f32 v92, v92, v4
    v_sub_f32 v93, v93, v4
    v_sub_f32 v94, v94, v4
    v_sub_f32 v95, v95, v4
    v_sub_f32 v96, v96, v4
    v_sub_f32 v97, v97, v4
    v_sub_f32 v98, v98, v4
    v_sub_f32 v99, v99, v4
    v_sub_f32 v100, v100, v4
    v_sub_f32 v101, v101, v4
    v_sub_f32 v102, v102, v4
    v_sub_f32 v103, v103, v4
    s_nop 1
    s_branch L_at7_ret
L_at7_heavy:
    s_waitcnt vmcnt(0)
    s_nop 15
    s_waitcnt lgkmcnt(0)
    v_log_f32 v5, v60
    v_add_u32 v6, 32768, v10
    s_mov_b32 s30, 0
L_at7_h1:
    ds_read_b128 v[168:171], v6
    ds_read_b128 v[172:175], v6 offset:1024
    s_waitcnt lgkmcnt(0)
    v_mfma_f32_32x32x16_bf16 v[152:167], v[168:171], v[16:19], v[72:87]
    v_mfma_f32_32x32x16_bf16 v[152:167], v[172:175], v[20:23], v[152:167]
    s_nop 15
    v_max3_f32 v5, v152, v153, v5
    v_max3_f32 v5, v154, v155, v5
    v_max3_f32 v5, v156, v157, v5
    v_max3_f32 v5, v158, v159, v5
    v_max3_f32 v5, v160, v161, v5
    v_max3_f32 v5, v162, v163, v5
    v_max3_f32 v5, v164, v165, v5
    v_max3_f32 v5, v166, v167, v5
    v_add_u32 v6, 4096, v6
    s_add_u32 s30, s30, 1
    s_cmp_lt_u32 s30, 8
    s_cbranch_scc1 L_at7_h1
    v_mov_b32 v6, v5
    s_nop 1
    v_permlane32_swap_b32 v5, v6
    s_nop 1
    v_max_f32 v5, v5, v6
    v_ceil_f32 v4, v5
    v_add_f32 v4, 1120403456, v4
    v_cvt_i32_f32 v3, v4
    v_sub_u32 v3, 0, v3
    v_ldexp_f32 v136, v120, v3
    v_ldexp_f32 v137, v121, v3
    v_ldexp_f32 v138, v122, v3
    v_ldexp_f32 v139, v123, v3
    v_ldexp_f32 v140, v124, v3
    v_ldexp_f32 v141, v125, v3
    v_ldexp_f32 v142, v126, v3
    v_ldexp_f32 v143, v127, v3
    v_ldexp_f32 v144, v128, v3
    v_ldexp_f32 v145, v129, v3
    v_ldexp_f32 v146, v130, v3
    v_ldexp_f32 v147, v131, v3
    v_ldexp_f32 v148, v132, v3
    v_ldexp_f32 v149, v133, v3
    v_ldexp_f32 v150, v134, v3
    v_ldexp_f32 v151, v135, v3
    v_ldexp_f32 v64, v60, v3
    v_ldexp_f32 v65, v61, v3
    v_ldexp_f32 v66, v62, v3
    v_ldexp_f32 v67, v63, v3
    v_sub_f32 v72, v72, v4
    v_sub_f32 v73, v73, v4
    v_sub_f32 v74, v74, v4
    v_sub_f32 v75, v75, v4
    v_sub_f32 v76, v76, v4
    v_sub_f32 v77, v77, v4
    v_sub_f32 v78, v78, v4
    v_sub_f32 v79, v79, v4
    v_sub_f32 v80, v80, v4
    v_sub_f32 v81, v81, v4
    v_sub_f32 v82, v82, v4
    v_sub_f32 v83, v83, v4
    v_sub_f32 v84, v84, v4
    v_sub_f32 v85, v85, v4
    v_sub_f32 v86, v86, v4
    v_sub_f32 v87, v87, v4
    v_sub_f32 v88, v88, v4
    v_sub_f32 v89, v89, v4
    v_sub_f32 v90, v90, v4
    v_sub_f32 v91, v91, v4
    v_sub_f32 v92, v92, v4
    v_sub_f32 v93, v93, v4
    v_sub_f32 v94, v94, v4
    v_sub_f32 v95, v95, v4
    v_sub_f32 v96, v96, v4
    v_sub_f32 v97, v97, v4
    v_sub_f32 v98, v98, v4
    v_sub_f32 v99, v99, v4
    v_sub_f32 v100, v100, v4
    v_sub_f32 v101, v101, v4
    v_sub_f32 v102, v102, v4
    v_sub_f32 v103, v103, v4
    v_add_u32 v6, 32768, v10
    s_mov_b32 s30, 0
L_at7_h2:
    ds_read_b128 v[168:171], v6
    ds_read_b128 v[172:175], v6 offset:1024
    ds_read_b128 v[176:179], v6 offset:2048
    ds_read_b128 v[180:183], v6 offset:3072
    s_waitcnt lgkmcnt(0)
    v_mfma_f32_32x32x16_bf16 v[152:167], v[168:171], v[16:19], v[72:87]
    v_mfma_f32_32x32x16_bf16 v[152:167], v[172:175], v[20:23], v[152:167]
    s_nop 15
    v_exp_f32 v152, v152
    v_exp_f32 v153, v153
    v_exp_f32 v154, v154
    v_exp_f32 v155, v155
    v_exp_f32 v156, v156
    v_exp_f32 v157, v157
    v_exp_f32 v158, v158
    v_exp_f32 v159, v159
    v_exp_f32 v160, v160
    v_exp_f32 v161, v161
    v_exp_f32 v162, v162
    v_exp_f32 v163, v163
    v_exp_f32 v164, v164
    v_exp_f32 v165, v165
    v_exp_f32 v166, v166
    v_exp_f32 v167, v167
    s_nop 0
    v_cvt_pk_bf16_f32 v184, v152, v153
    v_cvt_pk_bf16_f32 v185, v154, v155
    v_cvt_pk_bf16_f32 v186, v156, v157
    v_cvt_pk_bf16_f32 v187, v158, v159
    v_cvt_pk_bf16_f32 v188, v160, v161
    v_cvt_pk_bf16_f32 v189, v162, v163
    v_cvt_pk_bf16_f32 v190, v164, v165
    v_cvt_pk_bf16_f32 v191, v166, v167
    s_nop 1
    v_mfma_f32_32x32x16_bf16 v[136:151], v[176:179], v[184:187], v[136:151]
    v_mfma_f32_32x32x16_bf16 v[136:151], v[180:183], v[188:191], v[136:151]
    v_mfma_f32_16x16x32_bf16 v[64:67], v[56:59], v[184:187], v[64:67]
    v_mfma_f32_16x16x32_bf16 v[64:67], v[56:59], v[188:191], v[64:67]
    v_add_u32 v6, 4096, v6
    s_add_u32 s30, s30, 1
    s_cmp_lt_u32 s30, 8
    s_cbranch_scc1 L_at7_h2
    s_nop 7
    s_branch L_at7_ret
L_k2_end:
    s_endpgm
.globl k3_kernel
.p2align 8
.type k3_kernel,@function
k3_kernel:
    s_cmp_ge_u32 s2, 256
    s_cbranch_scc1 L_k3_end
    s_load_dwordx2 s[32:33], s[0:1], 32
    s_and_b32 s30, s2, 1
    s_and_b32 s31, s2, 2
    s_lshl_b32 s31, s31, 1
    s_or_b32 s30, s30, s31
    s_lshr_b32 s31, s2, 7
    s_lshl_b32 s31, s31, 1
    s_or_b32 s30, s30, s31
    s_and_b32 s31, s2, 0x78
    s_or_b32 s30, s30, s31
    s_and_b32 s31, s2, 4
    s_lshl_b32 s31, s31, 5
    s_or_b32 s2, s30, s31
    s_load_dwordx2 s[34:35], s[0:1], 80
    s_load_dwordx2 s[48:49], s[0:1], 96
    s_load_dwordx4 s[56:59], s[0:1], 48
    s_and_b32 s30, s2, 7
    s_lshr_b32 s31, s2, 3
    s_waitcnt lgkmcnt(0)
    s_cmp_ge_u32 s2, 128
    s_cbranch_scc1 L_k3_s2
    s_and_b32 s50, s30, 1
    s_lshl_b32 s50, s50, 2
    s_and_b32 s51, s31, 3
    s_add_u32 s50, s50, s51
    s_lshr_b32 s51, s30, 1
    s_lshl_b32 s51, s51, 2
    s_lshr_b32 s52, s31, 2
    s_add_u32 s51, s51, s52
    s_mov_b32 s4, s32
    s_mov_b32 s5, s33
    s_mov_b32 s6, 2097152
    s_mov_b32 s7, 0x00020000
    s_add_u32 s8, s48, 16777216
    s_addc_u32 s9, s49, 0
    s_mov_b32 s10, 4194304
    s_mov_b32 s11, 0x00020000
    s_mov_b32 s12, s34
    s_mov_b32 s13, s35
    s_mov_b32 s14, 8388608
    s_mov_b32 s15, 0x00020000
    s_lshl_b32 s16, s50, 8
    s_lshl_b32 s17, s51, 18
    s_lshl_b32 s21, s51, 19
    s_add_u32 s21, s21, s16
    v_lshrrev_b32 v1, 6, v0
    s_nop 0
    v_readfirstlane_b32 s22, v1
    v_and_b32 v2, 63, v0
    s_nop 2
    s_lshl_b32 s18, s22, 10
    s_lshr_b32 s24, s22, 2
    s_and_b32 s25, s22, 1
    s_lshr_b32 s26, s22, 1
    s_and_b32 s26, s26, 1
    v_lshrrev_b32 v3, 4, v2
    v_lshl_add_u32 v3, v1, 2, v3
    v_and_b32 v5, 15, v2
    v_lshrrev_b32 v6, 2, v5
    v_and_b32 v4, 3, v3
    v_xor_b32 v6, v6, v4
    v_and_b32 v5, 3, v5
    v_lshlrev_b32 v5, 4, v5
    v_lshl_add_u32 v5, v6, 6, v5
    s_mov_b32 s23, 2048
    v_mul_lo_u32 v3, v3, s23
    v_add_u32 v48, v3, v5
    v_add_u32 v49, 65536, v48
    v_lshrrev_b32 v3, 3, v2
    v_lshl_add_u32 v3, v1, 3, v3
    v_bfe_u32 v4, v3, 1, 3
    v_and_b32 v5, 7, v2
    v_xor_b32 v4, v4, v5
    v_lshlrev_b32 v4, 4, v4
    s_mov_b32 s23, 2048
    v_mul_lo_u32 v3, v3, s23
    v_add_u32 v50, v3, v4
    v_add_u32 v51, 131072, v50
    s_add_u32 m0, s18, 0
    s_nop 0
    buffer_load_dwordx4 v48, s[4:7], s16 offen lds
    s_add_u32 m0, s18, 8192
    s_nop 0
    buffer_load_dwordx4 v49, s[4:7], s16 offen lds
    s_add_u32 m0, s18, 16384
    s_nop 0
    buffer_load_dwordx4 v50, s[8:11], s17 offen lds
    s_add_u32 m0, s18, 24576
    s_nop 0
    buffer_load_dwordx4 v51, s[8:11], s17 offen lds
    s_add_u32 s16, s16, 131072
    s_add_u32 s17, s17, 128
    s_add_u32 m0, s18, 32768
    s_nop 0
    buffer_load_dwordx4 v48, s[4:7], s16 offen lds
    s_add_u32 m0, s18, 40960
    s_nop 0
    buffer_load_dwordx4 v49, s[4:7], s16 offen lds
    s_add_u32 m0, s18, 49152
    s_nop 0
    buffer_load_dwordx4 v50, s[8:11], s17 offen lds
    s_add_u32 m0, s18, 57344
    s_nop 0
    buffer_load_dwordx4 v51, s[8:11], s17 offen lds
    s_add_u32 s16, s16, 131072
    s_add_u32 s17, s17, 128
    s_add_u32 m0, s18, 65536
    s_nop 0
    buffer_load_dwordx4 v48, s[4:7], s16 offen lds
    s_add_u32 m0, s18, 73728
    s_nop 0
    buffer_load_dwordx4 v49, s[4:7], s16 offen lds
    s_add_u32 m0, s18, 81920
    s_nop 0
    buffer_load_dwordx4 v50, s[8:11], s17 offen lds
    s_add_u32 m0, s18, 90112
    s_nop 0
    buffer_load_dwordx4 v51, s[8:11], s17 offen lds
    s_add_u32 s16, s16, 131072
    s_add_u32 s17, s17, 128
    s_mul_i32 s27, s24, 4
    s_lshl_b32 s28, s25, 1
    s_mul_i32 s29, s24, 8192
    v_bfe_u32 v3, v2, 2, 2
    v_lshrrev_b32 v4, 5, v2
    v_lshl_add_u32 v4, v4, 3, v3
    s_mov_b32 s23, 256
    v_mul_lo_u32 v4, v4, s23
    v_add_u32 v4, s29, v4
    v_bfe_u32 v5, v2, 4, 1
    v_lshl_add_u32 v4, v5, 5, v4
    v_and_b32 v5, 3, v2
    v_lshl_add_u32 v4, v5, 3, v4
    s_add_u32 s23, s28, 0
    v_xor_b32 v5, s23, v3
    v_lshl_add_u32 v5, v5, 6, v4
    v_add_u32 v128, 0, v5
    v_add_u32 v132, 32768, v5
    v_add_u32 v136, 65536, v5
    v_add_u32 v140, 98304, v5
    s_add_u32 s23, s28, 1
    v_xor_b32 v5, s23, v3
    v_lshl_add_u32 v5, v5, 6, v4
    v_add_u32 v129, 0, v5
    v_add_u32 v133, 32768, v5
    v_add_u32 v137, 65536, v5
    v_add_u32 v141, 98304, v5
    s_lshl_b32 s28, s26, 6
    v_and_b32 v3, 31, v2
    v_bfe_u32 v4, v3, 1, 3
    v_lshrrev_b32 v5, 5, v2
    v_xor_b32 v4, v4, v5
    v_xor_b32 v4, s27, v4
    v_add_u32 v3, s28, v3
    v_lshlrev_b32 v3, 7, v3
    v_lshl_add_u32 v3, v4, 4, v3
    v_add_u32 v130, 16384, v3
    v_xor_b32 v131, 32, v130
    v_add_u32 v134, 49152, v3
    v_xor_b32 v135, 32, v134
    v_add_u32 v138, 81920, v3
    v_xor_b32 v139, 32, v138
    v_add_u32 v142, 114688, v3
    v_xor_b32 v143, 32, v142
    v_mov_b32 v64, 0
    v_mov_b32 v65, 0
    v_mov_b32 v66, 0
    v_mov_b32 v67, 0
    v_mov_b32 v68, 0
    v_mov_b32 v69, 0
    v_mov_b32 v70, 0
    v_mov_b32 v71, 0
    v_mov_b32 v72, 0
    v_mov_b32 v73, 0
    v_mov_b32 v74, 0
    v_mov_b32 v75, 0
    v_mov_b32 v76, 0
    v_mov_b32 v77, 0
    v_mov_b32 v78, 0
    v_mov_b32 v79, 0
    v_mov_b32 v80, 0
    v_mov_b32 v81, 0
    v_mov_b32 v82, 0
    v_mov_b32 v83, 0
    v_mov_b32 v84, 0
    v_mov_b32 v85, 0
    v_mov_b32 v86, 0
    v_mov_b32 v87, 0
    v_mov_b32 v88, 0
    v_mov_b32 v89, 0
    v_mov_b32 v90, 0
    v_mov_b32 v91, 0
    v_mov_b32 v92, 0
    v_mov_b32 v93, 0
    v_mov_b32 v94, 0
    v_mov_b32 v95, 0
    v_mov_b32 v96, 0
    v_mov_b32 v97, 0
    v_mov_b32 v98, 0
    v_mov_b32 v99, 0
    v_mov_b32 v100, 0
    v_mov_b32 v101, 0
    v_mov_b32 v102, 0
    v_mov_b32 v103, 0
    v_mov_b32 v104, 0
    v_mov_b32 v105, 0
    v_mov_b32 v106, 0
    v_mov_b32 v107, 0
    v_mov_b32 v108, 0
    v_mov_b32 v109, 0
    v_mov_b32 v110, 0
    v_mov_b32 v111, 0
    v_mov_b32 v112, 0
    v_mov_b32 v113, 0
    v_mov_b32 v114, 0
    v_mov_b32 v115, 0
    v_mov_b32 v116, 0
    v_mov_b32 v117, 0
    v_mov_b32 v118, 0
    v_mov_b32 v119, 0
    v_mov_b32 v120, 0
    v_mov_b32 v121, 0
    v_mov_b32 v122, 0
    v_mov_b32 v123, 0
    v_mov_b32 v124, 0
    v_mov_b32 v125, 0
    v_mov_b32 v126, 0
    v_mov_b32 v127, 0
    s_waitcnt vmcnt(8)
    s_barrier
    ds_read_b64_tr_b16 v[16:17], v128 offset:0
    ds_read_b64_tr_b16 v[18:19], v128 offset:1024
    ds_read_b64_tr_b16 v[20:21], v129 offset:0
    ds_read_b64_tr_b16 v[22:23], v129 offset:1024
    ds_read_b128 v[24:27], v130 offset:0
    ds_read_b128 v[28:31], v130 offset:4096
    ds_read_b64_tr_b16 v[32:33], v128 offset:4096
    ds_read_b64_tr_b16 v[34:35], v128 offset:5120
    ds_read_b64_tr_b16 v[36:37], v129 offset:4096
    ds_read_b64_tr_b16 v[38:39], v129 offset:5120
    ds_read_b128 v[40:43], v131 offset:0
    ds_read_b128 v[44:47], v131 offset:4096
    s_waitcnt lgkmcnt(6)
    v_mfma_f32_32x32x16_bf16 v[64:79], v[16:19], v[24:27], v[64:79]
    s_add_u32 m0, s18, 98304
    s_nop 0
    buffer_load_dwordx4 v48, s[4:7], s16 offen lds
    v_mfma_f32_32x32x16_bf16 v[80:95], v[20:23], v[24:27], v[80:95]
    s_add_u32 m0, s18, 106496
    s_nop 0
    buffer_load_dwordx4 v49, s[4:7], s16 offen lds
    v_mfma_f32_32x32x16_bf16 v[96:111], v[16:19], v[28:31], v[96:111]
    v_mfma_f32_32x32x16_bf16 v[112:127], v[20:23], v[28:31], v[112:127]
    s_add_u32 m0, s18, 114688
    s_nop 0
    buffer_load_dwordx4 v50, s[8:11], s17 offen lds
    s_waitcnt lgkmcnt(0)
    v_mfma_f32_32x32x16_bf16 v[64:79], v[32:35], v[40:43], v[64:79]
    s_add_u32 m0, s18, 122880
    s_nop 0
    buffer_load_dwordx4 v51, s[8:11], s17 offen lds
    v_mfma_f32_32x32x16_bf16 v[80:95], v[36:39], v[40:43], v[80:95]
    s_add_u32 s16, s16, 131072
    s_add_u32 s17, s17, 128
    s_waitcnt vmcnt(8)
    s_barrier
    ds_read_b64_tr_b16 v[16:17], v132 offset:0
    ds_read_b64_tr_b16 v[18:19], v132 offset:1024
    ds_read_b64_tr_b16 v[20:21], v133 offset:0
    ds_read_b64_tr_b16 v[22:23], v133 offset:1024
    ds_read_b128 v[24:27], v134 offset:0
    ds_read_b128 v[28:31], v134 offset:4096
    v_mfma_f32_32x32x16_bf16 v[96:111], v[32:35], v[44:47], v[96:111]
    v_mfma_f32_32x32x16_bf16 v[112:127], v[36:39], v[44:47], v[112:127]
    ds_read_b64_tr_b16 v[32:33], v132 offset:4096
    ds_read_b64_tr_b16 v[34:35], v132 offset:5120
    ds_read_b64_tr_b16 v[36:37], v133 offset:4096
    ds_read_b64_tr_b16 v[38:39], v133 offset:5120
    ds_read_b128 v[40:43], v135 offset:0
    ds_read_b128 v[44:47], v135 offset:4096
    s_waitcnt lgkmcnt(6)
    v_mfma_f32_32x32x16_bf16 v[64:79], v[16:19], v[24:27], v[64:79]
    s_add_u32 m0, s18, 0
    s_nop 0
    buffer_load_dwordx4 v48, s[4:7], s16 offen lds
    v_mfma_f32_32x32x16_bf16 v[80:95], v[20:23], v[24:27], v[80:95]
    s_add_u32 m0, s18, 8192
    s_nop 0
    buffer_load_dwordx4 v49, s[4:7], s16 offen lds
    v_mfma_f32_32x32x16_bf16 v[96:111], v[16:19], v[28:31], v[96:111]
    v_mfma_f32_32x32x16_bf16 v[112:127], v[20:23], v[28:31], v[112:127]
    s_add_u32 m0, s18, 16384
    s_nop 0
    buffer_load_dwordx4 v50, s[8:11], s17 offen lds
    s_waitcnt lgkmcnt(0)
    v_mfma_f32_32x32x16_bf16 v[64:79], v[32:35], v[40:43], v[64:79]
    s_add_u32 m0, s18, 24576
    s_nop 0
    buffer_load_dwordx4 v51, s[8:11], s17 offen lds
    v_mfma_f32_32x32x16_bf16 v[80:95], v[36:39], v[40:43], v[80:95]
    s_add_u32 s16, s16, 131072
    s_add_u32 s17, s17, 128
    s_waitcnt vmcnt(8)
    s_barrier
    ds_read_b64_tr_b16 v[16:17], v136 offset:0
    ds_read_b64_tr_b16 v[18:19], v136 offset:1024
    ds_read_b64_tr_b16 v[20:21], v137 offset:0
    ds_read_b64_tr_b16 v[22:23], v137 offset:1024
    ds_read_b128 v[24:27], v138 offset:0
    ds_read_b128 v[28:31], v138 offset:4096
    v_mfma_f32_32x32x16_bf16 v[96:111], v[32:35], v[44:47], v[96:111]
    v_mfma_f32_32x32x16_bf16 v[112:127], v[36:39], v[44:47], v[112:127]
    ds_read_b64_tr_b16 v[32:33], v136 offset:4096
    ds_read_b64_tr_b16 v[34:35], v136 offset:5120
    ds_read_b64_tr_b16 v[36:37], v137 offset:4096
    ds_read_b64_tr_b16 v[38:39], v137 offset:5120
    ds_read_b128 v[40:43], v139 offset:0
    ds_read_b128 v[44:47], v139 offset:4096
    s_waitcnt lgkmcnt(6)
    v_mfma_f32_32x32x16_bf16 v[64:79], v[16:19], v[24:27], v[64:79]
    s_add_u32 m0, s18, 32768
    s_nop 0
    buffer_load_dwordx4 v48, s[4:7], s16 offen lds
    v_mfma_f32_32x32x16_bf16 v[80:95], v[20:23], v[24:27], v[80:95]
    s_add_u32 m0, s18, 40960
    s_nop 0
    buffer_load_dwordx4 v49, s[4:7], s16 offen lds
    v_mfma_f32_32x32x16_bf16 v[96:111], v[16:19], v[28:31], v[96:111]
    v_mfma_f32_32x32x16_bf16 v[112:127], v[20:23], v[28:31], v[112:127]
    s_add_u32 m0, s18, 49152
    s_nop 0
    buffer_load_dwordx4 v50, s[8:11], s17 offen lds
    s_waitcnt lgkmcnt(0)
    v_mfma_f32_32x32x16_bf16 v[64:79], v[32:35], v[40:43], v[64:79]
    s_add_u32 m0, s18, 57344
    s_nop 0
    buffer_load_dwordx4 v51, s[8:11], s17 offen lds
    v_mfma_f32_32x32x16_bf16 v[80:95], v[36:39], v[40:43], v[80:95]
    s_add_u32 s16, s16, 131072
    s_add_u32 s17, s17, 128
    s_waitcnt vmcnt(8)
    s_barrier
    ds_read_b64_tr_b16 v[16:17], v140 offset:0
    ds_read_b64_tr_b16 v[18:19], v140 offset:1024
    ds_read_b64_tr_b16 v[20:21], v141 offset:0
    ds_read_b64_tr_b16 v[22:23], v141 offset:1024
    ds_read_b128 v[24:27], v142 offset:0
    ds_read_b128 v[28:31], v142 offset:4096
    v_mfma_f32_32x32x16_bf16 v[96:111], v[32:35], v[44:47], v[96:111]
    v_mfma_f32_32x32x16_bf16 v[112:127], v[36:39], v[44:47], v[112:127]
    ds_read_b64_tr_b16 v[32:33], v140 offset:4096
    ds_read_b64_tr_b16 v[34:35], v140 offset:5120
    ds_read_b64_tr_b16 v[36:37], v141 offset:4096
    ds_read_b64_tr_b16 v[38:39], v141 offset:5120
    ds_read_b128 v[40:43], v143 offset:0
    ds_read_b128 v[44:47], v143 offset:4096
    s_waitcnt lgkmcnt(6)
    v_mfma_f32_32x32x16_bf16 v[64:79], v[16:19], v[24:27], v[64:79]
    s_add_u32 m0, s18, 65536
    s_nop 0
    buffer_load_dwordx4 v48, s[4:7], s16 offen lds
    v_mfma_f32_32x32x16_bf16 v[80:95], v[20:23], v[24:27], v[80:95]
    s_add_u32 m0, s18, 73728
    s_nop 0
    buffer_load_dwordx4 v49, s[4:7], s16 offen lds
    v_mfma_f32_32x32x16_bf16 v[96:111], v[16:19], v[28:31], v[96:111]
    v_mfma_f32_32x32x16_bf16 v[112:127], v[20:23], v[28:31], v[112:127]
    s_add_u32 m0, s18, 81920
    s_nop 0
    buffer_load_dwordx4 v50, s[8:11], s17 offen lds
    s_waitcnt lgkmcnt(0)
    v_mfma_f32_32x32x16_bf16 v[64:79], v[32:35], v[40:43], v[64:79]
    s_add_u32 m0, s18, 90112
    s_nop 0
    buffer_load_dwordx4 v51, s[8:11], s17 offen lds
    v_mfma_f32_32x32x16_bf16 v[80:95], v[36:39], v[40:43], v[80:95]
    s_add_u32 s16, s16, 131072
    s_add_u32 s17, s17, 128
    s_waitcnt vmcnt(8)
    s_barrier
    ds_read_b64_tr_b16 v[16:17], v128 offset:0
    ds_read_b64_tr_b16 v[18:19], v128 offset:1024
    ds_read_b64_tr_b16 v[20:21], v129 offset:0
    ds_read_b64_tr_b16 v[22:23], v129 offset:1024
    ds_read_b128 v[24:27], v130 offset:0
    ds_read_b128 v[28:31], v130 offset:4096
    v_mfma_f32_32x32x16_bf16 v[96:111], v[32:35], v[44:47], v[96:111]
    v_mfma_f32_32x32x16_bf16 v[112:127], v[36:39], v[44:47], v[112:127]
    ds_read_b64_tr_b16 v[32:33], v128 offset:4096
    ds_read_b64_tr_b16 v[34:35], v128 offset:5120
    ds_read_b64_tr_b16 v[36:37], v129 offset:4096
    ds_read_b64_tr_b16 v[38:39], v129 offset:5120
    ds_read_b128 v[40:43], v131 offset:0
    ds_read_b128 v[44:47], v131 offset:4096
    s_waitcnt lgkmcnt(6)
    v_mfma_f32_32x32x16_bf16 v[64:79], v[16:19], v[24:27], v[64:79]
    s_add_u32 m0, s18, 98304
    s_nop 0
    buffer_load_dwordx4 v48, s[4:7], s16 offen lds
    v_mfma_f32_32x32x16_bf16 v[80:95], v[20:23], v[24:27], v[80:95]
    s_add_u32 m0, s18, 106496
    s_nop 0
    buffer_load_dwordx4 v49, s[4:7], s16 offen lds
    v_mfma_f32_32x32x16_bf16 v[96:111], v[16:19], v[28:31], v[96:111]
    v_mfma_f32_32x32x16_bf16 v[112:127], v[20:23], v[28:31], v[112:127]
    s_add_u32 m0, s18, 114688
    s_nop 0
    buffer_load_dwordx4 v50, s[8:11], s17 offen lds
    s_waitcnt lgkmcnt(0)
    v_mfma_f32_32x32x16_bf16 v[64:79], v[32:35], v[40:43], v[64:79]
    s_add_u32 m0, s18, 122880
    s_nop 0
    buffer_load_dwordx4 v51, s[8:11], s17 offen lds
    v_mfma_f32_32x32x16_bf16 v[80:95], v[36:39], v[40:43], v[80:95]
    s_add_u32 s16, s16, 131072
    s_add_u32 s17, s17, 128
    s_waitcnt vmcnt(8)
    s_barrier
    ds_read_b64_tr_b16 v[16:17], v132 offset:0
    ds_read_b64_tr_b16 v[18:19], v132 offset:1024
    ds_read_b64_tr_b16 v[20:21], v133 offset:0
    ds_read_b64_tr_b16 v[22:23], v133 offset:1024
    ds_read_b128 v[24:27], v134 offset:0
    ds_read_b128 v[28:31], v134 offset:4096
    v_mfma_f32_32x32x16_bf16 v[96:111], v[32:35], v[44:47], v[96:111]
    v_mfma_f32_32x32x16_bf16 v[112:127], v[36:39], v[44:47], v[112:127]
    ds_read_b64_tr_b16 v[32:33], v132 offset:4096
    ds_read_b64_tr_b16 v[34:35], v132 offset:5120
    ds_read_b64_tr_b16 v[36:37], v133 offset:4096
    ds_read_b64_tr_b16 v[38:39], v133 offset:5120
    ds_read_b128 v[40:43], v135 offset:0
    ds_read_b128 v[44:47], v135 offset:4096
    s_waitcnt lgkmcnt(6)
    v_mfma_f32_32x32x16_bf16 v[64:79], v[16:19], v[24:27], v[64:79]
    s_add_u32 m0, s18, 0
    s_nop 0
    buffer_load_dwordx4 v48, s[4:7], s16 offen lds
    v_mfma_f32_32x32x16_bf16 v[80:95], v[20:23], v[24:27], v[80:95]
    s_add_u32 m0, s18, 8192
    s_nop 0
    buffer_load_dwordx4 v49, s[4:7], s16 offen lds
    v_mfma_f32_32x32x16_bf16 v[96:111], v[16:19], v[28:31], v[96:111]
    v_mfma_f32_32x32x16_bf16 v[112:127], v[20:23], v[28:31], v[112:127]
    s_add_u32 m0, s18, 16384
    s_nop 0
    buffer_load_dwordx4 v50, s[8:11], s17 offen lds
    s_waitcnt lgkmcnt(0)
    v_mfma_f32_32x32x16_bf16 v[64:79], v[32:35], v[40:43], v[64:79]
    s_add_u32 m0, s18, 24576
    s_nop 0
    buffer_load_dwordx4 v51, s[8:11], s17 offen lds
    v_mfma_f32_32x32x16_bf16 v[80:95], v[36:39], v[40:43], v[80:95]
    s_add_u32 s16, s16, 131072
    s_add_u32 s17, s17, 128
    s_waitcnt vmcnt(8)
    s_barrier
    ds_read_b64_tr_b16 v[16:17], v136 offset:0
    ds_read_b64_tr_b16 v[18:19], v136 offset:1024
    ds_read_b64_tr_b16 v[20:21], v137 offset:0
    ds_read_b64_tr_b16 v[22:23], v137 offset:1024
    ds_read_b128 v[24:27], v138 offset:0
    ds_read_b128 v[28:31], v138 offset:4096
    v_mfma_f32_32x32x16_bf16 v[96:111], v[32:35], v[44:47], v[96:111]
    v_mfma_f32_32x32x16_bf16 v[112:127], v[36:39], v[44:47], v[112:127]
    ds_read_b64_tr_b16 v[32:33], v136 offset:4096
    ds_read_b64_tr_b16 v[34:35], v136 offset:5120
    ds_read_b64_tr_b16 v[36:37], v137 offset:4096
    ds_read_b64_tr_b16 v[38:39], v137 offset:5120
    ds_read_b128 v[40:43], v139 offset:0
    ds_read_b128 v[44:47], v139 offset:4096
    s_waitcnt lgkmcnt(6)
    v_mfma_f32_32x32x16_bf16 v[64:79], v[16:19], v[24:27], v[64:79]
    s_add_u32 m0, s18, 32768
    s_nop 0
    buffer_load_dwordx4 v48, s[4:7], s16 offen lds
    v_mfma_f32_32x32x16_bf16 v[80:95], v[20:23], v[24:27], v[80:95]
    s_add_u32 m0, s18, 40960
    s_nop 0
    buffer_load_dwordx4 v49, s[4:7], s16 offen lds
    v_mfma_f32_32x32x16_bf16 v[96:111], v[16:19], v[28:31], v[96:111]
    v_mfma_f32_32x32x16_bf16 v[112:127], v[20:23], v[28:31], v[112:127]
    s_add_u32 m0, s18, 49152
    s_nop 0
    buffer_load_dwordx4 v50, s[8:11], s17 offen lds
    s_waitcnt lgkmcnt(0)
    v_mfma_f32_32x32x16_bf16 v[64:79], v[32:35], v[40:43], v[64:79]
    s_add_u32 m0, s18, 57344
    s_nop 0
    buffer_load_dwordx4 v51, s[8:11], s17 offen lds
    v_mfma_f32_32x32x16_bf16 v[80:95], v[36:39], v[40:43], v[80:95]
    s_add_u32 s16, s16, 131072
    s_add_u32 s17, s17, 128
    s_waitcnt vmcnt(8)
    s_barrier
    ds_read_b64_tr_b16 v[16:17], v140 offset:0
    ds_read_b64_tr_b16 v[18:19], v140 offset:1024
    ds_read_b64_tr_b16 v[20:21], v141 offset:0
    ds_read_b64_tr_b16 v[22:23], v141 offset:1024
    ds_read_b128 v[24:27], v142 offset:0
    ds_read_b128 v[28:31], v142 offset:4096
    v_mfma_f32_32x32x16_bf16 v[96:111], v[32:35], v[44:47], v[96:111]
    v_mfma_f32_32x32x16_bf16 v[112:127], v[36:39], v[44:47], v[112:127]
    ds_read_b64_tr_b16 v[32:33], v140 offset:4096
    ds_read_b64_tr_b16 v[34:35], v140 offset:5120
    ds_read_b64_tr_b16 v[36:37], v141 offset:4096
    ds_read_b64_tr_b16 v[38:39], v141 offset:5120
    ds_read_b128 v[40:43], v143 offset:0
    ds_read_b128 v[44:47], v143 offset:4096
    s_waitcnt lgkmcnt(6)
    v_mfma_f32_32x32x16_bf16 v[64:79], v[16:19], v[24:27], v[64:79]
    s_add_u32 m0, s18, 65536
    s_nop 0
    buffer_load_dwordx4 v48, s[4:7], s16 offen lds
    v_mfma_f32_32x32x16_bf16 v[80:95], v[20:23], v[24:27], v[80:95]
    s_add_u32 m0, s18, 73728
    s_nop 0
    buffer_load_dwordx4 v49, s[4:7], s16 offen lds
    v_mfma_f32_32x32x16_bf16 v[96:111], v[16:19], v[28:31], v[96:111]
    v_mfma_f32_32x32x16_bf16 v[112:127], v[20:23], v[28:31], v[112:127]
    s_add_u32 m0, s18, 81920
    s_nop 0
    buffer_load_dwordx4 v50, s[8:11], s17 offen lds
    s_waitcnt lgkmcnt(0)
    v_mfma_f32_32x32x16_bf16 v[64:79], v[32:35], v[40:43], v[64:79]
    s_add_u32 m0, s18, 90112
    s_nop 0
    buffer_load_dwordx4 v51, s[8:11], s17 offen lds
    v_mfma_f32_32x32x16_bf16 v[80:95], v[36:39], v[40:43], v[80:95]
    s_add_u32 s16, s16, 131072
    s_add_u32 s17, s17, 128
    s_waitcnt vmcnt(8)
    s_barrier
    ds_read_b64_tr_b16 v[16:17], v128 offset:0
    ds_read_b64_tr_b16 v[18:19], v128 offset:1024
    ds_read_b64_tr_b16 v[20:21], v129 offset:0
    ds_read_b64_tr_b16 v[22:23], v129 offset:1024
    ds_read_b128 v[24:27], v130 offset:0
    ds_read_b128 v[28:31], v130 offset:4096
    v_mfma_f32_32x32x16_bf16 v[96:111], v[32:35], v[44:47], v[96:111]
    v_mfma_f32_32x32x16_bf16 v[112:127], v[36:39], v[44:47], v[112:127]
    ds_read_b64_tr_b16 v[32:33], v128 offset:4096
    ds_read_b64_tr_b16 v[34:35], v128 offset:5120
    ds_read_b64_tr_b16 v[36:37], v129 offset:4096
    ds_read_b64_tr_b16 v[38:39], v129 offset:5120
    ds_read_b128 v[40:43], v131 offset:0
    ds_read_b128 v[44:47], v131 offset:4096
    s_waitcnt lgkmcnt(6)
    v_mfma_f32_32x32x16_bf16 v[64:79], v[16:19], v[24:27], v[64:79]
    s_add_u32 m0, s18, 98304
    s_nop 0
    buffer_load_dwordx4 v48, s[4:7], s16 offen lds
    v_mfma_f32_32x32x16_bf16 v[80:95], v[20:23], v[24:27], v[80:95]
    s_add_u32 m0, s18, 106496
    s_nop 0
    buffer_load_dwordx4 v49, s[4:7], s16 offen lds
    v_mfma_f32_32x32x16_bf16 v[96:111], v[16:19], v[28:31], v[96:111]
    v_mfma_f32_32x32x16_bf16 v[112:127], v[20:23], v[28:31], v[112:127]
    s_add_u32 m0, s18, 114688
    s_nop 0
    buffer_load_dwordx4 v50, s[8:11], s17 offen lds
    s_waitcnt lgkmcnt(0)
    v_mfma_f32_32x32x16_bf16 v[64:79], v[32:35], v[40:43], v[64:79]
    s_add_u32 m0, s18, 122880
    s_nop 0
    buffer_load_dwordx4 v51, s[8:11], s17 offen lds
    v_mfma_f32_32x32x16_bf16 v[80:95], v[36:39], v[40:43], v[80:95]
    s_add_u32 s16, s16, 131072
    s_add_u32 s17, s17, 128
    s_waitcnt vmcnt(8)
    s_barrier
    ds_read_b64_tr_b16 v[16:17], v132 offset:0
    ds_read_b64_tr_b16 v[18:19], v132 offset:1024
    ds_read_b64_tr_b16 v[20:21], v133 offset:0
    ds_read_b64_tr_b16 v[22:23], v133 offset:1024
    ds_read_b128 v[24:27], v134 offset:0
    ds_read_b128 v[28:31], v134 offset:4096
    v_mfma_f32_32x32x16_bf16 v[96:111], v[32:35], v[44:47], v[96:111]
    v_mfma_f32_32x32x16_bf16 v[112:127], v[36:39], v[44:47], v[112:127]
    ds_read_b64_tr_b16 v[32:33], v132 offset:4096
    ds_read_b64_tr_b16 v[34:35], v132 offset:5120
    ds_read_b64_tr_b16 v[36:37], v133 offset:4096
    ds_read_b64_tr_b16 v[38:39], v133 offset:5120
    ds_read_b128 v[40:43], v135 offset:0
    ds_read_b128 v[44:47], v135 offset:4096
    s_waitcnt lgkmcnt(6)
    v_mfma_f32_32x32x16_bf16 v[64:79], v[16:19], v[24:27], v[64:79]
    s_add_u32 m0, s18, 0
    s_nop 0
    buffer_load_dwordx4 v48, s[4:7], s16 offen lds
    v_mfma_f32_32x32x16_bf16 v[80:95], v[20:23], v[24:27], v[80:95]
    s_add_u32 m0, s18, 8192
    s_nop 0
    buffer_load_dwordx4 v49, s[4:7], s16 offen lds
    v_mfma_f32_32x32x16_bf16 v[96:111], v[16:19], v[28:31], v[96:111]
    v_mfma_f32_32x32x16_bf16 v[112:127], v[20:23], v[28:31], v[112:127]
    s_add_u32 m0, s18, 16384
    s_nop 0
    buffer_load_dwordx4 v50, s[8:11], s17 offen lds
    s_waitcnt lgkmcnt(0)
    v_mfma_f32_32x32x16_bf16 v[64:79], v[32:35], v[40:43], v[64:79]
    s_add_u32 m0, s18, 24576
    s_nop 0
    buffer_load_dwordx4 v51, s[8:11], s17 offen lds
    v_mfma_f32_32x32x16_bf16 v[80:95], v[36:39], v[40:43], v[80:95]
    s_add_u32 s16, s16, 131072
    s_add_u32 s17, s17, 128
    s_waitcnt vmcnt(8)
    s_barrier
    ds_read_b64_tr_b16 v[16:17], v136 offset:0
    ds_read_b64_tr_b16 v[18:19], v136 offset:1024
    ds_read_b64_tr_b16 v[20:21], v137 offset:0
    ds_read_b64_tr_b16 v[22:23], v137 offset:1024
    ds_read_b128 v[24:27], v138 offset:0
    ds_read_b128 v[28:31], v138 offset:4096
    v_mfma_f32_32x32x16_bf16 v[96:111], v[32:35], v[44:47], v[96:111]
    v_mfma_f32_32x32x16_bf16 v[112:127], v[36:39], v[44:47], v[112:127]
    ds_read_b64_tr_b16 v[32:33], v136 offset:4096
    ds_read_b64_tr_b16 v[34:35], v136 offset:5120
    ds_read_b64_tr_b16 v[36:37], v137 offset:4096
    ds_read_b64_tr_b16 v[38:39], v137 offset:5120
    ds_read_b128 v[40:43], v139 offset:0
    ds_read_b128 v[44:47], v139 offset:4096
    s_waitcnt lgkmcnt(6)
    v_mfma_f32_32x32x16_bf16 v[64:79], v[16:19], v[24:27], v[64:79]
    s_add_u32 m0, s18, 32768
    s_nop 0
    buffer_load_dwordx4 v48, s[4:7], s16 offen lds
    v_mfma_f32_32x32x16_bf16 v[80:95], v[20:23], v[24:27], v[80:95]
    s_add_u32 m0, s18, 40960
    s_nop 0
    buffer_load_dwordx4 v49, s[4:7], s16 offen lds
    v_mfma_f32_32x32x16_bf16 v[96:111], v[16:19], v[28:31], v[96:111]
    v_mfma_f32_32x32x16_bf16 v[112:127], v[20:23], v[28:31], v[112:127]
    s_add_u32 m0, s18, 49152
    s_nop 0
    buffer_load_dwordx4 v50, s[8:11], s17 offen lds
    s_waitcnt lgkmcnt(0)
    v_mfma_f32_32x32x16_bf16 v[64:79], v[32:35], v[40:43], v[64:79]
    s_add_u32 m0, s18, 57344
    s_nop 0
    buffer_load_dwordx4 v51, s[8:11], s17 offen lds
    v_mfma_f32_32x32x16_bf16 v[80:95], v[36:39], v[40:43], v[80:95]
    s_add_u32 s16, s16, 131072
    s_add_u32 s17, s17, 128
    s_waitcnt vmcnt(8)
    s_barrier
    ds_read_b64_tr_b16 v[16:17], v140 offset:0
    ds_read_b64_tr_b16 v[18:19], v140 offset:1024
    ds_read_b64_tr_b16 v[20:21], v141 offset:0
    ds_read_b64_tr_b16 v[22:23], v141 offset:1024
    ds_read_b128 v[24:27], v142 offset:0
    ds_read_b128 v[28:31], v142 offset:4096
    v_mfma_f32_32x32x16_bf16 v[96:111], v[32:35], v[44:47], v[96:111]
    v_mfma_f32_32x32x16_bf16 v[112:127], v[36:39], v[44:47], v[112:127]
    ds_read_b64_tr_b16 v[32:33], v140 offset:4096
    ds_read_b64_tr_b16 v[34:35], v140 offset:5120
    ds_read_b64_tr_b16 v[36:37], v141 offset:4096
    ds_read_b64_tr_b16 v[38:39], v141 offset:5120
    ds_read_b128 v[40:43], v143 offset:0
    ds_read_b128 v[44:47], v143 offset:4096
    s_waitcnt lgkmcnt(6)
    v_mfma_f32_32x32x16_bf16 v[64:79], v[16:19], v[24:27], v[64:79]
    s_add_u32 m0, s18, 65536
    s_nop 0
    buffer_load_dwordx4 v48, s[4:7], s16 offen lds
    v_mfma_f32_32x32x16_bf16 v[80:95], v[20:23], v[24:27], v[80:95]
    s_add_u32 m0, s18, 73728
    s_nop 0
    buffer_load_dwordx4 v49, s[4:7], s16 offen lds
    v_mfma_f32_32x32x16_bf16 v[96:111], v[16:19], v[28:31], v[96:111]
    v_mfma_f32_32x32x16_bf16 v[112:127], v[20:23], v[28:31], v[112:127]
    s_add_u32 m0, s18, 81920
    s_nop 0
    buffer_load_dwordx4 v50, s[8:11], s17 offen lds
    s_waitcnt lgkmcnt(0)
    v_mfma_f32_32x32x16_bf16 v[64:79], v[32:35], v[40:43], v[64:79]
    s_add_u32 m0, s18, 90112
    s_nop 0
    buffer_load_dwordx4 v51, s[8:11], s17 offen lds
    v_mfma_f32_32x32x16_bf16 v[80:95], v[36:39], v[40:43], v[80:95]
    s_add_u32 s16, s16, 131072
    s_add_u32 s17, s17, 128
    s_waitcnt vmcnt(8)
    s_barrier
    ds_read_b64_tr_b16 v[16:17], v128 offset:0
    ds_read_b64_tr_b16 v[18:19], v128 offset:1024
    ds_read_b64_tr_b16 v[20:21], v129 offset:0
    ds_read_b64_tr_b16 v[22:23], v129 offset:1024
    ds_read_b128 v[24:27], v130 offset:0
    ds_read_b128 v[28:31], v130 offset:4096
    v_mfma_f32_32x32x16_bf16 v[96:111], v[32:35], v[44:47], v[96:111]
    v_mfma_f32_32x32x16_bf16 v[112:127], v[36:39], v[44:47], v[112:127]
    ds_read_b64_tr_b16 v[32:33], v128 offset:4096
    ds_read_b64_tr_b16 v[34:35], v128 offset:5120
    ds_read_b64_tr_b16 v[36:37], v129 offset:4096
    ds_read_b64_tr_b16 v[38:39], v129 offset:5120
    ds_read_b128 v[40:43], v131 offset:0
    ds_read_b128 v[44:47], v131 offset:4096
    s_waitcnt lgkmcnt(6)
    v_mfma_f32_32x32x16_bf16 v[64:79], v[16:19], v[24:27], v[64:79]
    s_add_u32 m0, s18, 98304
    s_nop 0
    buffer_load_dwordx4 v48, s[4:7], s16 offen lds
    v_mfma_f32_32x32x16_bf16 v[80:95], v[20:23], v[24:27], v[80:95]
    s_add_u32 m0, s18, 106496
    s_nop 0
    buffer_load_dwordx4 v49, s[4:7], s16 offen lds
    v_mfma_f32_32x32x16_bf16 v[96:111], v[16:19], v[28:31], v[96:111]
    v_mfma_f32_32x32x16_bf16 v[112:127], v[20:23], v[28:31], v[112:127]
    s_add_u32 m0, s18, 114688
    s_nop 0
    buffer_load_dwordx4 v50, s[8:11], s17 offen lds
    s_waitcnt lgkmcnt(0)
    v_mfma_f32_32x32x16_bf16 v[64:79], v[32:35], v[40:43], v[64:79]
    s_add_u32 m0, s18, 122880
    s_nop 0
    buffer_load_dwordx4 v51, s[8:11], s17 offen lds
    v_mfma_f32_32x32x16_bf16 v[80:95], v[36:39], v[40:43], v[80:95]
    s_add_u32 s16, s16, 131072
    s_add_u32 s17, s17, 128
    s_waitcnt vmcnt(8)
    s_barrier
    ds_read_b64_tr_b16 v[16:17], v132 offset:0
    ds_read_b64_tr_b16 v[18:19], v132 offset:1024
    ds_read_b64_tr_b16 v[20:21], v133 offset:0
    ds_read_b64_tr_b16 v[22:23], v133 offset:1024
    ds_read_b128 v[24:27], v134 offset:0
    ds_read_b128 v[28:31], v134 offset:4096
    v_mfma_f32_32x32x16_bf16 v[96:111], v[32:35], v[44:47], v[96:111]
    v_mfma_f32_32x32x16_bf16 v[112:127], v[36:39], v[44:47], v[112:127]
    ds_read_b64_tr_b16 v[32:33], v132 offset:4096
    ds_read_b64_tr_b16 v[34:35], v132 offset:5120
    ds_read_b64_tr_b16 v[36:37], v133 offset:4096
    ds_read_b64_tr_b16 v[38:39], v133 offset:5120
    ds_read_b128 v[40:43], v135 offset:0
    ds_read_b128 v[44:47], v135 offset:4096
    s_waitcnt lgkmcnt(6)
    v_mfma_f32_32x32x16_bf16 v[64:79], v[16:19], v[24:27], v[64:79]
    v_mfma_f32_32x32x16_bf16 v[80:95], v[20:23], v[24:27], v[80:95]
    v_mfma_f32_32x32x16_bf16 v[96:111], v[16:19], v[28:31], v[96:111]
    v_mfma_f32_32x32x16_bf16 v[112:127], v[20:23], v[28:31], v[112:127]
    s_waitcnt lgkmcnt(0)
    v_mfma_f32_32x32x16_bf16 v[64:79], v[32:35], v[40:43], v[64:79]
    v_mfma_f32_32x32x16_bf16 v[80:95], v[36:39], v[40:43], v[80:95]
    s_waitcnt vmcnt(4)
    s_barrier
    ds_read_b64_tr_b16 v[16:17], v136 offset:0
    ds_read_b64_tr_b16 v[18:19], v136 offset:1024
    ds_read_b64_tr_b16 v[20:21], v137 offset:0
    ds_read_b64_tr_b16 v[22:23], v137 offset:1024
    ds_read_b128 v[24:27], v138 offset:0
    ds_read_b128 v[28:31], v138 offset:4096
    v_mfma_f32_32x32x16_bf16 v[96:111], v[32:35], v[44:47], v[96:111]
    v_mfma_f32_32x32x16_bf16 v[112:127], v[36:39], v[44:47], v[112:127]
    ds_read_b64_tr_b16 v[32:33], v136 offset:4096
    ds_read_b64_tr_b16 v[34:35], v136 offset:5120
    ds_read_b64_tr_b16 v[36:37], v137 offset:4096
    ds_read_b64_tr_b16 v[38:39], v137 offset:5120
    ds_read_b128 v[40:43], v139 offset:0
    ds_read_b128 v[44:47], v139 offset:4096
    s_waitcnt lgkmcnt(6)
    v_mfma_f32_32x32x16_bf16 v[64:79], v[16:19], v[24:27], v[64:79]
    v_mfma_f32_32x32x16_bf16 v[80:95], v[20:23], v[24:27], v[80:95]
    v_mfma_f32_32x32x16_bf16 v[96:111], v[16:19], v[28:31], v[96:111]
    v_mfma_f32_32x32x16_bf16 v[112:127], v[20:23], v[28:31], v[112:127]
    s_waitcnt lgkmcnt(0)
    v_mfma_f32_32x32x16_bf16 v[64:79], v[32:35], v[40:43], v[64:79]
    v_mfma_f32_32x32x16_bf16 v[80:95], v[36:39], v[40:43], v[80:95]
    s_waitcnt vmcnt(0)
    s_barrier
    ds_read_b64_tr_b16 v[16:17], v140 offset:0
    ds_read_b64_tr_b16 v[18:19], v140 offset:1024
    ds_read_b64_tr_b16 v[20:21], v141 offset:0
    ds_read_b64_tr_b16 v[22:23], v141 offset:1024
    ds_read_b128 v[24:27], v142 offset:0
    ds_read_b128 v[28:31], v142 offset:4096
    v_mfma_f32_32x32x16_bf16 v[96:111], v[32:35], v[44:47], v[96:111]
    v_mfma_f32_32x32x16_bf16 v[112:127], v[36:39], v[44:47], v[112:127]
    s_mov_b32 s64, s56
    s_mov_b32 s65, s57
    s_mov_b32 s66, 8388608
    s_mov_b32 s67, 0x00020000
    s_mov_b32 s68, s48
    s_mov_b32 s69, s49
    s_mov_b32 s70, 41943040
    s_mov_b32 s71, 0x00020000
    s_lshr_b32 s74, s2, 3
    s_and_b32 s74, s74, 15
    s_and_b32 s75, s2, 7
    v_lshlrev_b32 v10, 5, v2
    v_lshlrev_b32 v11, 4, v2
    v_add_u32 v11, 2048, v11
    v_mov_b32 v3, 0x7ffffff0
    v_cmp_gt_u32 vcc, 8, v2
    s_lshl_b32 s58, s74, 6
    s_lshl_b32 s23, s75, 3
    s_add_u32 s58, s58, s23
    s_add_u32 s58, s58, s22
    v_cndmask_b32 v11, v3, v11, vcc
    s_lshl_b32 s59, s58, 12
    s_mov_b32 s60, 34668544
    s_lshl_b32 s61, s75, 6
    s_lshl_b32 s23, s74, 2
    s_add_u32 s61, s61, s23
    s_add_u32 s61, s61, s22
    s_cmp_ge_u32 s22, 4
    s_cselect_b32 s61, 512, s61
    s_mul_i32 s62, s61, 2176
    s_add_u32 s62, s62, 33554432
    s_mov_b32 s63, 4194304
    s_lshr_b32 s75, s22, 2
    s_lshl_b32 s23, s2, 3
    s_add_u32 s23, s23, s22
    s_cmp_eq_u32 s23, 4
    s_cselect_b32 s75, 0, s75
    s_cmp_lg_u32 s75, 0
    s_cselect_b32 s62, 0x7fff0000, s62
    s_cselect_b32 s63, 0x7fff0000, s63
    s_add_u32 s76, s48, 37748736
    s_addc_u32 s77, s49, 0
    s_mov_b32 s78, 2048
    s_mov_b32 s79, 0x00020000
    v_and_b32 v3, 63, v0
    v_lshlrev_b32 v3, 4, v3
    v_add_u32 v4, 4096, v3
    buffer_load_dwordx4 v[212:215], v3, s[76:79], 0 offen offset:0
    buffer_load_dwordx4 v[216:219], v3, s[76:79], 0 offen offset:1024
    buffer_load_dwordx4 v[164:167], v10, s[64:67], s59 offen
    buffer_load_dwordx4 v[168:171], v10, s[64:67], s59 offen offset:16
    buffer_load_dwordx4 v[172:175], v11, s[64:67], s59 offen
    buffer_load_dwordx4 v[176:179], v10, s[68:71], s60 offen
    buffer_load_dwordx4 v[180:183], v10, s[68:71], s60 offen offset:16
    buffer_load_dwordx4 v[184:187], v11, s[68:71], s60 offen
    buffer_load_dwordx4 v[188:191], v10, s[64:67], s63 offen
    buffer_load_dwordx4 v[192:195], v10, s[64:67], s63 offen offset:16
    buffer_load_dwordx4 v[196:199], v11, s[64:67], s63 offen
    buffer_load_dwordx4 v[200:203], v10, s[68:71], s62 offen
    buffer_load_dwordx4 v[204:207], v10, s[68:71], s62 offen offset:16
    buffer_load_dwordx4 v[208:211], v11, s[68:71], s62 offen
    ds_read_b64_tr_b16 v[32:33], v140 offset:4096
    ds_read_b64_tr_b16 v[34:35], v140 offset:5120
    ds_read_b64_tr_b16 v[36:37], v141 offset:4096
    ds_read_b64_tr_b16 v[38:39], v141 offset:5120
    ds_read_b128 v[40:43], v143 offset:0
    ds_read_b128 v[44:47], v143 offset:4096
    s_waitcnt lgkmcnt(6)
    v_mfma_f32_32x32x16_bf16 v[64:79], v[16:19], v[24:27], v[64:79]
    v_mfma_f32_32x32x16_bf16 v[80:95], v[20:23], v[24:27], v[80:95]
    v_mfma_f32_32x32x16_bf16 v[96:111], v[16:19], v[28:31], v[96:111]
    v_mfma_f32_32x32x16_bf16 v[112:127], v[20:23], v[28:31], v[112:127]
    s_waitcnt lgkmcnt(0)
    v_mfma_f32_32x32x16_bf16 v[64:79], v[32:35], v[40:43], v[64:79]
    v_mfma_f32_32x32x16_bf16 v[80:95], v[36:39], v[40:43], v[80:95]
    v_mfma_f32_32x32x16_bf16 v[96:111], v[32:35], v[44:47], v[96:111]
    v_mfma_f32_32x32x16_bf16 v[112:127], v[36:39], v[44:47], v[112:127]
    s_nop 15
    s_nop 3
    s_barrier
    v_lshlrev_b32 v3, 4, v2
    s_lshl_b32 s23, s22, 13
    v_add_u32 v3, s23, v3
    s_xor_b32 s23, s22, 4
    s_lshl_b32 s23, s23, 13
    v_lshlrev_b32 v4, 4, v2
    v_add_u32 v4, s23, v4
    s_cmp_eq_u32 s24, 0
    s_cbranch_scc1 L_g5_x0
    ds_write_b128 v3, v[64:67] offset:0
    ds_write_b128 v3, v[68:71] offset:1024
    ds_write_b128 v3, v[72:75] offset:2048
    ds_write_b128 v3, v[76:79] offset:3072
    ds_write_b128 v3, v[80:83] offset:4096
    ds_write_b128 v3, v[84:87] offset:5120
    ds_write_b128 v3, v[88:91] offset:6144
    ds_write_b128 v3, v[92:95] offset:7168
    v_mov_b32 v64, v96
    v_mov_b32 v65, v97
    v_mov_b32 v66, v98
    v_mov_b32 v67, v99
    v_mov_b32 v68, v100
    v_mov_b32 v69, v101
    v_mov_b32 v70, v102
    v_mov_b32 v71, v103
    v_mov_b32 v72, v104
    v_mov_b32 v73, v105
    v_mov_b32 v74, v106
    v_mov_b32 v75, v107
    v_mov_b32 v76, v108
    v_mov_b32 v77, v109
    v_mov_b32 v78, v110
    v_mov_b32 v79, v111
    v_mov_b32 v80, v112
    v_mov_b32 v81, v113
    v_mov_b32 v82, v114
    v_mov_b32 v83, v115
    v_mov_b32 v84, v116
    v_mov_b32 v85, v117
    v_mov_b32 v86, v118
    v_mov_b32 v87, v119
    v_mov_b32 v88, v120
    v_mov_b32 v89, v121
    v_mov_b32 v90, v122
    v_mov_b32 v91, v123
    v_mov_b32 v92, v124
    v_mov_b32 v93, v125
    v_mov_b32 v94, v126
    v_mov_b32 v95, v127
    s_branch L_g5_x1
L_g5_x0:
    ds_write_b128 v3, v[96:99] offset:0
    ds_write_b128 v3, v[100:103] offset:1024
    ds_write_b128 v3, v[104:107] offset:2048
    ds_write_b128 v3, v[108:111] offset:3072
    ds_write_b128 v3, v[112:115] offset:4096
    ds_write_b128 v3, v[116:119] offset:5120
    ds_write_b128 v3, v[120:123] offset:6144
    ds_write_b128 v3, v[124:127] offset:7168
L_g5_x1:
    s_waitcnt lgkmcnt(0)
    s_barrier
    ds_read_b128 v[96:99], v4 offset:0
    ds_read_b128 v[100:103], v4 offset:1024
    ds_read_b128 v[104:107], v4 offset:2048
    ds_read_b128 v[108:111], v4 offset:3072
    ds_read_b128 v[112:115], v4 offset:4096
    ds_read_b128 v[116:119], v4 offset:5120
    ds_read_b128 v[120:123], v4 offset:6144
    ds_read_b128 v[124:127], v4 offset:7168
    s_waitcnt lgkmcnt(7)
    v_add_f32 v64, v64, v96
    v_add_f32 v65, v65, v97
    v_add_f32 v66, v66, v98
    v_add_f32 v67, v67, v99
    s_waitcnt lgkmcnt(6)
    v_add_f32 v68, v68, v100
    v_add_f32 v69, v69, v101
    v_add_f32 v70, v70, v102
    v_add_f32 v71, v71, v103
    s_waitcnt lgkmcnt(5)
    v_add_f32 v72, v72, v104
    v_add_f32 v73, v73, v105
    v_add_f32 v74, v74, v106
    v_add_f32 v75, v75, v107
    s_waitcnt lgkmcnt(4)
    v_add_f32 v76, v76, v108
    v_add_f32 v77, v77, v109
    v_add_f32 v78, v78, v110
    v_add_f32 v79, v79, v111
    s_waitcnt lgkmcnt(3)
    v_add_f32 v80, v80, v112
    v_add_f32 v81, v81, v113
    v_add_f32 v82, v82, v114
    v_add_f32 v83, v83, v115
    s_waitcnt lgkmcnt(2)
    v_add_f32 v84, v84, v116
    v_add_f32 v85, v85, v117
    v_add_f32 v86, v86, v118
    v_add_f32 v87, v87, v119
    s_waitcnt lgkmcnt(1)
    v_add_f32 v88, v88, v120
    v_add_f32 v89, v89, v121
    v_add_f32 v90, v90, v122
    v_add_f32 v91, v91, v123
    s_waitcnt lgkmcnt(0)
    v_add_f32 v92, v92, v124
    v_add_f32 v93, v93, v125
    v_add_f32 v94, v94, v126
    v_add_f32 v95, v95, v127
    s_lshl_b32 s23, s26, 6
    v_and_b32 v3, 31, v2
    v_add_u32 v3, s23, v3
    s_lshl_b32 s23, s24, 5
    v_add_u32 v3, s23, v3
    s_mov_b32 s23, 4096
    v_mul_lo_u32 v3, v3, s23
    v_lshrrev_b32 v4, 5, v2
    v_lshl_add_u32 v3, v4, 4, v3
    s_lshl_b32 s23, s25, 7
    s_add_u32 s23, s23, s21
    v_add_u32 v3, s23, v3
    v_add_u32 v4, 131072, v3
    v_cvt_pk_bf16_f32 v16, v64, v65
    v_cvt_pk_bf16_f32 v17, v66, v67
    v_cvt_pk_bf16_f32 v18, v68, v69
    v_cvt_pk_bf16_f32 v19, v70, v71
    v_cvt_pk_bf16_f32 v20, v72, v73
    v_cvt_pk_bf16_f32 v21, v74, v75
    v_cvt_pk_bf16_f32 v22, v76, v77
    v_cvt_pk_bf16_f32 v23, v78, v79
    s_nop 1
    v_permlane32_swap_b32 v16, v18
    v_permlane32_swap_b32 v17, v19
    v_permlane32_swap_b32 v20, v22
    v_permlane32_swap_b32 v21, v23
    buffer_store_dwordx4 v[16:19], v3, s[12:15], 0 offen offset:0
    buffer_store_dwordx4 v[20:23], v3, s[12:15], 0 offen offset:32
    v_cvt_pk_bf16_f32 v24, v80, v81
    v_cvt_pk_bf16_f32 v25, v82, v83
    v_cvt_pk_bf16_f32 v26, v84, v85
    v_cvt_pk_bf16_f32 v27, v86, v87
    v_cvt_pk_bf16_f32 v28, v88, v89
    v_cvt_pk_bf16_f32 v29, v90, v91
    v_cvt_pk_bf16_f32 v30, v92, v93
    v_cvt_pk_bf16_f32 v31, v94, v95
    s_nop 1
    v_permlane32_swap_b32 v24, v26
    v_permlane32_swap_b32 v25, v27
    v_permlane32_swap_b32 v28, v30
    v_permlane32_swap_b32 v29, v31
    buffer_store_dwordx4 v[24:27], v3, s[12:15], 0 offen offset:64
    buffer_store_dwordx4 v[28:31], v3, s[12:15], 0 offen offset:96
    s_waitcnt vmcnt(4)
    v_or3_b32 v212, v212, v213, v214
    v_or3_b32 v212, v212, v215, v216
    v_or3_b32 v212, v212, v217, v218
    v_or_b32 v212, v212, v219
    v_cmp_ne_u32 vcc, 0, v212
    s_nop 1
    s_cmp_lg_u64 vcc, 0
    s_cbranch_scc1 L_edge_done
    v_mov_b32 v160, 0
    v_dot2c_f32_bf16 v160, v164, v176
    v_dot2c_f32_bf16 v160, v165, v177
    v_dot2c_f32_bf16 v160, v166, v178
    v_dot2c_f32_bf16 v160, v167, v179
    v_dot2c_f32_bf16 v160, v168, v180
    v_dot2c_f32_bf16 v160, v169, v181
    v_dot2c_f32_bf16 v160, v170, v182
    v_dot2c_f32_bf16 v160, v171, v183
    v_dot2c_f32_bf16 v160, v172, v184
    v_dot2c_f32_bf16 v160, v173, v185
    v_dot2c_f32_bf16 v160, v174, v186
    v_dot2c_f32_bf16 v160, v175, v187
    s_nop 3
    s_nop 1
    v_add_f32_dpp v160, v160, v160 row_ror:8 row_mask:0xf bank_mask:0xf
    s_nop 1
    v_add_f32_dpp v160, v160, v160 row_ror:4 row_mask:0xf bank_mask:0xf
    s_nop 1
    v_add_f32_dpp v160, v160, v160 row_ror:2 row_mask:0xf bank_mask:0xf
    s_nop 1
    v_add_f32_dpp v160, v160, v160 row_ror:1 row_mask:0xf bank_mask:0xf
    v_mov_b32 v3, v160
    s_nop 1
    v_permlane16_swap_b32 v160, v3
    s_nop 1
    v_add_f32 v160, v160, v3
    v_mov_b32 v3, v160
    s_nop 1
    v_permlane32_swap_b32 v160, v3
    s_nop 1
    v_add_f32 v160, v160, v3
    v_mov_b32 v161, 0
    v_dot2c_f32_bf16 v161, v188, v200
    v_dot2c_f32_bf16 v161, v189, v201
    v_dot2c_f32_bf16 v161, v190, v202
    v_dot2c_f32_bf16 v161, v191, v203
    v_dot2c_f32_bf16 v161, v192, v204
    v_dot2c_f32_bf16 v161, v193, v205
    v_dot2c_f32_bf16 v161, v194, v206
    v_dot2c_f32_bf16 v161, v195, v207
    v_dot2c_f32_bf16 v161, v196, v208
    v_dot2c_f32_bf16 v161, v197, v209
    v_dot2c_f32_bf16 v161, v198, v210
    v_dot2c_f32_bf16 v161, v199, v211
    s_nop 3
    s_nop 1
    v_add_f32_dpp v161, v161, v161 row_ror:8 row_mask:0xf bank_mask:0xf
    s_nop 1
    v_add_f32_dpp v161, v161, v161 row_ror:4 row_mask:0xf bank_mask:0xf
    s_nop 1
    v_add_f32_dpp v161, v161, v161 row_ror:2 row_mask:0xf bank_mask:0xf
    s_nop 1
    v_add_f32_dpp v161, v161, v161 row_ror:1 row_mask:0xf bank_mask:0xf
    v_mov_b32 v3, v161
    s_nop 1
    v_permlane16_swap_b32 v161, v3
    s_nop 1
    v_add_f32 v161, v161, v3
    v_mov_b32 v3, v161
    s_nop 1
    v_permlane32_swap_b32 v161, v3
    s_nop 1
    v_add_f32 v161, v161, v3
    v_cvt_pk_bf16_f32 v160, v160, v161
    v_lshrrev_b32 v161, 16, v160
    s_mov_b64 exec, 3
    s_sub_u32 s23, 2048, s58
    v_mov_b32 v3, s58
    v_mov_b32 v4, s23
    v_cmp_eq_u32 vcc, 0, v2
    s_nop 1
    v_cndmask_b32 v3, v4, v3, vcc
    v_lshlrev_b32 v3, 12, v3
    buffer_store_short v160, v3, s[12:15], 0 offen offset:3072
    s_sub_u32 s23, 1024, s61
    v_mov_b32 v3, s61
    v_mov_b32 v4, s23
    s_nop 0
    v_cndmask_b32 v3, v4, v3, vcc
    v_lshlrev_b32 v3, 1, v3
    v_add_u32 v3, 4196352, v3
    s_cmp_eq_u32 s61, 0
    s_cselect_b64 s[72:73], 1, 3
    s_cmp_lg_u32 s75, 0
    s_cselect_b64 s[72:73], 0, s[72:73]
    s_mov_b64 exec, s[72:73]
    s_cbranch_execz L_edge_done
    buffer_store_short v161, v3, s[12:15], 0 offen
L_edge_done:
    s_mov_b64 exec, -1
    s_endpgm
L_k3_s2:
    s_sub_u32 s31, s31, 16
    s_mov_b32 s50, s56
    s_mov_b32 s51, s57
    s_mov_b32 s52, s58
    s_mov_b32 s53, s59
    s_and_b32 s54, s30, 3
    s_lshl_b32 s54, s54, 2
    s_and_b32 s55, s31, 3
    s_add_u32 s54, s54, s55
    s_lshr_b32 s55, s30, 2
    s_lshl_b32 s55, s55, 2
    s_lshr_b32 s56, s31, 2
    s_add_u32 s55, s55, s56
    s_mov_b32 s4, s48
    s_mov_b32 s5, s49
    s_mov_b32 s6, 41943040
    s_mov_b32 s7, 0x00020000
    s_mov_b32 s36, s48
    s_mov_b32 s37, s49
    s_mov_b32 s38, 41943040
    s_mov_b32 s39, 0x00020000
    s_mov_b32 s8, s50
    s_mov_b32 s9, s51
    s_mov_b32 s10, 8388608
    s_mov_b32 s11, 0x00020000
    s_mov_b32 s44, s52
    s_mov_b32 s45, s53
    s_mov_b32 s46, 8388608
    s_mov_b32 s47, 0x00020000
    s_mov_b32 s12, s34
    s_mov_b32 s13, s35
    s_mov_b32 s14, 8388608
    s_mov_b32 s15, 0x00020000
    s_mul_i32 s16, s55, 139264
    s_add_u32 s40, s16, 35651584
    s_add_u32 s16, s16, 33554432
    s_lshl_b32 s17, s54, 18
    s_mov_b32 s41, s17
    v_lshrrev_b32 v1, 6, v0
    s_nop 0
    v_readfirstlane_b32 s22, v1
    v_and_b32 v2, 63, v0
    s_nop 2
    s_lshl_b32 s18, s22, 10
    s_add_u32 s76, s48, 37748736
    s_addc_u32 s77, s49, 0
    s_mov_b32 s78, 2048
    s_mov_b32 s79, 0x00020000
    v_and_b32 v3, 63, v0
    v_lshlrev_b32 v3, 4, v3
    v_add_u32 v4, 4096, v3
    buffer_load_dwordx4 v[212:215], v3, s[76:79], 0 offen offset:0
    buffer_load_dwordx4 v[216:219], v3, s[76:79], 0 offen offset:1024
    v_lshrrev_b32 v3, 3, v2
    v_lshl_add_u32 v3, v1, 3, v3
    v_bfe_u32 v4, v3, 1, 3
    v_and_b32 v5, 7, v2
    v_xor_b32 v4, v4, v5
    v_lshlrev_b32 v4, 4, v4
    s_mov_b32 s23, 2176
    v_mul_lo_u32 v3, v3, s23
    v_add_u32 v48, v3, v4
    v_lshrrev_b32 v3, 3, v2
    v_lshl_add_u32 v3, v1, 3, v3
    v_bfe_u32 v4, v3, 1, 3
    v_and_b32 v5, 7, v2
    v_xor_b32 v4, v4, v5
    v_lshlrev_b32 v4, 4, v4
    s_mov_b32 s23, 4096
    v_mul_lo_u32 v3, v3, s23
    v_add_u32 v49, v3, v4
    s_add_u32 m0, s18, 0
    s_nop 0
    buffer_load_dwordx4 v48, s[4:7], s16 offen lds
    s_add_u32 m0, s18, 8192
    s_nop 0
    buffer_load_dwordx4 v49, s[8:11], s17 offen lds
    s_add_u32 m0, s18, 16384
    s_nop 0
    buffer_load_dwordx4 v48, s[36:39], s40 offen lds
    s_add_u32 m0, s18, 24576
    s_nop 0
    buffer_load_dwordx4 v49, s[44:47], s41 offen lds
    s_add_u32 s16, s16, 128
    s_add_u32 s17, s17, 128
    s_add_u32 s40, s40, 128
    s_add_u32 s41, s41, 128
    s_add_u32 m0, s18, 32768
    s_nop 0
    buffer_load_dwordx4 v48, s[4:7], s16 offen lds
    s_add_u32 m0, s18, 40960
    s_nop 0
    buffer_load_dwordx4 v49, s[8:11], s17 offen lds
    s_add_u32 m0, s18, 49152
    s_nop 0
    buffer_load_dwordx4 v48, s[36:39], s40 offen lds
    s_add_u32 m0, s18, 57344
    s_nop 0
    buffer_load_dwordx4 v49, s[44:47], s41 offen lds
    s_add_u32 s16, s16, 128
    s_add_u32 s17, s17, 128
    s_add_u32 s40, s40, 128
    s_add_u32 s41, s41, 128
    s_add_u32 m0, s18, 65536
    s_nop 0
    buffer_load_dwordx4 v48, s[4:7], s16 offen lds
    s_add_u32 m0, s18, 73728
    s_nop 0
    buffer_load_dwordx4 v49, s[8:11], s17 offen lds
    s_add_u32 m0, s18, 81920
    s_nop 0
    buffer_load_dwordx4 v48, s[36:39], s40 offen lds
    s_add_u32 m0, s18, 90112
    s_nop 0
    buffer_load_dwordx4 v49, s[44:47], s41 offen lds
    s_add_u32 s16, s16, 128
    s_add_u32 s17, s17, 128
    s_add_u32 s40, s40, 128
    s_add_u32 s41, s41, 128
    s_and_b32 s26, s22, 1
    s_lshr_b32 s24, s22, 2
    s_and_b32 s27, s22, 2
    s_lshl_b32 s27, s27, 1
    s_lshl_b32 s28, s24, 7
    v_and_b32 v3, 31, v2
    v_bfe_u32 v4, v3, 1, 3
    v_lshrrev_b32 v5, 5, v2
    v_xor_b32 v4, v4, v5
    v_xor_b32 v4, s27, v4
    v_add_u32 v3, s28, v3
    v_lshlrev_b32 v3, 7, v3
    v_lshl_add_u32 v3, v4, 4, v3
    v_add_u32 v128, 0, v3
    v_xor_b32 v129, 32, v128
    v_add_u32 v132, 32768, v3
    v_xor_b32 v133, 32, v132
    v_add_u32 v136, 65536, v3
    v_xor_b32 v137, 32, v136
    v_add_u32 v140, 98304, v3
    v_xor_b32 v141, 32, v140
    s_lshl_b32 s29, s26, 5
    s_add_u32 s28, s28, s29
    v_and_b32 v3, 31, v2
    v_bfe_u32 v4, v3, 1, 3
    v_lshrrev_b32 v5, 5, v2
    v_xor_b32 v4, v4, v5
    v_xor_b32 v4, s27, v4
    v_add_u32 v3, s28, v3
    v_lshlrev_b32 v3, 7, v3
    v_lshl_add_u32 v3, v4, 4, v3
    v_add_u32 v130, 8192, v3
    v_xor_b32 v131, 32, v130
    v_add_u32 v134, 40960, v3
    v_xor_b32 v135, 32, v134
    v_add_u32 v138, 73728, v3
    v_xor_b32 v139, 32, v138
    v_add_u32 v142, 106496, v3
    v_xor_b32 v143, 32, v142
    v_mov_b32 v64, 0
    v_mov_b32 v65, 0
    v_mov_b32 v66, 0
    v_mov_b32 v67, 0
    v_mov_b32 v68, 0
    v_mov_b32 v69, 0
    v_mov_b32 v70, 0
    v_mov_b32 v71, 0
    v_mov_b32 v72, 0
    v_mov_b32 v73, 0
    v_mov_b32 v74, 0
    v_mov_b32 v75, 0
    v_mov_b32 v76, 0
    v_mov_b32 v77, 0
    v_mov_b32 v78, 0
    v_mov_b32 v79, 0
    v_mov_b32 v80, 0
    v_mov_b32 v81, 0
    v_mov_b32 v82, 0
    v_mov_b32 v83, 0
    v_mov_b32 v84, 0
    v_mov_b32 v85, 0
    v_mov_b32 v86, 0
    v_mov_b32 v87, 0
    v_mov_b32 v88, 0
    v_mov_b32 v89, 0
    v_mov_b32 v90, 0
    v_mov_b32 v91, 0
    v_mov_b32 v92, 0
    v_mov_b32 v93, 0
    v_mov_b32 v94, 0
    v_mov_b32 v95, 0
    s_waitcnt vmcnt(12)
    v_or3_b32 v212, v212, v213, v214
    v_or3_b32 v212, v212, v215, v216
    v_or3_b32 v212, v212, v217, v218
    v_or_b32 v212, v212, v219
    v_cmp_ne_u32 vcc, 0, v212
    s_nop 1
    s_cmp_lg_u64 vcc, 0
    s_cbranch_scc1 L_k3_fb
    s_waitcnt vmcnt(8)
    s_barrier
    ds_read_b128 v[16:19], v128
    ds_read_b128 v[20:23], v128 offset:4096
    ds_read_b128 v[24:27], v130
    s_mov_b32 s19, 0
L_s2_loop1:
    ds_read_b128 v[32:35], v129
    ds_read_b128 v[36:39], v129 offset:4096
    ds_read_b128 v[40:43], v131
    s_waitcnt lgkmcnt(3)
    v_mfma_f32_32x32x16_bf16 v[64:79], v[16:19], v[24:27], v[64:79]
    s_add_u32 m0, s18, 98304
    s_nop 0
    buffer_load_dwordx4 v48, s[4:7], s16 offen lds
    s_add_u32 m0, s18, 106496
    s_nop 0
    buffer_load_dwordx4 v49, s[8:11], s17 offen lds
    v_mfma_f32_32x32x16_bf16 v[80:95], v[20:23], v[24:27], v[80:95]
    s_add_u32 m0, s18, 114688
    s_nop 0
    buffer_load_dwordx4 v48, s[36:39], s40 offen lds
    s_waitcnt lgkmcnt(0)
    v_mfma_f32_32x32x16_bf16 v[64:79], v[32:35], v[40:43], v[64:79]
    s_add_u32 m0, s18, 122880
    s_nop 0
    buffer_load_dwordx4 v49, s[44:47], s41 offen lds
    s_add_u32 s16, s16, 128
    s_add_u32 s17, s17, 128
    s_add_u32 s40, s40, 128
    s_add_u32 s41, s41, 128
    s_waitcnt vmcnt(8)
    s_barrier
    ds_read_b128 v[16:19], v132
    ds_read_b128 v[20:23], v132 offset:4096
    ds_read_b128 v[24:27], v134
    v_mfma_f32_32x32x16_bf16 v[80:95], v[36:39], v[40:43], v[80:95]
    ds_read_b128 v[32:35], v133
    ds_read_b128 v[36:39], v133 offset:4096
    ds_read_b128 v[40:43], v135
    s_waitcnt lgkmcnt(3)
    v_mfma_f32_32x32x16_bf16 v[64:79], v[16:19], v[24:27], v[64:79]
    s_add_u32 m0, s18, 0
    s_nop 0
    buffer_load_dwordx4 v48, s[4:7], s16 offen lds
    s_add_u32 m0, s18, 8192
    s_nop 0
    buffer_load_dwordx4 v49, s[8:11], s17 offen lds
    v_mfma_f32_32x32x16_bf16 v[80:95], v[20:23], v[24:27], v[80:95]
    s_add_u32 m0, s18, 16384
    s_nop 0
    buffer_load_dwordx4 v48, s[36:39], s40 offen lds
    s_waitcnt lgkmcnt(0)
    v_mfma_f32_32x32x16_bf16 v[64:79], v[32:35], v[40:43], v[64:79]
    s_add_u32 m0, s18, 24576
    s_nop 0
    buffer_load_dwordx4 v49, s[44:47], s41 offen lds
    s_add_u32 s16, s16, 128
    s_add_u32 s17, s17, 128
    s_add_u32 s40, s40, 128
    s_add_u32 s41, s41, 128
    s_waitcnt vmcnt(8)
    s_barrier
    ds_read_b128 v[16:19], v136
    ds_read_b128 v[20:23], v136 offset:4096
    ds_read_b128 v[24:27], v138
    v_mfma_f32_32x32x16_bf16 v[80:95], v[36:39], v[40:43], v[80:95]
    ds_read_b128 v[32:35], v137
    ds_read_b128 v[36:39], v137 offset:4096
    ds_read_b128 v[40:43], v139
    s_waitcnt lgkmcnt(3)
    v_mfma_f32_32x32x16_bf16 v[64:79], v[16:19], v[24:27], v[64:79]
    s_add_u32 m0, s18, 32768
    s_nop 0
    buffer_load_dwordx4 v48, s[4:7], s16 offen lds
    s_add_u32 m0, s18, 40960
    s_nop 0
    buffer_load_dwordx4 v49, s[8:11], s17 offen lds
    v_mfma_f32_32x32x16_bf16 v[80:95], v[20:23], v[24:27], v[80:95]
    s_add_u32 m0, s18, 49152
    s_nop 0
    buffer_load_dwordx4 v48, s[36:39], s40 offen lds
    s_waitcnt lgkmcnt(0)
    v_mfma_f32_32x32x16_bf16 v[64:79], v[32:35], v[40:43], v[64:79]
    s_add_u32 m0, s18, 57344
    s_nop 0
    buffer_load_dwordx4 v49, s[44:47], s41 offen lds
    s_add_u32 s16, s16, 128
    s_add_u32 s17, s17, 128
    s_add_u32 s40, s40, 128
    s_add_u32 s41, s41, 128
    s_waitcnt vmcnt(8)
    s_barrier
    ds_read_b128 v[16:19], v140
    ds_read_b128 v[20:23], v140 offset:4096
    ds_read_b128 v[24:27], v142
    v_mfma_f32_32x32x16_bf16 v[80:95], v[36:39], v[40:43], v[80:95]
    ds_read_b128 v[32:35], v141
    ds_read_b128 v[36:39], v141 offset:4096
    ds_read_b128 v[40:43], v143
    s_waitcnt lgkmcnt(3)
    v_mfma_f32_32x32x16_bf16 v[64:79], v[16:19], v[24:27], v[64:79]
    s_add_u32 m0, s18, 65536
    s_nop 0
    buffer_load_dwordx4 v48, s[4:7], s16 offen lds
    s_add_u32 m0, s18, 73728
    s_nop 0
    buffer_load_dwordx4 v49, s[8:11], s17 offen lds
    v_mfma_f32_32x32x16_bf16 v[80:95], v[20:23], v[24:27], v[80:95]
    s_add_u32 m0, s18, 81920
    s_nop 0
    buffer_load_dwordx4 v48, s[36:39], s40 offen lds
    s_waitcnt lgkmcnt(0)
    v_mfma_f32_32x32x16_bf16 v[64:79], v[32:35], v[40:43], v[64:79]
    s_add_u32 m0, s18, 90112
    s_nop 0
    buffer_load_dwordx4 v49, s[44:47], s41 offen lds
    s_add_u32 s16, s16, 128
    s_add_u32 s17, s17, 128
    s_add_u32 s40, s40, 128
    s_add_u32 s41, s41, 128
    s_waitcnt vmcnt(8)
    s_barrier
    ds_read_b128 v[16:19], v128
    ds_read_b128 v[20:23], v128 offset:4096
    ds_read_b128 v[24:27], v130
    v_mfma_f32_32x32x16_bf16 v[80:95], v[36:39], v[40:43], v[80:95]
    s_add_u32 s19, s19, 1
    s_cmp_lt_u32 s19, 3
    s_cbranch_scc1 L_s2_loop1
    ds_read_b128 v[32:35], v129
    ds_read_b128 v[36:39], v129 offset:4096
    ds_read_b128 v[40:43], v131
    s_waitcnt lgkmcnt(3)
    v_mfma_f32_32x32x16_bf16 v[64:79], v[16:19], v[24:27], v[64:79]
    s_add_u32 m0, s18, 98304
    s_nop 0
    buffer_load_dwordx4 v48, s[4:7], s16 offen lds
    s_add_u32 m0, s18, 106496
    s_nop 0
    buffer_load_dwordx4 v49, s[8:11], s17 offen lds
    v_mfma_f32_32x32x16_bf16 v[80:95], v[20:23], v[24:27], v[80:95]
    s_add_u32 m0, s18, 114688
    s_nop 0
    buffer_load_dwordx4 v48, s[36:39], s40 offen lds
    s_waitcnt lgkmcnt(0)
    v_mfma_f32_32x32x16_bf16 v[64:79], v[32:35], v[40:43], v[64:79]
    s_add_u32 m0, s18, 122880
    s_nop 0
    buffer_load_dwordx4 v49, s[44:47], s41 offen lds
    s_add_u32 s16, s16, 128
    s_add_u32 s17, s17, 128
    s_add_u32 s40, s40, 128
    s_add_u32 s41, s41, 128
    s_waitcnt vmcnt(8)
    s_barrier
    ds_read_b128 v[16:19], v132
    ds_read_b128 v[20:23], v132 offset:4096
    ds_read_b128 v[24:27], v134
    v_mfma_f32_32x32x16_bf16 v[80:95], v[36:39], v[40:43], v[80:95]
    ds_read_b128 v[32:35], v133
    ds_read_b128 v[36:39], v133 offset:4096
    ds_read_b128 v[40:43], v135
    s_waitcnt lgkmcnt(3)
    v_mfma_f32_32x32x16_bf16 v[64:79], v[16:19], v[24:27], v[64:79]
    s_add_u32 m0, s18, 0
    s_nop 0
    buffer_load_dwordx4 v48, s[4:7], s16 offen lds
    s_add_u32 m0, s18, 8192
    s_nop 0
    buffer_load_dwordx4 v49, s[8:11], s17 offen lds
    v_mfma_f32_32x32x16_bf16 v[80:95], v[20:23], v[24:27], v[80:95]
    s_add_u32 m0, s18, 16384
    s_nop 0
    buffer_load_dwordx4 v48, s[36:39], s40 offen lds
    s_waitcnt lgkmcnt(0)
    v_mfma_f32_32x32x16_bf16 v[64:79], v[32:35], v[40:43], v[64:79]
    s_add_u32 m0, s18, 24576
    s_nop 0
    buffer_load_dwordx4 v49, s[44:47], s41 offen lds
    s_add_u32 s16, s16, 128
    s_add_u32 s17, s17, 128
    s_add_u32 s40, s40, 128
    s_add_u32 s41, s41, 128
    s_waitcnt vmcnt(8)
    s_barrier
    ds_read_b128 v[16:19], v136
    ds_read_b128 v[20:23], v136 offset:4096
    ds_read_b128 v[24:27], v138
    v_mfma_f32_32x32x16_bf16 v[80:95], v[36:39], v[40:43], v[80:95]
    ds_read_b128 v[32:35], v137
    ds_read_b128 v[36:39], v137 offset:4096
    ds_read_b128 v[40:43], v139
    s_waitcnt lgkmcnt(3)
    v_mfma_f32_32x32x16_bf16 v[64:79], v[16:19], v[24:27], v[64:79]
    v_mfma_f32_32x32x16_bf16 v[80:95], v[20:23], v[24:27], v[80:95]
    s_waitcnt lgkmcnt(0)
    v_mfma_f32_32x32x16_bf16 v[64:79], v[32:35], v[40:43], v[64:79]
    s_waitcnt vmcnt(4)
    s_barrier
    ds_read_b128 v[16:19], v140
    ds_read_b128 v[20:23], v140 offset:4096
    ds_read_b128 v[24:27], v142
    v_mfma_f32_32x32x16_bf16 v[80:95], v[36:39], v[40:43], v[80:95]
    ds_read_b128 v[32:35], v141
    ds_read_b128 v[36:39], v141 offset:4096
    ds_read_b128 v[40:43], v143
    s_waitcnt lgkmcnt(3)
    v_mfma_f32_32x32x16_bf16 v[64:79], v[16:19], v[24:27], v[64:79]
    v_mfma_f32_32x32x16_bf16 v[80:95], v[20:23], v[24:27], v[80:95]
    s_waitcnt lgkmcnt(0)
    v_mfma_f32_32x32x16_bf16 v[64:79], v[32:35], v[40:43], v[64:79]
    s_waitcnt vmcnt(0)
    s_barrier
    ds_read_b128 v[16:19], v128
    ds_read_b128 v[20:23], v128 offset:4096
    ds_read_b128 v[24:27], v130
    v_mfma_f32_32x32x16_bf16 v[80:95], v[36:39], v[40:43], v[80:95]
    ds_read_b128 v[32:35], v129
    ds_read_b128 v[36:39], v129 offset:4096
    ds_read_b128 v[40:43], v131
    s_waitcnt lgkmcnt(3)
    v_mfma_f32_32x32x16_bf16 v[64:79], v[16:19], v[24:27], v[64:79]
    v_mfma_f32_32x32x16_bf16 v[80:95], v[20:23], v[24:27], v[80:95]
    s_waitcnt lgkmcnt(0)
    v_mfma_f32_32x32x16_bf16 v[64:79], v[32:35], v[40:43], v[64:79]
    v_mfma_f32_32x32x16_bf16 v[80:95], v[36:39], v[40:43], v[80:95]
    s_and_b32 s26, s22, 1
    s_nop 15
    s_barrier
    v_lshlrev_b32 v3, 4, v2
    s_lshl_b32 s23, s22, 13
    v_add_u32 v4, s23, v3
    s_lshr_b32 s25, s22, 1
    s_lshl_b32 s23, s25, 11
    s_lshl_b32 s29, s26, 13
    s_add_u32 s23, s23, s29
    v_add_u32 v3, s23, v3
    ds_write_b128 v4, v[64:67] offset:0
    ds_write_b128 v4, v[68:71] offset:1024
    ds_write_b128 v4, v[72:75] offset:2048
    ds_write_b128 v4, v[76:79] offset:3072
    ds_write_b128 v4, v[80:83] offset:4096
    ds_write_b128 v4, v[84:87] offset:5120
    ds_write_b128 v4, v[88:91] offset:6144
    ds_write_b128 v4, v[92:95] offset:7168
    s_waitcnt lgkmcnt(0)
    s_barrier
    ds_read_b128 v[96:99], v3 offset:0
    ds_read_b128 v[100:103], v3 offset:1024
    ds_read_b128 v[104:107], v3 offset:16384
    ds_read_b128 v[108:111], v3 offset:17408
    ds_read_b128 v[112:115], v3 offset:32768
    ds_read_b128 v[116:119], v3 offset:33792
    ds_read_b128 v[120:123], v3 offset:49152
    ds_read_b128 v[124:127], v3 offset:50176
    s_waitcnt lgkmcnt(4)
    v_add_f32 v64, v96, v104
    v_add_f32 v65, v97, v105
    v_add_f32 v66, v98, v106
    v_add_f32 v67, v99, v107
    v_add_f32 v68, v100, v108
    v_add_f32 v69, v101, v109
    v_add_f32 v70, v102, v110
    v_add_f32 v71, v103, v111
    s_waitcnt lgkmcnt(0)
    v_add_f32 v72, v112, v120
    v_add_f32 v73, v113, v121
    v_add_f32 v74, v114, v122
    v_add_f32 v75, v115, v123
    v_add_f32 v76, v116, v124
    v_add_f32 v77, v117, v125
    v_add_f32 v78, v118, v126
    v_add_f32 v79, v119, v127
    v_sub_f32 v80, v64, v72
    v_add_f32 v88, v64, v72
    v_sub_f32 v81, v65, v73
    v_add_f32 v89, v65, v73
    v_sub_f32 v82, v66, v74
    v_add_f32 v90, v66, v74
    v_sub_f32 v83, v67, v75
    v_add_f32 v91, v67, v75
    v_sub_f32 v84, v68, v76
    v_add_f32 v92, v68, v76
    v_sub_f32 v85, v69, v77
    v_add_f32 v93, v69, v77
    v_sub_f32 v86, v70, v78
    v_add_f32 v94, v70, v78
    v_sub_f32 v87, v71, v79
    v_add_f32 v95, v71, v79
    v_cvt_pk_bf16_f32 v16, v80, v81
    v_cvt_pk_bf16_f32 v17, v82, v83
    v_cvt_pk_bf16_f32 v18, v84, v85
    v_cvt_pk_bf16_f32 v19, v86, v87
    s_nop 1
    v_permlane32_swap_b32 v16, v18
    v_permlane32_swap_b32 v17, v19
    v_cvt_pk_bf16_f32 v20, v88, v89
    v_cvt_pk_bf16_f32 v21, v90, v91
    v_cvt_pk_bf16_f32 v22, v92, v93
    v_cvt_pk_bf16_f32 v23, v94, v95
    s_nop 1
    v_permlane32_swap_b32 v20, v22
    v_permlane32_swap_b32 v21, v23
    s_nop 0
    v_alignbit_b32 v24, v19, v19, 16
    v_alignbit_b32 v28, v23, v23, 16
    v_alignbit_b32 v25, v18, v18, 16
    v_alignbit_b32 v29, v22, v22, 16
    v_alignbit_b32 v26, v17, v17, 16
    v_alignbit_b32 v30, v21, v21, 16
    v_alignbit_b32 v27, v16, v16, 16
    v_alignbit_b32 v31, v20, v20, 16
    v_and_b32 v3, 31, v2
    s_lshl_b32 s23, s26, 5
    s_lshl_b32 s29, s54, 6
    s_add_u32 s23, s23, s29
    v_add_u32 v3, s23, v3
    v_sub_u32 v4, 2048, v3
    v_lshlrev_b32 v3, 12, v3
    v_lshlrev_b32 v4, 12, v4
    v_lshrrev_b32 v5, 5, v2
    v_lshlrev_b32 v5, 4, v5
    s_lshl_b32 s23, s25, 5
    s_lshl_b32 s29, s55, 7
    s_add_u32 s23, s23, s29
    v_add_u32 v5, s23, v5
    v_add_u32 v6, v3, v5
    v_add_u32 v7, v4, v5
    v_sub_u32 v8, 4082, v5
    v_add_u32 v9, v4, v8
    v_add_u32 v8, v3, v8
    buffer_store_dwordx4 v[16:19], v6, s[12:15], 0 offen offset:2048
    buffer_store_dwordx4 v[20:23], v7, s[12:15], 0 offen offset:2048
    v_cmp_ne_u32 vcc, 0, v5
    s_and_saveexec_b64 s[64:65], vcc
    buffer_store_dwordx4 v[28:31], v8, s[12:15], 0 offen
    buffer_store_dwordx4 v[24:27], v9, s[12:15], 0 offen
    s_andn2_b64 exec, s[64:65], exec
    s_cbranch_execz L_s2_e2
    buffer_store_dwordx3 v[28:30], v8, s[12:15], 0 offen
    buffer_store_short v31, v8, s[12:15], 0 offen offset:12
    buffer_store_dwordx3 v[24:26], v9, s[12:15], 0 offen
    buffer_store_short v27, v9, s[12:15], 0 offen offset:12
L_s2_e2:
    s_mov_b64 exec, s[64:65]
    s_endpgm
L_k3_fb:
    s_load_dwordx2 s[40:41], s[0:1], 40
    s_load_dwordx4 s[44:47], s[0:1], 64
    s_load_dwordx2 s[90:91], s[0:1], 88
    s_mov_b32 s36, s34
    s_mov_b32 s37, s35
    s_mov_b32 s32, s50
    s_mov_b32 s33, s51
    s_mov_b32 s34, s52
    s_mov_b32 s35, s53
    s_waitcnt vmcnt(0) lgkmcnt(0)
    s_barrier
    s_mov_b32 s12, s48
    s_mov_b32 s13, s49
    s_mov_b32 s14, 41943040
    s_mov_b32 s15, 0x00020000
    s_and_b32 s50, s30, 3
    s_lshl_b32 s50, s50, 2
    s_and_b32 s51, s31, 3
    s_add_u32 s50, s50, s51
    s_lshr_b32 s51, s30, 2
    s_lshl_b32 s51, s51, 2
    s_lshr_b32 s52, s31, 2
    s_add_u32 s51, s51, s52
    s_mov_b32 s4, s40
    s_mov_b32 s5, s41
    s_mov_b32 s6, 4194304
    s_mov_b32 s7, 0x00020000
    s_cmp_ge_u32 s51, 4
    s_cselect_b32 s8, s46, s44
    s_cselect_b32 s9, s47, s45
    s_cselect_b32 s20, 3212836864, 1.0
    s_mov_b32 s10, 2097152
    s_mov_b32 s11, 0x00020000
    s_lshl_b32 s16, s50, 18
    s_and_b32 s17, s51, 3
    s_lshl_b32 s17, s17, 19
    s_lshl_b32 s21, s51, 20
    s_lshl_b32 s23, s50, 8
    s_add_u32 s21, s21, s23
    s_add_u32 s21, s21, 8388608
    v_lshrrev_b32 v1, 6, v0
    s_nop 0
    v_readfirstlane_b32 s22, v1
    v_and_b32 v2, 63, v0
    s_nop 2
    s_lshl_b32 s18, s22, 10
    s_lshr_b32 s24, s22, 3
    s_and_b32 s25, s22, 1
    s_lshr_b32 s26, s22, 1
    s_and_b32 s26, s26, 3
    v_lshrrev_b32 v3, 3, v2
    v_lshl_add_u32 v3, v1, 3, v3
    v_bfe_u32 v4, v3, 1, 3
    v_and_b32 v5, 7, v2
    v_xor_b32 v4, v4, v5
    v_lshlrev_b32 v4, 4, v4
    s_mov_b32 s23, 2048
    v_mul_lo_u32 v3, v3, s23
    v_add_u32 v48, v3, v4
    v_add_u32 v49, 131072, v48
    v_lshrrev_b32 v3, 3, v2
    v_lshl_add_u32 v3, v1, 3, v3
    v_bfe_u32 v4, v3, 1, 3
    v_and_b32 v5, 7, v2
    v_xor_b32 v4, v4, v5
    v_lshlrev_b32 v4, 4, v4
    s_mov_b32 s23, 2048
    v_mul_lo_u32 v3, v3, s23
    v_add_u32 v50, v3, v4
    v_add_u32 v51, 131072, v50
    v_add_u32 v52, 262144, v50
    v_add_u32 v53, 393216, v50
    s_add_u32 m0, s18, 0
    s_nop 0
    buffer_load_dwordx4 v48, s[4:7], s16 offen lds
    s_add_u32 m0, s18, 8192
    s_nop 0
    buffer_load_dwordx4 v49, s[4:7], s16 offen lds
    s_add_u32 m0, s18, 16384
    s_nop 0
    buffer_load_dwordx4 v50, s[8:11], s17 offen lds
    s_add_u32 m0, s18, 24576
    s_nop 0
    buffer_load_dwordx4 v51, s[8:11], s17 offen lds
    s_add_u32 m0, s18, 32768
    s_nop 0
    buffer_load_dwordx4 v52, s[8:11], s17 offen lds
    s_add_u32 m0, s18, 40960
    s_nop 0
    buffer_load_dwordx4 v53, s[8:11], s17 offen lds
    s_add_u32 s16, s16, 128
    s_add_u32 s17, s17, 128
    s_add_u32 m0, s18, 49152
    s_nop 0
    buffer_load_dwordx4 v48, s[4:7], s16 offen lds
    s_add_u32 m0, s18, 57344
    s_nop 0
    buffer_load_dwordx4 v49, s[4:7], s16 offen lds
    s_add_u32 m0, s18, 65536
    s_nop 0
    buffer_load_dwordx4 v50, s[8:11], s17 offen lds
    s_add_u32 m0, s18, 73728
    s_nop 0
    buffer_load_dwordx4 v51, s[8:11], s17 offen lds
    s_add_u32 m0, s18, 81920
    s_nop 0
    buffer_load_dwordx4 v52, s[8:11], s17 offen lds
    s_add_u32 m0, s18, 90112
    s_nop 0
    buffer_load_dwordx4 v53, s[8:11], s17 offen lds
    s_add_u32 s16, s16, 128
    s_add_u32 s17, s17, 128
    s_mul_i32 s27, s24, 8
    s_lshl_b32 s28, s25, 6
    v_and_b32 v3, 31, v2
    v_bfe_u32 v4, v3, 1, 3
    v_lshrrev_b32 v5, 5, v2
    v_xor_b32 v4, v4, v5
    v_xor_b32 v4, s27, v4
    v_add_u32 v3, s28, v3
    v_lshlrev_b32 v3, 7, v3
    v_lshl_add_u32 v3, v4, 4, v3
    v_add_u32 v128, 0, v3
    v_xor_b32 v129, 32, v128
    v_xor_b32 v130, 64, v128
    v_xor_b32 v131, 96, v128
    v_add_u32 v136, 49152, v3
    v_xor_b32 v137, 32, v136
    v_xor_b32 v138, 64, v136
    v_xor_b32 v139, 96, v136
    v_add_u32 v144, 98304, v3
    v_xor_b32 v145, 32, v144
    v_xor_b32 v146, 64, v144
    v_xor_b32 v147, 96, v144
    s_lshl_b32 s28, s26, 6
    v_and_b32 v3, 31, v2
    v_bfe_u32 v4, v3, 1, 3
    v_lshrrev_b32 v5, 5, v2
    v_xor_b32 v4, v4, v5
    v_xor_b32 v4, s27, v4
    v_add_u32 v3, s28, v3
    v_lshlrev_b32 v3, 7, v3
    v_lshl_add_u32 v3, v4, 4, v3
    v_add_u32 v132, 16384, v3
    v_xor_b32 v133, 32, v132
    v_xor_b32 v134, 64, v132
    v_xor_b32 v135, 96, v132
    v_add_u32 v140, 65536, v3
    v_xor_b32 v141, 32, v140
    v_xor_b32 v142, 64, v140
    v_xor_b32 v143, 96, v140
    v_add_u32 v148, 114688, v3
    v_xor_b32 v149, 32, v148
    v_xor_b32 v150, 64, v148
    v_xor_b32 v151, 96, v148
    v_mov_b32 v64, 0
    v_mov_b32 v65, 0
    v_mov_b32 v66, 0
    v_mov_b32 v67, 0
    v_mov_b32 v68, 0
    v_mov_b32 v69, 0
    v_mov_b32 v70, 0
    v_mov_b32 v71, 0
    v_mov_b32 v72, 0
    v_mov_b32 v73, 0
    v_mov_b32 v74, 0
    v_mov_b32 v75, 0
    v_mov_b32 v76, 0
    v_mov_b32 v77, 0
    v_mov_b32 v78, 0
    v_mov_b32 v79, 0
    v_mov_b32 v80, 0
    v_mov_b32 v81, 0
    v_mov_b32 v82, 0
    v_mov_b32 v83, 0
    v_mov_b32 v84, 0
    v_mov_b32 v85, 0
    v_mov_b32 v86, 0
    v_mov_b32 v87, 0
    v_mov_b32 v88, 0
    v_mov_b32 v89, 0
    v_mov_b32 v90, 0
    v_mov_b32 v91, 0
    v_mov_b32 v92, 0
    v_mov_b32 v93, 0
    v_mov_b32 v94, 0
    v_mov_b32 v95, 0
    v_mov_b32 v96, 0
    v_mov_b32 v97, 0
    v_mov_b32 v98, 0
    v_mov_b32 v99, 0
    v_mov_b32 v100, 0
    v_mov_b32 v101, 0
    v_mov_b32 v102, 0
    v_mov_b32 v103, 0
    v_mov_b32 v104, 0
    v_mov_b32 v105, 0
    v_mov_b32 v106, 0
    v_mov_b32 v107, 0
    v_mov_b32 v108, 0
    v_mov_b32 v109, 0
    v_mov_b32 v110, 0
    v_mov_b32 v111, 0
    v_mov_b32 v112, 0
    v_mov_b32 v113, 0
    v_mov_b32 v114, 0
    v_mov_b32 v115, 0
    v_mov_b32 v116, 0
    v_mov_b32 v117, 0
    v_mov_b32 v118, 0
    v_mov_b32 v119, 0
    v_mov_b32 v120, 0
    v_mov_b32 v121, 0
    v_mov_b32 v122, 0
    v_mov_b32 v123, 0
    v_mov_b32 v124, 0
    v_mov_b32 v125, 0
    v_mov_b32 v126, 0
    v_mov_b32 v127, 0
    s_waitcnt vmcnt(6)
    s_barrier
    ds_read_b128 v[16:19], v128 offset:0
    ds_read_b128 v[20:23], v128 offset:4096
    ds_read_b128 v[24:27], v132 offset:0
    ds_read_b128 v[28:31], v132 offset:4096
    ds_read_b128 v[32:35], v129 offset:0
    ds_read_b128 v[36:39], v129 offset:4096
    ds_read_b128 v[40:43], v133 offset:0
    ds_read_b128 v[44:47], v133 offset:4096
    s_waitcnt lgkmcnt(4)
    v_mfma_f32_32x32x16_bf16 v[64:79], v[16:19], v[24:27], v[64:79]
    s_add_u32 m0, s18, 98304
    s_nop 0
    buffer_load_dwordx4 v48, s[4:7], s16 offen lds
    v_mfma_f32_32x32x16_bf16 v[80:95], v[20:23], v[24:27], v[80:95]
    v_mfma_f32_32x32x16_bf16 v[96:111], v[16:19], v[28:31], v[96:111]
    s_add_u32 m0, s18, 106496
    s_nop 0
    buffer_load_dwordx4 v49, s[4:7], s16 offen lds
    v_mfma_f32_32x32x16_bf16 v[112:127], v[20:23], v[28:31], v[112:127]
    ds_read_b128 v[16:19], v130 offset:0
    ds_read_b128 v[20:23], v130 offset:4096
    ds_read_b128 v[24:27], v134 offset:0
    ds_read_b128 v[28:31], v134 offset:4096
    s_waitcnt lgkmcnt(4)
    v_mfma_f32_32x32x16_bf16 v[64:79], v[32:35], v[40:43], v[64:79]
    s_add_u32 m0, s18, 114688
    s_nop 0
    buffer_load_dwordx4 v50, s[8:11], s17 offen lds
    v_mfma_f32_32x32x16_bf16 v[80:95], v[36:39], v[40:43], v[80:95]
    v_mfma_f32_32x32x16_bf16 v[96:111], v[32:35], v[44:47], v[96:111]
    v_mfma_f32_32x32x16_bf16 v[112:127], v[36:39], v[44:47], v[112:127]
    s_add_u32 m0, s18, 122880
    s_nop 0
    buffer_load_dwordx4 v51, s[8:11], s17 offen lds
    ds_read_b128 v[32:35], v131 offset:0
    ds_read_b128 v[36:39], v131 offset:4096
    ds_read_b128 v[40:43], v135 offset:0
    ds_read_b128 v[44:47], v135 offset:4096
    s_waitcnt lgkmcnt(4)
    v_mfma_f32_32x32x16_bf16 v[64:79], v[16:19], v[24:27], v[64:79]
    v_mfma_f32_32x32x16_bf16 v[80:95], v[20:23], v[24:27], v[80:95]
    s_add_u32 m0, s18, 131072
    s_nop 0
    buffer_load_dwordx4 v52, s[8:11], s17 offen lds
    v_mfma_f32_32x32x16_bf16 v[96:111], v[16:19], v[28:31], v[96:111]
    v_mfma_f32_32x32x16_bf16 v[112:127], v[20:23], v[28:31], v[112:127]
    s_add_u32 m0, s18, 139264
    s_nop 0
    buffer_load_dwordx4 v53, s[8:11], s17 offen lds
    s_waitcnt lgkmcnt(0)
    v_mfma_f32_32x32x16_bf16 v[64:79], v[32:35], v[40:43], v[64:79]
    v_mfma_f32_32x32x16_bf16 v[80:95], v[36:39], v[40:43], v[80:95]
    s_add_u32 s16, s16, 128
    s_add_u32 s17, s17, 128
    s_waitcnt vmcnt(6)
    s_barrier
    ds_read_b128 v[16:19], v136 offset:0
    ds_read_b128 v[20:23], v136 offset:4096
    ds_read_b128 v[24:27], v140 offset:0
    ds_read_b128 v[28:31], v140 offset:4096
    v_mfma_f32_32x32x16_bf16 v[96:111], v[32:35], v[44:47], v[96:111]
    v_mfma_f32_32x32x16_bf16 v[112:127], v[36:39], v[44:47], v[112:127]
    ds_read_b128 v[32:35], v137 offset:0
    ds_read_b128 v[36:39], v137 offset:4096
    ds_read_b128 v[40:43], v141 offset:0
    ds_read_b128 v[44:47], v141 offset:4096
    s_waitcnt lgkmcnt(4)
    v_mfma_f32_32x32x16_bf16 v[64:79], v[16:19], v[24:27], v[64:79]
    s_add_u32 m0, s18, 0
    s_nop 0
    buffer_load_dwordx4 v48, s[4:7], s16 offen lds
    v_mfma_f32_32x32x16_bf16 v[80:95], v[20:23], v[24:27], v[80:95]
    v_mfma_f32_32x32x16_bf16 v[96:111], v[16:19], v[28:31], v[96:111]
    s_add_u32 m0, s18, 8192
    s_nop 0
    buffer_load_dwordx4 v49, s[4:7], s16 offen lds
    v_mfma_f32_32x32x16_bf16 v[112:127], v[20:23], v[28:31], v[112:127]
    ds_read_b128 v[16:19], v138 offset:0
    ds_read_b128 v[20:23], v138 offset:4096
    ds_read_b128 v[24:27], v142 offset:0
    ds_read_b128 v[28:31], v142 offset:4096
    s_waitcnt lgkmcnt(4)
    v_mfma_f32_32x32x16_bf16 v[64:79], v[32:35], v[40:43], v[64:79]
    s_add_u32 m0, s18, 16384
    s_nop 0
    buffer_load_dwordx4 v50, s[8:11], s17 offen lds
    v_mfma_f32_32x32x16_bf16 v[80:95], v[36:39], v[40:43], v[80:95]
    v_mfma_f32_32x32x16_bf16 v[96:111], v[32:35], v[44:47], v[96:111]
    v_mfma_f32_32x32x16_bf16 v[112:127], v[36:39], v[44:47], v[112:127]
    s_add_u32 m0, s18, 24576
    s_nop 0
    buffer_load_dwordx4 v51, s[8:11], s17 offen lds
    ds_read_b128 v[32:35], v139 offset:0
    ds_read_b128 v[36:39], v139 offset:4096
    ds_read_b128 v[40:43], v143 offset:0
    ds_read_b128 v[44:47], v143 offset:4096
    s_waitcnt lgkmcnt(4)
    v_mfma_f32_32x32x16_bf16 v[64:79], v[16:19], v[24:27], v[64:79]
    v_mfma_f32_32x32x16_bf16 v[80:95], v[20:23], v[24:27], v[80:95]
    s_add_u32 m0, s18, 32768
    s_nop 0
    buffer_load_dwordx4 v52, s[8:11], s17 offen lds
    v_mfma_f32_32x32x16_bf16 v[96:111], v[16:19], v[28:31], v[96:111]
    v_mfma_f32_32x32x16_bf16 v[112:127], v[20:23], v[28:31], v[112:127]
    s_add_u32 m0, s18, 40960
    s_nop 0
    buffer_load_dwordx4 v53, s[8:11], s17 offen lds
    s_waitcnt lgkmcnt(0)
    v_mfma_f32_32x32x16_bf16 v[64:79], v[32:35], v[40:43], v[64:79]
    v_mfma_f32_32x32x16_bf16 v[80:95], v[36:39], v[40:43], v[80:95]
    s_add_u32 s16, s16, 128
    s_add_u32 s17, s17, 128
    s_waitcnt vmcnt(6)
    s_barrier
    ds_read_b128 v[16:19], v144 offset:0
    ds_read_b128 v[20:23], v144 offset:4096
    ds_read_b128 v[24:27], v148 offset:0
    ds_read_b128 v[28:31], v148 offset:4096
    v_mfma_f32_32x32x16_bf16 v[96:111], v[32:35], v[44:47], v[96:111]
    v_mfma_f32_32x32x16_bf16 v[112:127], v[36:39], v[44:47], v[112:127]
    ds_read_b128 v[32:35], v145 offset:0
    ds_read_b128 v[36:39], v145 offset:4096
    ds_read_b128 v[40:43], v149 offset:0
    ds_read_b128 v[44:47], v149 offset:4096
    s_waitcnt lgkmcnt(4)
    v_mfma_f32_32x32x16_bf16 v[64:79], v[16:19], v[24:27], v[64:79]
    s_add_u32 m0, s18, 49152
    s_nop 0
    buffer_load_dwordx4 v48, s[4:7], s16 offen lds
    v_mfma_f32_32x32x16_bf16 v[80:95], v[20:23], v[24:27], v[80:95]
    v_mfma_f32_32x32x16_bf16 v[96:111], v[16:19], v[28:31], v[96:111]
    s_add_u32 m0, s18, 57344
    s_nop 0
    buffer_load_dwordx4 v49, s[4:7], s16 offen lds
    v_mfma_f32_32x32x16_bf16 v[112:127], v[20:23], v[28:31], v[112:127]
    ds_read_b128 v[16:19], v146 offset:0
    ds_read_b128 v[20:23], v146 offset:4096
    ds_read_b128 v[24:27], v150 offset:0
    ds_read_b128 v[28:31], v150 offset:4096
    s_waitcnt lgkmcnt(4)
    v_mfma_f32_32x32x16_bf16 v[64:79], v[32:35], v[40:43], v[64:79]
    s_add_u32 m0, s18, 65536
    s_nop 0
    buffer_load_dwordx4 v50, s[8:11], s17 offen lds
    v_mfma_f32_32x32x16_bf16 v[80:95], v[36:39], v[40:43], v[80:95]
    v_mfma_f32_32x32x16_bf16 v[96:111], v[32:35], v[44:47], v[96:111]
    v_mfma_f32_32x32x16_bf16 v[112:127], v[36:39], v[44:47], v[112:127]
    s_add_u32 m0, s18, 73728
    s_nop 0
    buffer_load_dwordx4 v51, s[8:11], s17 offen lds
    ds_read_b128 v[32:35], v147 offset:0
    ds_read_b128 v[36:39], v147 offset:4096
    ds_read_b128 v[40:43], v151 offset:0
    ds_read_b128 v[44:47], v151 offset:4096
    s_waitcnt lgkmcnt(4)
    v_mfma_f32_32x32x16_bf16 v[64:79], v[16:19], v[24:27], v[64:79]
    v_mfma_f32_32x32x16_bf16 v[80:95], v[20:23], v[24:27], v[80:95]
    s_add_u32 m0, s18, 81920
    s_nop 0
    buffer_load_dwordx4 v52, s[8:11], s17 offen lds
    v_mfma_f32_32x32x16_bf16 v[96:111], v[16:19], v[28:31], v[96:111]
    v_mfma_f32_32x32x16_bf16 v[112:127], v[20:23], v[28:31], v[112:127]
    s_add_u32 m0, s18, 90112
    s_nop 0
    buffer_load_dwordx4 v53, s[8:11], s17 offen lds
    s_waitcnt lgkmcnt(0)
    v_mfma_f32_32x32x16_bf16 v[64:79], v[32:35], v[40:43], v[64:79]
    v_mfma_f32_32x32x16_bf16 v[80:95], v[36:39], v[40:43], v[80:95]
    s_add_u32 s16, s16, 128
    s_add_u32 s17, s17, 128
    s_waitcnt vmcnt(6)
    s_barrier
    ds_read_b128 v[16:19], v128 offset:0
    ds_read_b128 v[20:23], v128 offset:4096
    ds_read_b128 v[24:27], v132 offset:0
    ds_read_b128 v[28:31], v132 offset:4096
    v_mfma_f32_32x32x16_bf16 v[96:111], v[32:35], v[44:47], v[96:111]
    v_mfma_f32_32x32x16_bf16 v[112:127], v[36:39], v[44:47], v[112:127]
    ds_read_b128 v[32:35], v129 offset:0
    ds_read_b128 v[36:39], v129 offset:4096
    ds_read_b128 v[40:43], v133 offset:0
    ds_read_b128 v[44:47], v133 offset:4096
    s_waitcnt lgkmcnt(4)
    v_mfma_f32_32x32x16_bf16 v[64:79], v[16:19], v[24:27], v[64:79]
    s_add_u32 m0, s18, 98304
    s_nop 0
    buffer_load_dwordx4 v48, s[4:7], s16 offen lds
    v_mfma_f32_32x32x16_bf16 v[80:95], v[20:23], v[24:27], v[80:95]
    v_mfma_f32_32x32x16_bf16 v[96:111], v[16:19], v[28:31], v[96:111]
    s_add_u32 m0, s18, 106496
    s_nop 0
    buffer_load_dwordx4 v49, s[4:7], s16 offen lds
    v_mfma_f32_32x32x16_bf16 v[112:127], v[20:23], v[28:31], v[112:127]
    ds_read_b128 v[16:19], v130 offset:0
    ds_read_b128 v[20:23], v130 offset:4096
    ds_read_b128 v[24:27], v134 offset:0
    ds_read_b128 v[28:31], v134 offset:4096
    s_waitcnt lgkmcnt(4)
    v_mfma_f32_32x32x16_bf16 v[64:79], v[32:35], v[40:43], v[64:79]
    s_add_u32 m0, s18, 114688
    s_nop 0
    buffer_load_dwordx4 v50, s[8:11], s17 offen lds
    v_mfma_f32_32x32x16_bf16 v[80:95], v[36:39], v[40:43], v[80:95]
    v_mfma_f32_32x32x16_bf16 v[96:111], v[32:35], v[44:47], v[96:111]
    v_mfma_f32_32x32x16_bf16 v[112:127], v[36:39], v[44:47], v[112:127]
    s_add_u32 m0, s18, 122880
    s_nop 0
    buffer_load_dwordx4 v51, s[8:11], s17 offen lds
    ds_read_b128 v[32:35], v131 offset:0
    ds_read_b128 v[36:39], v131 offset:4096
    ds_read_b128 v[40:43], v135 offset:0
    ds_read_b128 v[44:47], v135 offset:4096
    s_waitcnt lgkmcnt(4)
    v_mfma_f32_32x32x16_bf16 v[64:79], v[16:19], v[24:27], v[64:79]
    v_mfma_f32_32x32x16_bf16 v[80:95], v[20:23], v[24:27], v[80:95]
    s_add_u32 m0, s18, 131072
    s_nop 0
    buffer_load_dwordx4 v52, s[8:11], s17 offen lds
    v_mfma_f32_32x32x16_bf16 v[96:111], v[16:19], v[28:31], v[96:111]
    v_mfma_f32_32x32x16_bf16 v[112:127], v[20:23], v[28:31], v[112:127]
    s_add_u32 m0, s18, 139264
    s_nop 0
    buffer_load_dwordx4 v53, s[8:11], s17 offen lds
    s_waitcnt lgkmcnt(0)
    v_mfma_f32_32x32x16_bf16 v[64:79], v[32:35], v[40:43], v[64:79]
    v_mfma_f32_32x32x16_bf16 v[80:95], v[36:39], v[40:43], v[80:95]
    s_add_u32 s16, s16, 128
    s_add_u32 s17, s17, 128
    s_waitcnt vmcnt(6)
    s_barrier
    ds_read_b128 v[16:19], v136 offset:0
    ds_read_b128 v[20:23], v136 offset:4096
    ds_read_b128 v[24:27], v140 offset:0
    ds_read_b128 v[28:31], v140 offset:4096
    v_mfma_f32_32x32x16_bf16 v[96:111], v[32:35], v[44:47], v[96:111]
    v_mfma_f32_32x32x16_bf16 v[112:127], v[36:39], v[44:47], v[112:127]
    ds_read_b128 v[32:35], v137 offset:0
    ds_read_b128 v[36:39], v137 offset:4096
    ds_read_b128 v[40:43], v141 offset:0
    ds_read_b128 v[44:47], v141 offset:4096
    s_waitcnt lgkmcnt(4)
    v_mfma_f32_32x32x16_bf16 v[64:79], v[16:19], v[24:27], v[64:79]
    s_add_u32 m0, s18, 0
    s_nop 0
    buffer_load_dwordx4 v48, s[4:7], s16 offen lds
    v_mfma_f32_32x32x16_bf16 v[80:95], v[20:23], v[24:27], v[80:95]
    v_mfma_f32_32x32x16_bf16 v[96:111], v[16:19], v[28:31], v[96:111]
    s_add_u32 m0, s18, 8192
    s_nop 0
    buffer_load_dwordx4 v49, s[4:7], s16 offen lds
    v_mfma_f32_32x32x16_bf16 v[112:127], v[20:23], v[28:31], v[112:127]
    ds_read_b128 v[16:19], v138 offset:0
    ds_read_b128 v[20:23], v138 offset:4096
    ds_read_b128 v[24:27], v142 offset:0
    ds_read_b128 v[28:31], v142 offset:4096
    s_waitcnt lgkmcnt(4)
    v_mfma_f32_32x32x16_bf16 v[64:79], v[32:35], v[40:43], v[64:79]
    s_add_u32 m0, s18, 16384
    s_nop 0
    buffer_load_dwordx4 v50, s[8:11], s17 offen lds
    v_mfma_f32_32x32x16_bf16 v[80:95], v[36:39], v[40:43], v[80:95]
    v_mfma_f32_32x32x16_bf16 v[96:111], v[32:35], v[44:47], v[96:111]
    v_mfma_f32_32x32x16_bf16 v[112:127], v[36:39], v[44:47], v[112:127]
    s_add_u32 m0, s18, 24576
    s_nop 0
    buffer_load_dwordx4 v51, s[8:11], s17 offen lds
    ds_read_b128 v[32:35], v139 offset:0
    ds_read_b128 v[36:39], v139 offset:4096
    ds_read_b128 v[40:43], v143 offset:0
    ds_read_b128 v[44:47], v143 offset:4096
    s_waitcnt lgkmcnt(4)
    v_mfma_f32_32x32x16_bf16 v[64:79], v[16:19], v[24:27], v[64:79]
    v_mfma_f32_32x32x16_bf16 v[80:95], v[20:23], v[24:27], v[80:95]
    s_add_u32 m0, s18, 32768
    s_nop 0
    buffer_load_dwordx4 v52, s[8:11], s17 offen lds
    v_mfma_f32_32x32x16_bf16 v[96:111], v[16:19], v[28:31], v[96:111]
    v_mfma_f32_32x32x16_bf16 v[112:127], v[20:23], v[28:31], v[112:127]
    s_add_u32 m0, s18, 40960
    s_nop 0
    buffer_load_dwordx4 v53, s[8:11], s17 offen lds
    s_waitcnt lgkmcnt(0)
    v_mfma_f32_32x32x16_bf16 v[64:79], v[32:35], v[40:43], v[64:79]
    v_mfma_f32_32x32x16_bf16 v[80:95], v[36:39], v[40:43], v[80:95]
    s_add_u32 s16, s16, 128
    s_add_u32 s17, s17, 128
    s_waitcnt vmcnt(6)
    s_barrier
    ds_read_b128 v[16:19], v144 offset:0
    ds_read_b128 v[20:23], v144 offset:4096
    ds_read_b128 v[24:27], v148 offset:0
    ds_read_b128 v[28:31], v148 offset:4096
    v_mfma_f32_32x32x16_bf16 v[96:111], v[32:35], v[44:47], v[96:111]
    v_mfma_f32_32x32x16_bf16 v[112:127], v[36:39], v[44:47], v[112:127]
    ds_read_b128 v[32:35], v145 offset:0
    ds_read_b128 v[36:39], v145 offset:4096
    ds_read_b128 v[40:43], v149 offset:0
    ds_read_b128 v[44:47], v149 offset:4096
    s_waitcnt lgkmcnt(4)
    v_mfma_f32_32x32x16_bf16 v[64:79], v[16:19], v[24:27], v[64:79]
    s_add_u32 m0, s18, 49152
    s_nop 0
    buffer_load_dwordx4 v48, s[4:7], s16 offen lds
    v_mfma_f32_32x32x16_bf16 v[80:95], v[20:23], v[24:27], v[80:95]
    v_mfma_f32_32x32x16_bf16 v[96:111], v[16:19], v[28:31], v[96:111]
    s_add_u32 m0, s18, 57344
    s_nop 0
    buffer_load_dwordx4 v49, s[4:7], s16 offen lds
    v_mfma_f32_32x32x16_bf16 v[112:127], v[20:23], v[28:31], v[112:127]
    ds_read_b128 v[16:19], v146 offset:0
    ds_read_b128 v[20:23], v146 offset:4096
    ds_read_b128 v[24:27], v150 offset:0
    ds_read_b128 v[28:31], v150 offset:4096
    s_waitcnt lgkmcnt(4)
    v_mfma_f32_32x32x16_bf16 v[64:79], v[32:35], v[40:43], v[64:79]
    s_add_u32 m0, s18, 65536
    s_nop 0
    buffer_load_dwordx4 v50, s[8:11], s17 offen lds
    v_mfma_f32_32x32x16_bf16 v[80:95], v[36:39], v[40:43], v[80:95]
    v_mfma_f32_32x32x16_bf16 v[96:111], v[32:35], v[44:47], v[96:111]
    v_mfma_f32_32x32x16_bf16 v[112:127], v[36:39], v[44:47], v[112:127]
    s_add_u32 m0, s18, 73728
    s_nop 0
    buffer_load_dwordx4 v51, s[8:11], s17 offen lds
    ds_read_b128 v[32:35], v147 offset:0
    ds_read_b128 v[36:39], v147 offset:4096
    ds_read_b128 v[40:43], v151 offset:0
    ds_read_b128 v[44:47], v151 offset:4096
    s_waitcnt lgkmcnt(4)
    v_mfma_f32_32x32x16_bf16 v[64:79], v[16:19], v[24:27], v[64:79]
    v_mfma_f32_32x32x16_bf16 v[80:95], v[20:23], v[24:27], v[80:95]
    s_add_u32 m0, s18, 81920
    s_nop 0
    buffer_load_dwordx4 v52, s[8:11], s17 offen lds
    v_mfma_f32_32x32x16_bf16 v[96:111], v[16:19], v[28:31], v[96:111]
    v_mfma_f32_32x32x16_bf16 v[112:127], v[20:23], v[28:31], v[112:127]
    s_add_u32 m0, s18, 90112
    s_nop 0
    buffer_load_dwordx4 v53, s[8:11], s17 offen lds
    s_waitcnt lgkmcnt(0)
    v_mfma_f32_32x32x16_bf16 v[64:79], v[32:35], v[40:43], v[64:79]
    v_mfma_f32_32x32x16_bf16 v[80:95], v[36:39], v[40:43], v[80:95]
    s_add_u32 s16, s16, 128
    s_add_u32 s17, s17, 128
    s_waitcnt vmcnt(6)
    s_barrier
    ds_read_b128 v[16:19], v128 offset:0
    ds_read_b128 v[20:23], v128 offset:4096
    ds_read_b128 v[24:27], v132 offset:0
    ds_read_b128 v[28:31], v132 offset:4096
    v_mfma_f32_32x32x16_bf16 v[96:111], v[32:35], v[44:47], v[96:111]
    v_mfma_f32_32x32x16_bf16 v[112:127], v[36:39], v[44:47], v[112:127]
    ds_read_b128 v[32:35], v129 offset:0
    ds_read_b128 v[36:39], v129 offset:4096
    ds_read_b128 v[40:43], v133 offset:0
    ds_read_b128 v[44:47], v133 offset:4096
    s_waitcnt lgkmcnt(4)
    v_mfma_f32_32x32x16_bf16 v[64:79], v[16:19], v[24:27], v[64:79]
    s_add_u32 m0, s18, 98304
    s_nop 0
    buffer_load_dwordx4 v48, s[4:7], s16 offen lds
    v_mfma_f32_32x32x16_bf16 v[80:95], v[20:23], v[24:27], v[80:95]
    v_mfma_f32_32x32x16_bf16 v[96:111], v[16:19], v[28:31], v[96:111]
    s_add_u32 m0, s18, 106496
    s_nop 0
    buffer_load_dwordx4 v49, s[4:7], s16 offen lds
    v_mfma_f32_32x32x16_bf16 v[112:127], v[20:23], v[28:31], v[112:127]
    ds_read_b128 v[16:19], v130 offset:0
    ds_read_b128 v[20:23], v130 offset:4096
    ds_read_b128 v[24:27], v134 offset:0
    ds_read_b128 v[28:31], v134 offset:4096
    s_waitcnt lgkmcnt(4)
    v_mfma_f32_32x32x16_bf16 v[64:79], v[32:35], v[40:43], v[64:79]
    s_add_u32 m0, s18, 114688
    s_nop 0
    buffer_load_dwordx4 v50, s[8:11], s17 offen lds
    v_mfma_f32_32x32x16_bf16 v[80:95], v[36:39], v[40:43], v[80:95]
    v_mfma_f32_32x32x16_bf16 v[96:111], v[32:35], v[44:47], v[96:111]
    v_mfma_f32_32x32x16_bf16 v[112:127], v[36:39], v[44:47], v[112:127]
    s_add_u32 m0, s18, 122880
    s_nop 0
    buffer_load_dwordx4 v51, s[8:11], s17 offen lds
    ds_read_b128 v[32:35], v131 offset:0
    ds_read_b128 v[36:39], v131 offset:4096
    ds_read_b128 v[40:43], v135 offset:0
    ds_read_b128 v[44:47], v135 offset:4096
    s_waitcnt lgkmcnt(4)
    v_mfma_f32_32x32x16_bf16 v[64:79], v[16:19], v[24:27], v[64:79]
    v_mfma_f32_32x32x16_bf16 v[80:95], v[20:23], v[24:27], v[80:95]
    s_add_u32 m0, s18, 131072
    s_nop 0
    buffer_load_dwordx4 v52, s[8:11], s17 offen lds
    v_mfma_f32_32x32x16_bf16 v[96:111], v[16:19], v[28:31], v[96:111]
    v_mfma_f32_32x32x16_bf16 v[112:127], v[20:23], v[28:31], v[112:127]
    s_add_u32 m0, s18, 139264
    s_nop 0
    buffer_load_dwordx4 v53, s[8:11], s17 offen lds
    s_waitcnt lgkmcnt(0)
    v_mfma_f32_32x32x16_bf16 v[64:79], v[32:35], v[40:43], v[64:79]
    v_mfma_f32_32x32x16_bf16 v[80:95], v[36:39], v[40:43], v[80:95]
    s_add_u32 s16, s16, 128
    s_add_u32 s17, s17, 128
    s_waitcnt vmcnt(6)
    s_barrier
    ds_read_b128 v[16:19], v136 offset:0
    ds_read_b128 v[20:23], v136 offset:4096
    ds_read_b128 v[24:27], v140 offset:0
    ds_read_b128 v[28:31], v140 offset:4096
    v_mfma_f32_32x32x16_bf16 v[96:111], v[32:35], v[44:47], v[96:111]
    v_mfma_f32_32x32x16_bf16 v[112:127], v[36:39], v[44:47], v[112:127]
    ds_read_b128 v[32:35], v137 offset:0
    ds_read_b128 v[36:39], v137 offset:4096
    ds_read_b128 v[40:43], v141 offset:0
    ds_read_b128 v[44:47], v141 offset:4096
    s_waitcnt lgkmcnt(4)
    v_mfma_f32_32x32x16_bf16 v[64:79], v[16:19], v[24:27], v[64:79]
    s_add_u32 m0, s18, 0
    s_nop 0
    buffer_load_dwordx4 v48, s[4:7], s16 offen lds
    v_mfma_f32_32x32x16_bf16 v[80:95], v[20:23], v[24:27], v[80:95]
    v_mfma_f32_32x32x16_bf16 v[96:111], v[16:19], v[28:31], v[96:111]
    s_add_u32 m0, s18, 8192
    s_nop 0
    buffer_load_dwordx4 v49, s[4:7], s16 offen lds
    v_mfma_f32_32x32x16_bf16 v[112:127], v[20:23], v[28:31], v[112:127]
    ds_read_b128 v[16:19], v138 offset:0
    ds_read_b128 v[20:23], v138 offset:4096
    ds_read_b128 v[24:27], v142 offset:0
    ds_read_b128 v[28:31], v142 offset:4096
    s_waitcnt lgkmcnt(4)
    v_mfma_f32_32x32x16_bf16 v[64:79], v[32:35], v[40:43], v[64:79]
    s_add_u32 m0, s18, 16384
    s_nop 0
    buffer_load_dwordx4 v50, s[8:11], s17 offen lds
    v_mfma_f32_32x32x16_bf16 v[80:95], v[36:39], v[40:43], v[80:95]
    v_mfma_f32_32x32x16_bf16 v[96:111], v[32:35], v[44:47], v[96:111]
    v_mfma_f32_32x32x16_bf16 v[112:127], v[36:39], v[44:47], v[112:127]
    s_add_u32 m0, s18, 24576
    s_nop 0
    buffer_load_dwordx4 v51, s[8:11], s17 offen lds
    ds_read_b128 v[32:35], v139 offset:0
    ds_read_b128 v[36:39], v139 offset:4096
    ds_read_b128 v[40:43], v143 offset:0
    ds_read_b128 v[44:47], v143 offset:4096
    s_waitcnt lgkmcnt(4)
    v_mfma_f32_32x32x16_bf16 v[64:79], v[16:19], v[24:27], v[64:79]
    v_mfma_f32_32x32x16_bf16 v[80:95], v[20:23], v[24:27], v[80:95]
    s_add_u32 m0, s18, 32768
    s_nop 0
    buffer_load_dwordx4 v52, s[8:11], s17 offen lds
    v_mfma_f32_32x32x16_bf16 v[96:111], v[16:19], v[28:31], v[96:111]
    v_mfma_f32_32x32x16_bf16 v[112:127], v[20:23], v[28:31], v[112:127]
    s_add_u32 m0, s18, 40960
    s_nop 0
    buffer_load_dwordx4 v53, s[8:11], s17 offen lds
    s_waitcnt lgkmcnt(0)
    v_mfma_f32_32x32x16_bf16 v[64:79], v[32:35], v[40:43], v[64:79]
    v_mfma_f32_32x32x16_bf16 v[80:95], v[36:39], v[40:43], v[80:95]
    s_add_u32 s16, s16, 128
    s_add_u32 s17, s17, 128
    s_waitcnt vmcnt(6)
    s_barrier
    ds_read_b128 v[16:19], v144 offset:0
    ds_read_b128 v[20:23], v144 offset:4096
    ds_read_b128 v[24:27], v148 offset:0
    ds_read_b128 v[28:31], v148 offset:4096
    v_mfma_f32_32x32x16_bf16 v[96:111], v[32:35], v[44:47], v[96:111]
    v_mfma_f32_32x32x16_bf16 v[112:127], v[36:39], v[44:47], v[112:127]
    ds_read_b128 v[32:35], v145 offset:0
    ds_read_b128 v[36:39], v145 offset:4096
    ds_read_b128 v[40:43], v149 offset:0
    ds_read_b128 v[44:47], v149 offset:4096
    s_waitcnt lgkmcnt(4)
    v_mfma_f32_32x32x16_bf16 v[64:79], v[16:19], v[24:27], v[64:79]
    s_add_u32 m0, s18, 49152
    s_nop 0
    buffer_load_dwordx4 v48, s[4:7], s16 offen lds
    v_mfma_f32_32x32x16_bf16 v[80:95], v[20:23], v[24:27], v[80:95]
    v_mfma_f32_32x32x16_bf16 v[96:111], v[16:19], v[28:31], v[96:111]
    s_add_u32 m0, s18, 57344
    s_nop 0
    buffer_load_dwordx4 v49, s[4:7], s16 offen lds
    v_mfma_f32_32x32x16_bf16 v[112:127], v[20:23], v[28:31], v[112:127]
    ds_read_b128 v[16:19], v146 offset:0
    ds_read_b128 v[20:23], v146 offset:4096
    ds_read_b128 v[24:27], v150 offset:0
    ds_read_b128 v[28:31], v150 offset:4096
    s_waitcnt lgkmcnt(4)
    v_mfma_f32_32x32x16_bf16 v[64:79], v[32:35], v[40:43], v[64:79]
    s_add_u32 m0, s18, 65536
    s_nop 0
    buffer_load_dwordx4 v50, s[8:11], s17 offen lds
    v_mfma_f32_32x32x16_bf16 v[80:95], v[36:39], v[40:43], v[80:95]
    v_mfma_f32_32x32x16_bf16 v[96:111], v[32:35], v[44:47], v[96:111]
    v_mfma_f32_32x32x16_bf16 v[112:127], v[36:39], v[44:47], v[112:127]
    s_add_u32 m0, s18, 73728
    s_nop 0
    buffer_load_dwordx4 v51, s[8:11], s17 offen lds
    ds_read_b128 v[32:35], v147 offset:0
    ds_read_b128 v[36:39], v147 offset:4096
    ds_read_b128 v[40:43], v151 offset:0
    ds_read_b128 v[44:47], v151 offset:4096
    s_waitcnt lgkmcnt(4)
    v_mfma_f32_32x32x16_bf16 v[64:79], v[16:19], v[24:27], v[64:79]
    v_mfma_f32_32x32x16_bf16 v[80:95], v[20:23], v[24:27], v[80:95]
    s_add_u32 m0, s18, 81920
    s_nop 0
    buffer_load_dwordx4 v52, s[8:11], s17 offen lds
    v_mfma_f32_32x32x16_bf16 v[96:111], v[16:19], v[28:31], v[96:111]
    v_mfma_f32_32x32x16_bf16 v[112:127], v[20:23], v[28:31], v[112:127]
    s_add_u32 m0, s18, 90112
    s_nop 0
    buffer_load_dwordx4 v53, s[8:11], s17 offen lds
    s_waitcnt lgkmcnt(0)
    v_mfma_f32_32x32x16_bf16 v[64:79], v[32:35], v[40:43], v[64:79]
    v_mfma_f32_32x32x16_bf16 v[80:95], v[36:39], v[40:43], v[80:95]
    s_add_u32 s16, s16, 128
    s_add_u32 s17, s17, 128
    s_waitcnt vmcnt(6)
    s_barrier
    ds_read_b128 v[16:19], v128 offset:0
    ds_read_b128 v[20:23], v128 offset:4096
    ds_read_b128 v[24:27], v132 offset:0
    ds_read_b128 v[28:31], v132 offset:4096
    v_mfma_f32_32x32x16_bf16 v[96:111], v[32:35], v[44:47], v[96:111]
    v_mfma_f32_32x32x16_bf16 v[112:127], v[36:39], v[44:47], v[112:127]
    ds_read_b128 v[32:35], v129 offset:0
    ds_read_b128 v[36:39], v129 offset:4096
    ds_read_b128 v[40:43], v133 offset:0
    ds_read_b128 v[44:47], v133 offset:4096
    s_waitcnt lgkmcnt(4)
    v_mfma_f32_32x32x16_bf16 v[64:79], v[16:19], v[24:27], v[64:79]
    s_add_u32 m0, s18, 98304
    s_nop 0
    buffer_load_dwordx4 v48, s[4:7], s16 offen lds
    v_mfma_f32_32x32x16_bf16 v[80:95], v[20:23], v[24:27], v[80:95]
    v_mfma_f32_32x32x16_bf16 v[96:111], v[16:19], v[28:31], v[96:111]
    s_add_u32 m0, s18, 106496
    s_nop 0
    buffer_load_dwordx4 v49, s[4:7], s16 offen lds
    v_mfma_f32_32x32x16_bf16 v[112:127], v[20:23], v[28:31], v[112:127]
    ds_read_b128 v[16:19], v130 offset:0
    ds_read_b128 v[20:23], v130 offset:4096
    ds_read_b128 v[24:27], v134 offset:0
    ds_read_b128 v[28:31], v134 offset:4096
    s_waitcnt lgkmcnt(4)
    v_mfma_f32_32x32x16_bf16 v[64:79], v[32:35], v[40:43], v[64:79]
    s_add_u32 m0, s18, 114688
    s_nop 0
    buffer_load_dwordx4 v50, s[8:11], s17 offen lds
    v_mfma_f32_32x32x16_bf16 v[80:95], v[36:39], v[40:43], v[80:95]
    v_mfma_f32_32x32x16_bf16 v[96:111], v[32:35], v[44:47], v[96:111]
    v_mfma_f32_32x32x16_bf16 v[112:127], v[36:39], v[44:47], v[112:127]
    s_add_u32 m0, s18, 122880
    s_nop 0
    buffer_load_dwordx4 v51, s[8:11], s17 offen lds
    ds_read_b128 v[32:35], v131 offset:0
    ds_read_b128 v[36:39], v131 offset:4096
    ds_read_b128 v[40:43], v135 offset:0
    ds_read_b128 v[44:47], v135 offset:4096
    s_waitcnt lgkmcnt(4)
    v_mfma_f32_32x32x16_bf16 v[64:79], v[16:19], v[24:27], v[64:79]
    v_mfma_f32_32x32x16_bf16 v[80:95], v[20:23], v[24:27], v[80:95]
    s_add_u32 m0, s18, 131072
    s_nop 0
    buffer_load_dwordx4 v52, s[8:11], s17 offen lds
    v_mfma_f32_32x32x16_bf16 v[96:111], v[16:19], v[28:31], v[96:111]
    v_mfma_f32_32x32x16_bf16 v[112:127], v[20:23], v[28:31], v[112:127]
    s_add_u32 m0, s18, 139264
    s_nop 0
    buffer_load_dwordx4 v53, s[8:11], s17 offen lds
    s_waitcnt lgkmcnt(0)
    v_mfma_f32_32x32x16_bf16 v[64:79], v[32:35], v[40:43], v[64:79]
    v_mfma_f32_32x32x16_bf16 v[80:95], v[36:39], v[40:43], v[80:95]
    s_add_u32 s16, s16, 128
    s_add_u32 s17, s17, 128
    s_waitcnt vmcnt(6)
    s_barrier
    ds_read_b128 v[16:19], v136 offset:0
    ds_read_b128 v[20:23], v136 offset:4096
    ds_read_b128 v[24:27], v140 offset:0
    ds_read_b128 v[28:31], v140 offset:4096
    v_mfma_f32_32x32x16_bf16 v[96:111], v[32:35], v[44:47], v[96:111]
    v_mfma_f32_32x32x16_bf16 v[112:127], v[36:39], v[44:47], v[112:127]
    ds_read_b128 v[32:35], v137 offset:0
    ds_read_b128 v[36:39], v137 offset:4096
    ds_read_b128 v[40:43], v141 offset:0
    ds_read_b128 v[44:47], v141 offset:4096
    s_waitcnt lgkmcnt(4)
    v_mfma_f32_32x32x16_bf16 v[64:79], v[16:19], v[24:27], v[64:79]
    s_add_u32 m0, s18, 0
    s_nop 0
    buffer_load_dwordx4 v48, s[4:7], s16 offen lds
    v_mfma_f32_32x32x16_bf16 v[80:95], v[20:23], v[24:27], v[80:95]
    v_mfma_f32_32x32x16_bf16 v[96:111], v[16:19], v[28:31], v[96:111]
    s_add_u32 m0, s18, 8192
    s_nop 0
    buffer_load_dwordx4 v49, s[4:7], s16 offen lds
    v_mfma_f32_32x32x16_bf16 v[112:127], v[20:23], v[28:31], v[112:127]
    ds_read_b128 v[16:19], v138 offset:0
    ds_read_b128 v[20:23], v138 offset:4096
    ds_read_b128 v[24:27], v142 offset:0
    ds_read_b128 v[28:31], v142 offset:4096
    s_waitcnt lgkmcnt(4)
    v_mfma_f32_32x32x16_bf16 v[64:79], v[32:35], v[40:43], v[64:79]
    s_add_u32 m0, s18, 16384
    s_nop 0
    buffer_load_dwordx4 v50, s[8:11], s17 offen lds
    v_mfma_f32_32x32x16_bf16 v[80:95], v[36:39], v[40:43], v[80:95]
    v_mfma_f32_32x32x16_bf16 v[96:111], v[32:35], v[44:47], v[96:111]
    v_mfma_f32_32x32x16_bf16 v[112:127], v[36:39], v[44:47], v[112:127]
    s_add_u32 m0, s18, 24576
    s_nop 0
    buffer_load_dwordx4 v51, s[8:11], s17 offen lds
    ds_read_b128 v[32:35], v139 offset:0
    ds_read_b128 v[36:39], v139 offset:4096
    ds_read_b128 v[40:43], v143 offset:0
    ds_read_b128 v[44:47], v143 offset:4096
    s_waitcnt lgkmcnt(4)
    v_mfma_f32_32x32x16_bf16 v[64:79], v[16:19], v[24:27], v[64:79]
    v_mfma_f32_32x32x16_bf16 v[80:95], v[20:23], v[24:27], v[80:95]
    s_add_u32 m0, s18, 32768
    s_nop 0
    buffer_load_dwordx4 v52, s[8:11], s17 offen lds
    v_mfma_f32_32x32x16_bf16 v[96:111], v[16:19], v[28:31], v[96:111]
    v_mfma_f32_32x32x16_bf16 v[112:127], v[20:23], v[28:31], v[112:127]
    s_add_u32 m0, s18, 40960
    s_nop 0
    buffer_load_dwordx4 v53, s[8:11], s17 offen lds
    s_waitcnt lgkmcnt(0)
    v_mfma_f32_32x32x16_bf16 v[64:79], v[32:35], v[40:43], v[64:79]
    v_mfma_f32_32x32x16_bf16 v[80:95], v[36:39], v[40:43], v[80:95]
    s_add_u32 s16, s16, 128
    s_add_u32 s17, s17, 128
    s_waitcnt vmcnt(6)
    s_barrier
    ds_read_b128 v[16:19], v144 offset:0
    ds_read_b128 v[20:23], v144 offset:4096
    ds_read_b128 v[24:27], v148 offset:0
    ds_read_b128 v[28:31], v148 offset:4096
    v_mfma_f32_32x32x16_bf16 v[96:111], v[32:35], v[44:47], v[96:111]
    v_mfma_f32_32x32x16_bf16 v[112:127], v[36:39], v[44:47], v[112:127]
    ds_read_b128 v[32:35], v145 offset:0
    ds_read_b128 v[36:39], v145 offset:4096
    ds_read_b128 v[40:43], v149 offset:0
    ds_read_b128 v[44:47], v149 offset:4096
    s_waitcnt lgkmcnt(4)
    v_mfma_f32_32x32x16_bf16 v[64:79], v[16:19], v[24:27], v[64:79]
    s_add_u32 m0, s18, 49152
    s_nop 0
    buffer_load_dwordx4 v48, s[4:7], s16 offen lds
    v_mfma_f32_32x32x16_bf16 v[80:95], v[20:23], v[24:27], v[80:95]
    v_mfma_f32_32x32x16_bf16 v[96:111], v[16:19], v[28:31], v[96:111]
    s_add_u32 m0, s18, 57344
    s_nop 0
    buffer_load_dwordx4 v49, s[4:7], s16 offen lds
    v_mfma_f32_32x32x16_bf16 v[112:127], v[20:23], v[28:31], v[112:127]
    ds_read_b128 v[16:19], v146 offset:0
    ds_read_b128 v[20:23], v146 offset:4096
    ds_read_b128 v[24:27], v150 offset:0
    ds_read_b128 v[28:31], v150 offset:4096
    s_waitcnt lgkmcnt(4)
    v_mfma_f32_32x32x16_bf16 v[64:79], v[32:35], v[40:43], v[64:79]
    s_add_u32 m0, s18, 65536
    s_nop 0
    buffer_load_dwordx4 v50, s[8:11], s17 offen lds
    v_mfma_f32_32x32x16_bf16 v[80:95], v[36:39], v[40:43], v[80:95]
    v_mfma_f32_32x32x16_bf16 v[96:111], v[32:35], v[44:47], v[96:111]
    v_mfma_f32_32x32x16_bf16 v[112:127], v[36:39], v[44:47], v[112:127]
    s_add_u32 m0, s18, 73728
    s_nop 0
    buffer_load_dwordx4 v51, s[8:11], s17 offen lds
    ds_read_b128 v[32:35], v147 offset:0
    ds_read_b128 v[36:39], v147 offset:4096
    ds_read_b128 v[40:43], v151 offset:0
    ds_read_b128 v[44:47], v151 offset:4096
    s_waitcnt lgkmcnt(4)
    v_mfma_f32_32x32x16_bf16 v[64:79], v[16:19], v[24:27], v[64:79]
    v_mfma_f32_32x32x16_bf16 v[80:95], v[20:23], v[24:27], v[80:95]
    s_add_u32 m0, s18, 81920
    s_nop 0
    buffer_load_dwordx4 v52, s[8:11], s17 offen lds
    v_mfma_f32_32x32x16_bf16 v[96:111], v[16:19], v[28:31], v[96:111]
    v_mfma_f32_32x32x16_bf16 v[112:127], v[20:23], v[28:31], v[112:127]
    s_add_u32 m0, s18, 90112
    s_nop 0
    buffer_load_dwordx4 v53, s[8:11], s17 offen lds
    s_waitcnt lgkmcnt(0)
    v_mfma_f32_32x32x16_bf16 v[64:79], v[32:35], v[40:43], v[64:79]
    v_mfma_f32_32x32x16_bf16 v[80:95], v[36:39], v[40:43], v[80:95]
    s_add_u32 s16, s16, 128
    s_add_u32 s17, s17, 128
    s_waitcnt vmcnt(6)
    s_barrier
    ds_read_b128 v[16:19], v128 offset:0
    ds_read_b128 v[20:23], v128 offset:4096
    ds_read_b128 v[24:27], v132 offset:0
    ds_read_b128 v[28:31], v132 offset:4096
    v_mfma_f32_32x32x16_bf16 v[96:111], v[32:35], v[44:47], v[96:111]
    v_mfma_f32_32x32x16_bf16 v[112:127], v[36:39], v[44:47], v[112:127]
    ds_read_b128 v[32:35], v129 offset:0
    ds_read_b128 v[36:39], v129 offset:4096
    ds_read_b128 v[40:43], v133 offset:0
    ds_read_b128 v[44:47], v133 offset:4096
    s_waitcnt lgkmcnt(4)
    v_mfma_f32_32x32x16_bf16 v[64:79], v[16:19], v[24:27], v[64:79]
    s_add_u32 m0, s18, 98304
    s_nop 0
    buffer_load_dwordx4 v48, s[4:7], s16 offen lds
    v_mfma_f32_32x32x16_bf16 v[80:95], v[20:23], v[24:27], v[80:95]
    v_mfma_f32_32x32x16_bf16 v[96:111], v[16:19], v[28:31], v[96:111]
    s_add_u32 m0, s18, 106496
    s_nop 0
    buffer_load_dwordx4 v49, s[4:7], s16 offen lds
    v_mfma_f32_32x32x16_bf16 v[112:127], v[20:23], v[28:31], v[112:127]
    ds_read_b128 v[16:19], v130 offset:0
    ds_read_b128 v[20:23], v130 offset:4096
    ds_read_b128 v[24:27], v134 offset:0
    ds_read_b128 v[28:31], v134 offset:4096
    s_waitcnt lgkmcnt(4)
    v_mfma_f32_32x32x16_bf16 v[64:79], v[32:35], v[40:43], v[64:79]
    s_add_u32 m0, s18, 114688
    s_nop 0
    buffer_load_dwordx4 v50, s[8:11], s17 offen lds
    v_mfma_f32_32x32x16_bf16 v[80:95], v[36:39], v[40:43], v[80:95]
    v_mfma_f32_32x32x16_bf16 v[96:111], v[32:35], v[44:47], v[96:111]
    v_mfma_f32_32x32x16_bf16 v[112:127], v[36:39], v[44:47], v[112:127]
    s_add_u32 m0, s18, 122880
    s_nop 0
    buffer_load_dwordx4 v51, s[8:11], s17 offen lds
    ds_read_b128 v[32:35], v131 offset:0
    ds_read_b128 v[36:39], v131 offset:4096
    ds_read_b128 v[40:43], v135 offset:0
    ds_read_b128 v[44:47], v135 offset:4096
    s_waitcnt lgkmcnt(4)
    v_mfma_f32_32x32x16_bf16 v[64:79], v[16:19], v[24:27], v[64:79]
    v_mfma_f32_32x32x16_bf16 v[80:95], v[20:23], v[24:27], v[80:95]
    s_add_u32 m0, s18, 131072
    s_nop 0
    buffer_load_dwordx4 v52, s[8:11], s17 offen lds
    v_mfma_f32_32x32x16_bf16 v[96:111], v[16:19], v[28:31], v[96:111]
    v_mfma_f32_32x32x16_bf16 v[112:127], v[20:23], v[28:31], v[112:127]
    s_add_u32 m0, s18, 139264
    s_nop 0
    buffer_load_dwordx4 v53, s[8:11], s17 offen lds
    s_waitcnt lgkmcnt(0)
    v_mfma_f32_32x32x16_bf16 v[64:79], v[32:35], v[40:43], v[64:79]
    v_mfma_f32_32x32x16_bf16 v[80:95], v[36:39], v[40:43], v[80:95]
    s_add_u32 s16, s16, 128
    s_add_u32 s17, s17, 128
    s_waitcnt vmcnt(6)
    s_barrier
    ds_read_b128 v[16:19], v136 offset:0
    ds_read_b128 v[20:23], v136 offset:4096
    ds_read_b128 v[24:27], v140 offset:0
    ds_read_b128 v[28:31], v140 offset:4096
    v_mfma_f32_32x32x16_bf16 v[96:111], v[32:35], v[44:47], v[96:111]
    v_mfma_f32_32x32x16_bf16 v[112:127], v[36:39], v[44:47], v[112:127]
    ds_read_b128 v[32:35], v137 offset:0
    ds_read_b128 v[36:39], v137 offset:4096
    ds_read_b128 v[40:43], v141 offset:0
    ds_read_b128 v[44:47], v141 offset:4096
    s_waitcnt lgkmcnt(4)
    v_mfma_f32_32x32x16_bf16 v[64:79], v[16:19], v[24:27], v[64:79]
    s_add_u32 m0, s18, 0
    s_nop 0
    buffer_load_dwordx4 v48, s[4:7], s16 offen lds
    v_mfma_f32_32x32x16_bf16 v[80:95], v[20:23], v[24:27], v[80:95]
    v_mfma_f32_32x32x16_bf16 v[96:111], v[16:19], v[28:31], v[96:111]
    s_add_u32 m0, s18, 8192
    s_nop 0
    buffer_load_dwordx4 v49, s[4:7], s16 offen lds
    v_mfma_f32_32x32x16_bf16 v[112:127], v[20:23], v[28:31], v[112:127]
    ds_read_b128 v[16:19], v138 offset:0
    ds_read_b128 v[20:23], v138 offset:4096
    ds_read_b128 v[24:27], v142 offset:0
    ds_read_b128 v[28:31], v142 offset:4096
    s_waitcnt lgkmcnt(4)
    v_mfma_f32_32x32x16_bf16 v[64:79], v[32:35], v[40:43], v[64:79]
    s_add_u32 m0, s18, 16384
    s_nop 0
    buffer_load_dwordx4 v50, s[8:11], s17 offen lds
    v_mfma_f32_32x32x16_bf16 v[80:95], v[36:39], v[40:43], v[80:95]
    v_mfma_f32_32x32x16_bf16 v[96:111], v[32:35], v[44:47], v[96:111]
    v_mfma_f32_32x32x16_bf16 v[112:127], v[36:39], v[44:47], v[112:127]
    s_add_u32 m0, s18, 24576
    s_nop 0
    buffer_load_dwordx4 v51, s[8:11], s17 offen lds
    ds_read_b128 v[32:35], v139 offset:0
    ds_read_b128 v[36:39], v139 offset:4096
    ds_read_b128 v[40:43], v143 offset:0
    ds_read_b128 v[44:47], v143 offset:4096
    s_waitcnt lgkmcnt(4)
    v_mfma_f32_32x32x16_bf16 v[64:79], v[16:19], v[24:27], v[64:79]
    v_mfma_f32_32x32x16_bf16 v[80:95], v[20:23], v[24:27], v[80:95]
    s_add_u32 m0, s18, 32768
    s_nop 0
    buffer_load_dwordx4 v52, s[8:11], s17 offen lds
    v_mfma_f32_32x32x16_bf16 v[96:111], v[16:19], v[28:31], v[96:111]
    v_mfma_f32_32x32x16_bf16 v[112:127], v[20:23], v[28:31], v[112:127]
    s_add_u32 m0, s18, 40960
    s_nop 0
    buffer_load_dwordx4 v53, s[8:11], s17 offen lds
    s_waitcnt lgkmcnt(0)
    v_mfma_f32_32x32x16_bf16 v[64:79], v[32:35], v[40:43], v[64:79]
    v_mfma_f32_32x32x16_bf16 v[80:95], v[36:39], v[40:43], v[80:95]
    s_add_u32 s16, s16, 128
    s_add_u32 s17, s17, 128
    s_waitcnt vmcnt(6)
    s_barrier
    ds_read_b128 v[16:19], v144 offset:0
    ds_read_b128 v[20:23], v144 offset:4096
    ds_read_b128 v[24:27], v148 offset:0
    ds_read_b128 v[28:31], v148 offset:4096
    v_mfma_f32_32x32x16_bf16 v[96:111], v[32:35], v[44:47], v[96:111]
    v_mfma_f32_32x32x16_bf16 v[112:127], v[36:39], v[44:47], v[112:127]
    ds_read_b128 v[32:35], v145 offset:0
    ds_read_b128 v[36:39], v145 offset:4096
    ds_read_b128 v[40:43], v149 offset:0
    ds_read_b128 v[44:47], v149 offset:4096
    s_waitcnt lgkmcnt(4)
    v_mfma_f32_32x32x16_bf16 v[64:79], v[16:19], v[24:27], v[64:79]
    v_mfma_f32_32x32x16_bf16 v[80:95], v[20:23], v[24:27], v[80:95]
    v_mfma_f32_32x32x16_bf16 v[96:111], v[16:19], v[28:31], v[96:111]
    v_mfma_f32_32x32x16_bf16 v[112:127], v[20:23], v[28:31], v[112:127]
    ds_read_b128 v[16:19], v146 offset:0
    ds_read_b128 v[20:23], v146 offset:4096
    ds_read_b128 v[24:27], v150 offset:0
    ds_read_b128 v[28:31], v150 offset:4096
    s_waitcnt lgkmcnt(4)
    v_mfma_f32_32x32x16_bf16 v[64:79], v[32:35], v[40:43], v[64:79]
    v_mfma_f32_32x32x16_bf16 v[80:95], v[36:39], v[40:43], v[80:95]
    v_mfma_f32_32x32x16_bf16 v[96:111], v[32:35], v[44:47], v[96:111]
    v_mfma_f32_32x32x16_bf16 v[112:127], v[36:39], v[44:47], v[112:127]
    ds_read_b128 v[32:35], v147 offset:0
    ds_read_b128 v[36:39], v147 offset:4096
    ds_read_b128 v[40:43], v151 offset:0
    ds_read_b128 v[44:47], v151 offset:4096
    s_waitcnt lgkmcnt(4)
    v_mfma_f32_32x32x16_bf16 v[64:79], v[16:19], v[24:27], v[64:79]
    v_mfma_f32_32x32x16_bf16 v[80:95], v[20:23], v[24:27], v[80:95]
    v_mfma_f32_32x32x16_bf16 v[96:111], v[16:19], v[28:31], v[96:111]
    v_mfma_f32_32x32x16_bf16 v[112:127], v[20:23], v[28:31], v[112:127]
    s_waitcnt lgkmcnt(0)
    v_mfma_f32_32x32x16_bf16 v[64:79], v[32:35], v[40:43], v[64:79]
    v_mfma_f32_32x32x16_bf16 v[80:95], v[36:39], v[40:43], v[80:95]
    s_waitcnt vmcnt(0)
    s_barrier
    ds_read_b128 v[16:19], v128 offset:0
    ds_read_b128 v[20:23], v128 offset:4096
    ds_read_b128 v[24:27], v132 offset:0
    ds_read_b128 v[28:31], v132 offset:4096
    v_mfma_f32_32x32x16_bf16 v[96:111], v[32:35], v[44:47], v[96:111]
    v_mfma_f32_32x32x16_bf16 v[112:127], v[36:39], v[44:47], v[112:127]
    ds_read_b128 v[32:35], v129 offset:0
    ds_read_b128 v[36:39], v129 offset:4096
    ds_read_b128 v[40:43], v133 offset:0
    ds_read_b128 v[44:47], v133 offset:4096
    s_waitcnt lgkmcnt(4)
    v_mfma_f32_32x32x16_bf16 v[64:79], v[16:19], v[24:27], v[64:79]
    v_mfma_f32_32x32x16_bf16 v[80:95], v[20:23], v[24:27], v[80:95]
    v_mfma_f32_32x32x16_bf16 v[96:111], v[16:19], v[28:31], v[96:111]
    v_mfma_f32_32x32x16_bf16 v[112:127], v[20:23], v[28:31], v[112:127]
    ds_read_b128 v[16:19], v130 offset:0
    ds_read_b128 v[20:23], v130 offset:4096
    ds_read_b128 v[24:27], v134 offset:0
    ds_read_b128 v[28:31], v134 offset:4096
    s_waitcnt lgkmcnt(4)
    v_mfma_f32_32x32x16_bf16 v[64:79], v[32:35], v[40:43], v[64:79]
    v_mfma_f32_32x32x16_bf16 v[80:95], v[36:39], v[40:43], v[80:95]
    v_mfma_f32_32x32x16_bf16 v[96:111], v[32:35], v[44:47], v[96:111]
    v_mfma_f32_32x32x16_bf16 v[112:127], v[36:39], v[44:47], v[112:127]
    ds_read_b128 v[32:35], v131 offset:0
    ds_read_b128 v[36:39], v131 offset:4096
    ds_read_b128 v[40:43], v135 offset:0
    ds_read_b128 v[44:47], v135 offset:4096
    s_waitcnt lgkmcnt(4)
    v_mfma_f32_32x32x16_bf16 v[64:79], v[16:19], v[24:27], v[64:79]
    v_mfma_f32_32x32x16_bf16 v[80:95], v[20:23], v[24:27], v[80:95]
    v_mfma_f32_32x32x16_bf16 v[96:111], v[16:19], v[28:31], v[96:111]
    v_mfma_f32_32x32x16_bf16 v[112:127], v[20:23], v[28:31], v[112:127]
    s_waitcnt lgkmcnt(0)
    v_mfma_f32_32x32x16_bf16 v[64:79], v[32:35], v[40:43], v[64:79]
    v_mfma_f32_32x32x16_bf16 v[80:95], v[36:39], v[40:43], v[80:95]
    v_mfma_f32_32x32x16_bf16 v[96:111], v[32:35], v[44:47], v[96:111]
    v_mfma_f32_32x32x16_bf16 v[112:127], v[36:39], v[44:47], v[112:127]
    s_nop 15
    s_nop 3
    s_lshl_b32 s23, s26, 6
    v_and_b32 v3, 31, v2
    v_add_u32 v3, s23, v3
    s_mov_b32 s23, 4096
    v_mul_lo_u32 v3, v3, s23
    v_lshrrev_b32 v4, 5, v2
    v_lshl_add_u32 v3, v4, 4, v3
    s_lshl_b32 s23, s25, 7
    s_add_u32 s23, s23, s21
    v_add_u32 v3, s23, v3
    v_add_u32 v4, 131072, v3
    v_mul_f32 v64, s20, v64
    v_mul_f32 v65, s20, v65
    v_mul_f32 v66, s20, v66
    v_mul_f32 v67, s20, v67
    v_mul_f32 v68, s20, v68
    v_mul_f32 v69, s20, v69
    v_mul_f32 v70, s20, v70
    v_mul_f32 v71, s20, v71
    v_mul_f32 v72, s20, v72
    v_mul_f32 v73, s20, v73
    v_mul_f32 v74, s20, v74
    v_mul_f32 v75, s20, v75
    v_mul_f32 v76, s20, v76
    v_mul_f32 v77, s20, v77
    v_mul_f32 v78, s20, v78
    v_mul_f32 v79, s20, v79
    v_cvt_pk_bf16_f32 v16, v64, v65
    v_cvt_pk_bf16_f32 v17, v66, v67
    v_cvt_pk_bf16_f32 v18, v68, v69
    v_cvt_pk_bf16_f32 v19, v70, v71
    v_cvt_pk_bf16_f32 v20, v72, v73
    v_cvt_pk_bf16_f32 v21, v74, v75
    v_cvt_pk_bf16_f32 v22, v76, v77
    v_cvt_pk_bf16_f32 v23, v78, v79
    s_nop 1
    v_permlane32_swap_b32 v16, v18
    v_permlane32_swap_b32 v17, v19
    v_permlane32_swap_b32 v20, v22
    v_permlane32_swap_b32 v21, v23
    buffer_store_dwordx4 v[16:19], v3, s[12:15], 0 offen offset:0
    buffer_store_dwordx4 v[20:23], v3, s[12:15], 0 offen offset:32
    v_mul_f32 v80, s20, v80
    v_mul_f32 v81, s20, v81
    v_mul_f32 v82, s20, v82
    v_mul_f32 v83, s20, v83
    v_mul_f32 v84, s20, v84
    v_mul_f32 v85, s20, v85
    v_mul_f32 v86, s20, v86
    v_mul_f32 v87, s20, v87
    v_mul_f32 v88, s20, v88
    v_mul_f32 v89, s20, v89
    v_mul_f32 v90, s20, v90
    v_mul_f32 v91, s20, v91
    v_mul_f32 v92, s20, v92
    v_mul_f32 v93, s20, v93
    v_mul_f32 v94, s20, v94
    v_mul_f32 v95, s20, v95
    v_cvt_pk_bf16_f32 v24, v80, v81
    v_cvt_pk_bf16_f32 v25, v82, v83
    v_cvt_pk_bf16_f32 v26, v84, v85
    v_cvt_pk_bf16_f32 v27, v86, v87
    v_cvt_pk_bf16_f32 v28, v88, v89
    v_cvt_pk_bf16_f32 v29, v90, v91
    v_cvt_pk_bf16_f32 v30, v92, v93
    v_cvt_pk_bf16_f32 v31, v94, v95
    s_nop 1
    v_permlane32_swap_b32 v24, v26
    v_permlane32_swap_b32 v25, v27
    v_permlane32_swap_b32 v28, v30
    v_permlane32_swap_b32 v29, v31
    buffer_store_dwordx4 v[24:27], v3, s[12:15], 0 offen offset:64
    buffer_store_dwordx4 v[28:31], v3, s[12:15], 0 offen offset:96
    v_mul_f32 v96, s20, v96
    v_mul_f32 v97, s20, v97
    v_mul_f32 v98, s20, v98
    v_mul_f32 v99, s20, v99
    v_mul_f32 v100, s20, v100
    v_mul_f32 v101, s20, v101
    v_mul_f32 v102, s20, v102
    v_mul_f32 v103, s20, v103
    v_mul_f32 v104, s20, v104
    v_mul_f32 v105, s20, v105
    v_mul_f32 v106, s20, v106
    v_mul_f32 v107, s20, v107
    v_mul_f32 v108, s20, v108
    v_mul_f32 v109, s20, v109
    v_mul_f32 v110, s20, v110
    v_mul_f32 v111, s20, v111
    v_cvt_pk_bf16_f32 v32, v96, v97
    v_cvt_pk_bf16_f32 v33, v98, v99
    v_cvt_pk_bf16_f32 v34, v100, v101
    v_cvt_pk_bf16_f32 v35, v102, v103
    v_cvt_pk_bf16_f32 v36, v104, v105
    v_cvt_pk_bf16_f32 v37, v106, v107
    v_cvt_pk_bf16_f32 v38, v108, v109
    v_cvt_pk_bf16_f32 v39, v110, v111
    s_nop 1
    v_permlane32_swap_b32 v32, v34
    v_permlane32_swap_b32 v33, v35
    v_permlane32_swap_b32 v36, v38
    v_permlane32_swap_b32 v37, v39
    buffer_store_dwordx4 v[32:35], v4, s[12:15], 0 offen offset:0
    buffer_store_dwordx4 v[36:39], v4, s[12:15], 0 offen offset:32
    v_mul_f32 v112, s20, v112
    v_mul_f32 v113, s20, v113
    v_mul_f32 v114, s20, v114
    v_mul_f32 v115, s20, v115
    v_mul_f32 v116, s20, v116
    v_mul_f32 v117, s20, v117
    v_mul_f32 v118, s20, v118
    v_mul_f32 v119, s20, v119
    v_mul_f32 v120, s20, v120
    v_mul_f32 v121, s20, v121
    v_mul_f32 v122, s20, v122
    v_mul_f32 v123, s20, v123
    v_mul_f32 v124, s20, v124
    v_mul_f32 v125, s20, v125
    v_mul_f32 v126, s20, v126
    v_mul_f32 v127, s20, v127
    v_cvt_pk_bf16_f32 v40, v112, v113
    v_cvt_pk_bf16_f32 v41, v114, v115
    v_cvt_pk_bf16_f32 v42, v116, v117
    v_cvt_pk_bf16_f32 v43, v118, v119
    v_cvt_pk_bf16_f32 v44, v120, v121
    v_cvt_pk_bf16_f32 v45, v122, v123
    v_cvt_pk_bf16_f32 v46, v124, v125
    v_cvt_pk_bf16_f32 v47, v126, v127
    s_nop 1
    v_permlane32_swap_b32 v40, v42
    v_permlane32_swap_b32 v41, v43
    v_permlane32_swap_b32 v44, v46
    v_permlane32_swap_b32 v45, v47
    buffer_store_dwordx4 v[40:43], v4, s[12:15], 0 offen offset:64
    buffer_store_dwordx4 v[44:47], v4, s[12:15], 0 offen offset:96
    s_waitcnt vmcnt(0) lgkmcnt(0)
    s_barrier
    s_cmp_lg_u32 s22, 0
    s_cbranch_scc1 L_k3_gb2
    buffer_wbl2 sc1
    s_waitcnt vmcnt(0)
    v_mov_b32 v3, 0
    v_mov_b32 v4, 1
    s_mov_b64 exec, 1
    global_atomic_add v3, v4, s[90:91] sc1
    s_waitcnt vmcnt(0)
L_k3_gb1:
    s_sleep 8
    global_load_dword v5, v3, s[90:91] sc1
    s_waitcnt vmcnt(0)
    v_readfirstlane_b32 s23, v5
    s_nop 3
    s_cmp_lt_u32 s23, 128
    s_cbranch_scc1 L_k3_gb1
    s_mov_b64 exec, -1
    buffer_inv sc1
    s_waitcnt vmcnt(0)
L_k3_gb2:
    s_barrier
    s_and_b32 s50, s30, 1
    s_lshl_b32 s50, s50, 2
    s_and_b32 s51, s31, 3
    s_add_u32 s50, s50, s51
    s_lshr_b32 s51, s30, 1
    s_lshl_b32 s51, s51, 2
    s_lshr_b32 s52, s31, 2
    s_add_u32 s51, s51, s52
    s_add_u32 s4, s48, 8388608
    s_addc_u32 s5, s49, 0
    s_mov_b32 s6, 8388608
    s_mov_b32 s7, 0x00020000
    s_mov_b32 s8, s32
    s_mov_b32 s9, s33
    s_mov_b32 s10, 8388608
    s_mov_b32 s11, 0x00020000
    s_mov_b32 s12, s36
    s_mov_b32 s13, s37
    s_mov_b32 s14, 8388608
    s_mov_b32 s15, 0x00020000
    s_lshl_b32 s16, s50, 19
    s_lshl_b32 s17, s51, 19
    s_lshl_b32 s21, s50, 8
    s_add_u32 s21, s21, s17
    s_add_u32 s21, s21, 2048
    s_add_u32 s53, s17, 4096
    v_lshrrev_b32 v1, 6, v0
    s_nop 0
    v_readfirstlane_b32 s22, v1
    v_and_b32 v2, 63, v0
    s_nop 2
    s_lshl_b32 s18, s22, 10
    s_lshr_b32 s24, s22, 2
    s_and_b32 s25, s22, 1
    s_lshr_b32 s26, s22, 1
    s_and_b32 s26, s26, 1
    v_lshrrev_b32 v3, 3, v2
    v_lshl_add_u32 v3, v1, 3, v3
    v_bfe_u32 v4, v3, 1, 3
    v_and_b32 v5, 7, v2
    v_xor_b32 v4, v4, v5
    v_lshlrev_b32 v4, 4, v4
    s_mov_b32 s23, 4096
    v_mul_lo_u32 v3, v3, s23
    v_add_u32 v48, v3, v4
    v_add_u32 v49, 262144, v48
    v_lshrrev_b32 v3, 3, v2
    v_lshl_add_u32 v3, v1, 3, v3
    v_bfe_u32 v4, v3, 1, 3
    v_and_b32 v5, 7, v2
    v_xor_b32 v4, v4, v5
    v_lshlrev_b32 v4, 4, v4
    s_mov_b32 s23, 4096
    v_mul_lo_u32 v3, v3, s23
    v_add_u32 v50, v3, v4
    v_add_u32 v51, 262144, v50
    s_add_u32 m0, s18, 0
    s_nop 0
    buffer_load_dwordx4 v48, s[4:7], s16 offen lds
    s_add_u32 m0, s18, 8192
    s_nop 0
    buffer_load_dwordx4 v49, s[4:7], s16 offen lds
    s_add_u32 m0, s18, 16384
    s_nop 0
    buffer_load_dwordx4 v50, s[8:11], s17 offen lds
    s_add_u32 m0, s18, 24576
    s_nop 0
    buffer_load_dwordx4 v51, s[8:11], s17 offen lds
    s_add_u32 s16, s16, 128
    s_add_u32 s17, s17, 128
    s_add_u32 m0, s18, 32768
    s_nop 0
    buffer_load_dwordx4 v48, s[4:7], s16 offen lds
    s_add_u32 m0, s18, 40960
    s_nop 0
    buffer_load_dwordx4 v49, s[4:7], s16 offen lds
    s_add_u32 m0, s18, 49152
    s_nop 0
    buffer_load_dwordx4 v50, s[8:11], s17 offen lds
    s_add_u32 m0, s18, 57344
    s_nop 0
    buffer_load_dwordx4 v51, s[8:11], s17 offen lds
    s_add_u32 s16, s16, 128
    s_add_u32 s17, s17, 128
    s_add_u32 m0, s18, 65536
    s_nop 0
    buffer_load_dwordx4 v48, s[4:7], s16 offen lds
    s_add_u32 m0, s18, 73728
    s_nop 0
    buffer_load_dwordx4 v49, s[4:7], s16 offen lds
    s_add_u32 m0, s18, 81920
    s_nop 0
    buffer_load_dwordx4 v50, s[8:11], s17 offen lds
    s_add_u32 m0, s18, 90112
    s_nop 0
    buffer_load_dwordx4 v51, s[8:11], s17 offen lds
    s_add_u32 s16, s16, 128
    s_add_u32 s17, s17, 128
    s_mul_i32 s27, s24, 4
    s_lshl_b32 s28, s25, 6
    v_and_b32 v3, 31, v2
    v_bfe_u32 v4, v3, 1, 3
    v_lshrrev_b32 v5, 5, v2
    v_xor_b32 v4, v4, v5
    v_xor_b32 v4, s27, v4
    v_add_u32 v3, s28, v3
    v_lshlrev_b32 v3, 7, v3
    v_lshl_add_u32 v3, v4, 4, v3
    v_add_u32 v128, 0, v3
    v_xor_b32 v129, 32, v128
    v_add_u32 v132, 32768, v3
    v_xor_b32 v133, 32, v132
    v_add_u32 v136, 65536, v3
    v_xor_b32 v137, 32, v136
    v_add_u32 v140, 98304, v3
    v_xor_b32 v141, 32, v140
    s_lshl_b32 s28, s26, 6
    v_and_b32 v3, 31, v2
    v_bfe_u32 v4, v3, 1, 3
    v_lshrrev_b32 v5, 5, v2
    v_xor_b32 v4, v4, v5
    v_xor_b32 v4, s27, v4
    v_add_u32 v3, s28, v3
    v_lshlrev_b32 v3, 7, v3
    v_lshl_add_u32 v3, v4, 4, v3
    v_add_u32 v130, 16384, v3
    v_xor_b32 v131, 32, v130
    v_add_u32 v134, 49152, v3
    v_xor_b32 v135, 32, v134
    v_add_u32 v138, 81920, v3
    v_xor_b32 v139, 32, v138
    v_add_u32 v142, 114688, v3
    v_xor_b32 v143, 32, v142
    v_mov_b32 v64, 0
    v_mov_b32 v65, 0
    v_mov_b32 v66, 0
    v_mov_b32 v67, 0
    v_mov_b32 v68, 0
    v_mov_b32 v69, 0
    v_mov_b32 v70, 0
    v_mov_b32 v71, 0
    v_mov_b32 v72, 0
    v_mov_b32 v73, 0
    v_mov_b32 v74, 0
    v_mov_b32 v75, 0
    v_mov_b32 v76, 0
    v_mov_b32 v77, 0
    v_mov_b32 v78, 0
    v_mov_b32 v79, 0
    v_mov_b32 v80, 0
    v_mov_b32 v81, 0
    v_mov_b32 v82, 0
    v_mov_b32 v83, 0
    v_mov_b32 v84, 0
    v_mov_b32 v85, 0
    v_mov_b32 v86, 0
    v_mov_b32 v87, 0
    v_mov_b32 v88, 0
    v_mov_b32 v89, 0
    v_mov_b32 v90, 0
    v_mov_b32 v91, 0
    v_mov_b32 v92, 0
    v_mov_b32 v93, 0
    v_mov_b32 v94, 0
    v_mov_b32 v95, 0
    v_mov_b32 v96, 0
    v_mov_b32 v97, 0
    v_mov_b32 v98, 0
    v_mov_b32 v99, 0
    v_mov_b32 v100, 0
    v_mov_b32 v101, 0
    v_mov_b32 v102, 0
    v_mov_b32 v103, 0
    v_mov_b32 v104, 0
    v_mov_b32 v105, 0
    v_mov_b32 v106, 0
    v_mov_b32 v107, 0
    v_mov_b32 v108, 0
    v_mov_b32 v109, 0
    v_mov_b32 v110, 0
    v_mov_b32 v111, 0
    v_mov_b32 v112, 0
    v_mov_b32 v113, 0
    v_mov_b32 v114, 0
    v_mov_b32 v115, 0
    v_mov_b32 v116, 0
    v_mov_b32 v117, 0
    v_mov_b32 v118, 0
    v_mov_b32 v119, 0
    v_mov_b32 v120, 0
    v_mov_b32 v121, 0
    v_mov_b32 v122, 0
    v_mov_b32 v123, 0
    v_mov_b32 v124, 0
    v_mov_b32 v125, 0
    v_mov_b32 v126, 0
    v_mov_b32 v127, 0
    s_waitcnt vmcnt(8)
    s_barrier
    ds_read_b128 v[16:19], v128 offset:0
    ds_read_b128 v[20:23], v128 offset:4096
    ds_read_b128 v[24:27], v130 offset:0
    ds_read_b128 v[28:31], v130 offset:4096
    s_mov_b32 s19, 0
L_g4_loop2:
    s_cmp_eq_u32 s17, s53
    s_cselect_b32 s8, s34, s8
    s_cselect_b32 s9, s35, s9
    s_cselect_b32 s23, 4096, 0
    s_cselect_b32 s54, 4190208, 0
    s_cselect_b32 s53, -1, s53
    s_sub_u32 s17, s17, s23
    s_add_u32 s16, s16, s54
    ds_read_b128 v[32:35], v129 offset:0
    ds_read_b128 v[36:39], v129 offset:4096
    ds_read_b128 v[40:43], v131 offset:0
    ds_read_b128 v[44:47], v131 offset:4096
    s_waitcnt lgkmcnt(4)
    v_mfma_f32_32x32x16_bf16 v[64:79], v[16:19], v[24:27], v[64:79]
    s_add_u32 m0, s18, 98304
    s_nop 0
    buffer_load_dwordx4 v48, s[4:7], s16 offen lds
    v_mfma_f32_32x32x16_bf16 v[80:95], v[20:23], v[24:27], v[80:95]
    s_add_u32 m0, s18, 106496
    s_nop 0
    buffer_load_dwordx4 v49, s[4:7], s16 offen lds
    v_mfma_f32_32x32x16_bf16 v[96:111], v[16:19], v[28:31], v[96:111]
    v_mfma_f32_32x32x16_bf16 v[112:127], v[20:23], v[28:31], v[112:127]
    s_add_u32 m0, s18, 114688
    s_nop 0
    buffer_load_dwordx4 v50, s[8:11], s17 offen lds
    s_waitcnt lgkmcnt(0)
    v_mfma_f32_32x32x16_bf16 v[64:79], v[32:35], v[40:43], v[64:79]
    s_add_u32 m0, s18, 122880
    s_nop 0
    buffer_load_dwordx4 v51, s[8:11], s17 offen lds
    v_mfma_f32_32x32x16_bf16 v[80:95], v[36:39], v[40:43], v[80:95]
    s_add_u32 s16, s16, 128
    s_add_u32 s17, s17, 128
    s_waitcnt vmcnt(8)
    s_barrier
    ds_read_b128 v[16:19], v132 offset:0
    ds_read_b128 v[20:23], v132 offset:4096
    ds_read_b128 v[24:27], v134 offset:0
    ds_read_b128 v[28:31], v134 offset:4096
    v_mfma_f32_32x32x16_bf16 v[96:111], v[32:35], v[44:47], v[96:111]
    v_mfma_f32_32x32x16_bf16 v[112:127], v[36:39], v[44:47], v[112:127]
    s_cmp_eq_u32 s17, s53
    s_cselect_b32 s8, s34, s8
    s_cselect_b32 s9, s35, s9
    s_cselect_b32 s23, 4096, 0
    s_cselect_b32 s54, 4190208, 0
    s_cselect_b32 s53, -1, s53
    s_sub_u32 s17, s17, s23
    s_add_u32 s16, s16, s54
    ds_read_b128 v[32:35], v133 offset:0
    ds_read_b128 v[36:39], v133 offset:4096
    ds_read_b128 v[40:43], v135 offset:0
    ds_read_b128 v[44:47], v135 offset:4096
    s_waitcnt lgkmcnt(4)
    v_mfma_f32_32x32x16_bf16 v[64:79], v[16:19], v[24:27], v[64:79]
    s_add_u32 m0, s18, 0
    s_nop 0
    buffer_load_dwordx4 v48, s[4:7], s16 offen lds
    v_mfma_f32_32x32x16_bf16 v[80:95], v[20:23], v[24:27], v[80:95]
    s_add_u32 m0, s18, 8192
    s_nop 0
    buffer_load_dwordx4 v49, s[4:7], s16 offen lds
    v_mfma_f32_32x32x16_bf16 v[96:111], v[16:19], v[28:31], v[96:111]
    v_mfma_f32_32x32x16_bf16 v[112:127], v[20:23], v[28:31], v[112:127]
    s_add_u32 m0, s18, 16384
    s_nop 0
    buffer_load_dwordx4 v50, s[8:11], s17 offen lds
    s_waitcnt lgkmcnt(0)
    v_mfma_f32_32x32x16_bf16 v[64:79], v[32:35], v[40:43], v[64:79]
    s_add_u32 m0, s18, 24576
    s_nop 0
    buffer_load_dwordx4 v51, s[8:11], s17 offen lds
    v_mfma_f32_32x32x16_bf16 v[80:95], v[36:39], v[40:43], v[80:95]
    s_add_u32 s16, s16, 128
    s_add_u32 s17, s17, 128
    s_waitcnt vmcnt(8)
    s_barrier
    ds_read_b128 v[16:19], v136 offset:0
    ds_read_b128 v[20:23], v136 offset:4096
    ds_read_b128 v[24:27], v138 offset:0
    ds_read_b128 v[28:31], v138 offset:4096
    v_mfma_f32_32x32x16_bf16 v[96:111], v[32:35], v[44:47], v[96:111]
    v_mfma_f32_32x32x16_bf16 v[112:127], v[36:39], v[44:47], v[112:127]
    s_cmp_eq_u32 s17, s53
    s_cselect_b32 s8, s34, s8
    s_cselect_b32 s9, s35, s9
    s_cselect_b32 s23, 4096, 0
    s_cselect_b32 s54, 4190208, 0
    s_cselect_b32 s53, -1, s53
    s_sub_u32 s17, s17, s23
    s_add_u32 s16, s16, s54
    ds_read_b128 v[32:35], v137 offset:0
    ds_read_b128 v[36:39], v137 offset:4096
    ds_read_b128 v[40:43], v139 offset:0
    ds_read_b128 v[44:47], v139 offset:4096
    s_waitcnt lgkmcnt(4)
    v_mfma_f32_32x32x16_bf16 v[64:79], v[16:19], v[24:27], v[64:79]
    s_add_u32 m0, s18, 32768
    s_nop 0
    buffer_load_dwordx4 v48, s[4:7], s16 offen lds
    v_mfma_f32_32x32x16_bf16 v[80:95], v[20:23], v[24:27], v[80:95]
    s_add_u32 m0, s18, 40960
    s_nop 0
    buffer_load_dwordx4 v49, s[4:7], s16 offen lds
    v_mfma_f32_32x32x16_bf16 v[96:111], v[16:19], v[28:31], v[96:111]
    v_mfma_f32_32x32x16_bf16 v[112:127], v[20:23], v[28:31], v[112:127]
    s_add_u32 m0, s18, 49152
    s_nop 0
    buffer_load_dwordx4 v50, s[8:11], s17 offen lds
    s_waitcnt lgkmcnt(0)
    v_mfma_f32_32x32x16_bf16 v[64:79], v[32:35], v[40:43], v[64:79]
    s_add_u32 m0, s18, 57344
    s_nop 0
    buffer_load_dwordx4 v51, s[8:11], s17 offen lds
    v_mfma_f32_32x32x16_bf16 v[80:95], v[36:39], v[40:43], v[80:95]
    s_add_u32 s16, s16, 128
    s_add_u32 s17, s17, 128
    s_waitcnt vmcnt(8)
    s_barrier
    ds_read_b128 v[16:19], v140 offset:0
    ds_read_b128 v[20:23], v140 offset:4096
    ds_read_b128 v[24:27], v142 offset:0
    ds_read_b128 v[28:31], v142 offset:4096
    v_mfma_f32_32x32x16_bf16 v[96:111], v[32:35], v[44:47], v[96:111]
    v_mfma_f32_32x32x16_bf16 v[112:127], v[36:39], v[44:47], v[112:127]
    s_cmp_eq_u32 s17, s53
    s_cselect_b32 s8, s34, s8
    s_cselect_b32 s9, s35, s9
    s_cselect_b32 s23, 4096, 0
    s_cselect_b32 s54, 4190208, 0
    s_cselect_b32 s53, -1, s53
    s_sub_u32 s17, s17, s23
    s_add_u32 s16, s16, s54
    ds_read_b128 v[32:35], v141 offset:0
    ds_read_b128 v[36:39], v141 offset:4096
    ds_read_b128 v[40:43], v143 offset:0
    ds_read_b128 v[44:47], v143 offset:4096
    s_waitcnt lgkmcnt(4)
    v_mfma_f32_32x32x16_bf16 v[64:79], v[16:19], v[24:27], v[64:79]
    s_add_u32 m0, s18, 65536
    s_nop 0
    buffer_load_dwordx4 v48, s[4:7], s16 offen lds
    v_mfma_f32_32x32x16_bf16 v[80:95], v[20:23], v[24:27], v[80:95]
    s_add_u32 m0, s18, 73728
    s_nop 0
    buffer_load_dwordx4 v49, s[4:7], s16 offen lds
    v_mfma_f32_32x32x16_bf16 v[96:111], v[16:19], v[28:31], v[96:111]
    v_mfma_f32_32x32x16_bf16 v[112:127], v[20:23], v[28:31], v[112:127]
    s_add_u32 m0, s18, 81920
    s_nop 0
    buffer_load_dwordx4 v50, s[8:11], s17 offen lds
    s_waitcnt lgkmcnt(0)
    v_mfma_f32_32x32x16_bf16 v[64:79], v[32:35], v[40:43], v[64:79]
    s_add_u32 m0, s18, 90112
    s_nop 0
    buffer_load_dwordx4 v51, s[8:11], s17 offen lds
    v_mfma_f32_32x32x16_bf16 v[80:95], v[36:39], v[40:43], v[80:95]
    s_add_u32 s16, s16, 128
    s_add_u32 s17, s17, 128
    s_waitcnt vmcnt(8)
    s_barrier
    ds_read_b128 v[16:19], v128 offset:0
    ds_read_b128 v[20:23], v128 offset:4096
    ds_read_b128 v[24:27], v130 offset:0
    ds_read_b128 v[28:31], v130 offset:4096
    v_mfma_f32_32x32x16_bf16 v[96:111], v[32:35], v[44:47], v[96:111]
    v_mfma_f32_32x32x16_bf16 v[112:127], v[36:39], v[44:47], v[112:127]
    s_add_u32 s19, s19, 1
    s_cmp_lt_u32 s19, 15
    s_cbranch_scc1 L_g4_loop2
    ds_read_b128 v[32:35], v129 offset:0
    ds_read_b128 v[36:39], v129 offset:4096
    ds_read_b128 v[40:43], v131 offset:0
    ds_read_b128 v[44:47], v131 offset:4096
    s_waitcnt lgkmcnt(4)
    v_mfma_f32_32x32x16_bf16 v[64:79], v[16:19], v[24:27], v[64:79]
    s_add_u32 m0, s18, 98304
    s_nop 0
    buffer_load_dwordx4 v48, s[4:7], s16 offen lds
    v_mfma_f32_32x32x16_bf16 v[80:95], v[20:23], v[24:27], v[80:95]
    s_add_u32 m0, s18, 106496
    s_nop 0
    buffer_load_dwordx4 v49, s[4:7], s16 offen lds
    v_mfma_f32_32x32x16_bf16 v[96:111], v[16:19], v[28:31], v[96:111]
    v_mfma_f32_32x32x16_bf16 v[112:127], v[20:23], v[28:31], v[112:127]
    s_add_u32 m0, s18, 114688
    s_nop 0
    buffer_load_dwordx4 v50, s[8:11], s17 offen lds
    s_waitcnt lgkmcnt(0)
    v_mfma_f32_32x32x16_bf16 v[64:79], v[32:35], v[40:43], v[64:79]
    s_add_u32 m0, s18, 122880
    s_nop 0
    buffer_load_dwordx4 v51, s[8:11], s17 offen lds
    v_mfma_f32_32x32x16_bf16 v[80:95], v[36:39], v[40:43], v[80:95]
    s_add_u32 s16, s16, 128
    s_add_u32 s17, s17, 128
    s_waitcnt vmcnt(8)
    s_barrier
    ds_read_b128 v[16:19], v132 offset:0
    ds_read_b128 v[20:23], v132 offset:4096
    ds_read_b128 v[24:27], v134 offset:0
    ds_read_b128 v[28:31], v134 offset:4096
    v_mfma_f32_32x32x16_bf16 v[96:111], v[32:35], v[44:47], v[96:111]
    v_mfma_f32_32x32x16_bf16 v[112:127], v[36:39], v[44:47], v[112:127]
    ds_read_b128 v[32:35], v133 offset:0
    ds_read_b128 v[36:39], v133 offset:4096
    ds_read_b128 v[40:43], v135 offset:0
    ds_read_b128 v[44:47], v135 offset:4096
    s_waitcnt lgkmcnt(4)
    v_mfma_f32_32x32x16_bf16 v[64:79], v[16:19], v[24:27], v[64:79]
    v_mfma_f32_32x32x16_bf16 v[80:95], v[20:23], v[24:27], v[80:95]
    v_mfma_f32_32x32x16_bf16 v[96:111], v[16:19], v[28:31], v[96:111]
    v_mfma_f32_32x32x16_bf16 v[112:127], v[20:23], v[28:31], v[112:127]
    s_waitcnt lgkmcnt(0)
    v_mfma_f32_32x32x16_bf16 v[64:79], v[32:35], v[40:43], v[64:79]
    v_mfma_f32_32x32x16_bf16 v[80:95], v[36:39], v[40:43], v[80:95]
    s_waitcnt vmcnt(4)
    s_barrier
    ds_read_b128 v[16:19], v136 offset:0
    ds_read_b128 v[20:23], v136 offset:4096
    ds_read_b128 v[24:27], v138 offset:0
    ds_read_b128 v[28:31], v138 offset:4096
    v_mfma_f32_32x32x16_bf16 v[96:111], v[32:35], v[44:47], v[96:111]
    v_mfma_f32_32x32x16_bf16 v[112:127], v[36:39], v[44:47], v[112:127]
    ds_read_b128 v[32:35], v137 offset:0
    ds_read_b128 v[36:39], v137 offset:4096
    ds_read_b128 v[40:43], v139 offset:0
    ds_read_b128 v[44:47], v139 offset:4096
    s_waitcnt lgkmcnt(4)
    v_mfma_f32_32x32x16_bf16 v[64:79], v[16:19], v[24:27], v[64:79]
    v_mfma_f32_32x32x16_bf16 v[80:95], v[20:23], v[24:27], v[80:95]
    v_mfma_f32_32x32x16_bf16 v[96:111], v[16:19], v[28:31], v[96:111]
    v_mfma_f32_32x32x16_bf16 v[112:127], v[20:23], v[28:31], v[112:127]
    s_waitcnt lgkmcnt(0)
    v_mfma_f32_32x32x16_bf16 v[64:79], v[32:35], v[40:43], v[64:79]
    v_mfma_f32_32x32x16_bf16 v[80:95], v[36:39], v[40:43], v[80:95]
    s_waitcnt vmcnt(0)
    s_barrier
    ds_read_b128 v[16:19], v140 offset:0
    ds_read_b128 v[20:23], v140 offset:4096
    ds_read_b128 v[24:27], v142 offset:0
    ds_read_b128 v[28:31], v142 offset:4096
    v_mfma_f32_32x32x16_bf16 v[96:111], v[32:35], v[44:47], v[96:111]
    v_mfma_f32_32x32x16_bf16 v[112:127], v[36:39], v[44:47], v[112:127]
    ds_read_b128 v[32:35], v141 offset:0
    ds_read_b128 v[36:39], v141 offset:4096
    ds_read_b128 v[40:43], v143 offset:0
    ds_read_b128 v[44:47], v143 offset:4096
    s_waitcnt lgkmcnt(4)
    v_mfma_f32_32x32x16_bf16 v[64:79], v[16:19], v[24:27], v[64:79]
    v_mfma_f32_32x32x16_bf16 v[80:95], v[20:23], v[24:27], v[80:95]
    v_mfma_f32_32x32x16_bf16 v[96:111], v[16:19], v[28:31], v[96:111]
    v_mfma_f32_32x32x16_bf16 v[112:127], v[20:23], v[28:31], v[112:127]
    s_waitcnt lgkmcnt(0)
    v_mfma_f32_32x32x16_bf16 v[64:79], v[32:35], v[40:43], v[64:79]
    v_mfma_f32_32x32x16_bf16 v[80:95], v[36:39], v[40:43], v[80:95]
    v_mfma_f32_32x32x16_bf16 v[96:111], v[32:35], v[44:47], v[96:111]
    v_mfma_f32_32x32x16_bf16 v[112:127], v[36:39], v[44:47], v[112:127]
    s_nop 15
    s_nop 3
    s_barrier
    v_lshlrev_b32 v3, 4, v2
    s_lshl_b32 s23, s22, 13
    v_add_u32 v3, s23, v3
    s_xor_b32 s23, s22, 4
    s_lshl_b32 s23, s23, 13
    v_lshlrev_b32 v4, 4, v2
    v_add_u32 v4, s23, v4
    s_cmp_eq_u32 s24, 0
    s_cbranch_scc1 L_g4_x0
    ds_write_b128 v3, v[64:67] offset:0
    ds_write_b128 v3, v[68:71] offset:1024
    ds_write_b128 v3, v[72:75] offset:2048
    ds_write_b128 v3, v[76:79] offset:3072
    ds_write_b128 v3, v[80:83] offset:4096
    ds_write_b128 v3, v[84:87] offset:5120
    ds_write_b128 v3, v[88:91] offset:6144
    ds_write_b128 v3, v[92:95] offset:7168
    v_mov_b32 v64, v96
    v_mov_b32 v65, v97
    v_mov_b32 v66, v98
    v_mov_b32 v67, v99
    v_mov_b32 v68, v100
    v_mov_b32 v69, v101
    v_mov_b32 v70, v102
    v_mov_b32 v71, v103
    v_mov_b32 v72, v104
    v_mov_b32 v73, v105
    v_mov_b32 v74, v106
    v_mov_b32 v75, v107
    v_mov_b32 v76, v108
    v_mov_b32 v77, v109
    v_mov_b32 v78, v110
    v_mov_b32 v79, v111
    v_mov_b32 v80, v112
    v_mov_b32 v81, v113
    v_mov_b32 v82, v114
    v_mov_b32 v83, v115
    v_mov_b32 v84, v116
    v_mov_b32 v85, v117
    v_mov_b32 v86, v118
    v_mov_b32 v87, v119
    v_mov_b32 v88, v120
    v_mov_b32 v89, v121
    v_mov_b32 v90, v122
    v_mov_b32 v91, v123
    v_mov_b32 v92, v124
    v_mov_b32 v93, v125
    v_mov_b32 v94, v126
    v_mov_b32 v95, v127
    s_branch L_g4_x1
L_g4_x0:
    ds_write_b128 v3, v[96:99] offset:0
    ds_write_b128 v3, v[100:103] offset:1024
    ds_write_b128 v3, v[104:107] offset:2048
    ds_write_b128 v3, v[108:111] offset:3072
    ds_write_b128 v3, v[112:115] offset:4096
    ds_write_b128 v3, v[116:119] offset:5120
    ds_write_b128 v3, v[120:123] offset:6144
    ds_write_b128 v3, v[124:127] offset:7168
L_g4_x1:
    s_waitcnt lgkmcnt(0)
    s_barrier
    ds_read_b128 v[96:99], v4 offset:0
    ds_read_b128 v[100:103], v4 offset:1024
    ds_read_b128 v[104:107], v4 offset:2048
    ds_read_b128 v[108:111], v4 offset:3072
    ds_read_b128 v[112:115], v4 offset:4096
    ds_read_b128 v[116:119], v4 offset:5120
    ds_read_b128 v[120:123], v4 offset:6144
    ds_read_b128 v[124:127], v4 offset:7168
    s_waitcnt lgkmcnt(7)
    v_add_f32 v64, v64, v96
    v_add_f32 v65, v65, v97
    v_add_f32 v66, v66, v98
    v_add_f32 v67, v67, v99
    s_waitcnt lgkmcnt(6)
    v_add_f32 v68, v68, v100
    v_add_f32 v69, v69, v101
    v_add_f32 v70, v70, v102
    v_add_f32 v71, v71, v103
    s_waitcnt lgkmcnt(5)
    v_add_f32 v72, v72, v104
    v_add_f32 v73, v73, v105
    v_add_f32 v74, v74, v106
    v_add_f32 v75, v75, v107
    s_waitcnt lgkmcnt(4)
    v_add_f32 v76, v76, v108
    v_add_f32 v77, v77, v109
    v_add_f32 v78, v78, v110
    v_add_f32 v79, v79, v111
    s_waitcnt lgkmcnt(3)
    v_add_f32 v80, v80, v112
    v_add_f32 v81, v81, v113
    v_add_f32 v82, v82, v114
    v_add_f32 v83, v83, v115
    s_waitcnt lgkmcnt(2)
    v_add_f32 v84, v84, v116
    v_add_f32 v85, v85, v117
    v_add_f32 v86, v86, v118
    v_add_f32 v87, v87, v119
    s_waitcnt lgkmcnt(1)
    v_add_f32 v88, v88, v120
    v_add_f32 v89, v89, v121
    v_add_f32 v90, v90, v122
    v_add_f32 v91, v91, v123
    s_waitcnt lgkmcnt(0)
    v_add_f32 v92, v92, v124
    v_add_f32 v93, v93, v125
    v_add_f32 v94, v94, v126
    v_add_f32 v95, v95, v127
    s_lshl_b32 s23, s26, 6
    v_and_b32 v3, 31, v2
    v_add_u32 v3, s23, v3
    s_lshl_b32 s23, s24, 5
    v_add_u32 v3, s23, v3
    s_mov_b32 s23, 4096
    v_mul_lo_u32 v3, v3, s23
    v_lshrrev_b32 v4, 5, v2
    v_lshl_add_u32 v3, v4, 4, v3
    s_lshl_b32 s23, s25, 7
    s_add_u32 s23, s23, s21
    v_add_u32 v3, s23, v3
    v_add_u32 v4, 131072, v3
    v_cvt_pk_bf16_f32 v16, v64, v65
    v_cvt_pk_bf16_f32 v17, v66, v67
    v_cvt_pk_bf16_f32 v18, v68, v69
    v_cvt_pk_bf16_f32 v19, v70, v71
    v_cvt_pk_bf16_f32 v20, v72, v73
    v_cvt_pk_bf16_f32 v21, v74, v75
    v_cvt_pk_bf16_f32 v22, v76, v77
    v_cvt_pk_bf16_f32 v23, v78, v79
    s_nop 1
    v_permlane32_swap_b32 v16, v18
    v_permlane32_swap_b32 v17, v19
    v_permlane32_swap_b32 v20, v22
    v_permlane32_swap_b32 v21, v23
    buffer_store_dwordx4 v[16:19], v3, s[12:15], 0 offen offset:0
    buffer_store_dwordx4 v[20:23], v3, s[12:15], 0 offen offset:32
    v_cvt_pk_bf16_f32 v24, v80, v81
    v_cvt_pk_bf16_f32 v25, v82, v83
    v_cvt_pk_bf16_f32 v26, v84, v85
    v_cvt_pk_bf16_f32 v27, v86, v87
    v_cvt_pk_bf16_f32 v28, v88, v89
    v_cvt_pk_bf16_f32 v29, v90, v91
    v_cvt_pk_bf16_f32 v30, v92, v93
    v_cvt_pk_bf16_f32 v31, v94, v95
    s_nop 1
    v_permlane32_swap_b32 v24, v26
    v_permlane32_swap_b32 v25, v27
    v_permlane32_swap_b32 v28, v30
    v_permlane32_swap_b32 v29, v31
    buffer_store_dwordx4 v[24:27], v3, s[12:15], 0 offen offset:64
    buffer_store_dwordx4 v[28:31], v3, s[12:15], 0 offen offset:96
L_k3_end:
    s_endpgm
.section .rodata,"a"
.p2align 6
.amdhsa_kernel k1_kernel
  .amdhsa_next_free_vgpr 256
  .amdhsa_next_free_sgpr 102
  .amdhsa_accum_offset 256
  .amdhsa_group_segment_fixed_size 0
  .amdhsa_kernarg_size 104
  .amdhsa_user_sgpr_count 2
  .amdhsa_user_sgpr_kernarg_segment_ptr 1
  .amdhsa_system_sgpr_workgroup_id_x 1
.end_amdhsa_kernel
.p2align 6
.amdhsa_kernel k2_kernel
  .amdhsa_next_free_vgpr 256
  .amdhsa_next_free_sgpr 100
  .amdhsa_accum_offset 256
  .amdhsa_group_segment_fixed_size 0
  .amdhsa_kernarg_size 104
  .amdhsa_user_sgpr_count 2
  .amdhsa_user_sgpr_kernarg_segment_ptr 1
  .amdhsa_system_sgpr_workgroup_id_x 1
.end_amdhsa_kernel
.p2align 6
.amdhsa_kernel k3_kernel
  .amdhsa_next_free_vgpr 248
  .amdhsa_next_free_sgpr 100
  .amdhsa_accum_offset 248
  .amdhsa_group_segment_fixed_size 0
  .amdhsa_kernarg_size 104
  .amdhsa_user_sgpr_count 2
  .amdhsa_user_sgpr_kernarg_segment_ptr 1
  .amdhsa_system_sgpr_workgroup_id_x 1
.end_amdhsa_kernel
```
